```python
import torch

def _softmax(x, axis=-1):
    return torch.softmax(x, dim=axis)
def _gelu(x):
    return torch.nn.functional.gelu(x, approximate="tanh")
def _silu(x):
    return torch.nn.functional.silu(x)
def _sigmoid(x):
    return torch.sigmoid(x)
def _layernorm(x, axis=-1, eps=1e-5):
    m = x.mean(dim=axis, keepdim=True)
    v = x.var(dim=axis, keepdim=True, unbiased=False)
    return (x - m) / torch.sqrt(v + eps)
def _scatter_add(tgt, idx, src, axis=0):
    return tgt.clone().index_add_(axis, idx, src)
def _segment_sum(src, seg, n):
    out = torch.zeros((n,) + src.shape[1:], dtype=src.dtype)
    return out.index_add_(0, seg, src)
def _pad(x, pw):
    flat = tuple(v for pair in reversed(pw) for v in pair)
    return torch.nn.functional.pad(x, flat)

kernel_name = 'interleave_layers__ssm_conv_s4d__grouped_kv_mqa__prompt'

def setup_inputs():

    _w = (lambda a: (lambda t: t.to(torch.bfloat16) if t.is_floating_point() else t)(torch.as_tensor(a)))
    def _A_setup():
        Bsz, L, D, N = 1, 2048, 640, 128
        return {
            "u": _w((lambda *s: torch.randn(*s, dtype=torch.bfloat16) * 0.05)(Bsz, L, D)),
            "log_A_real": _w((lambda *s: torch.randn(*s, dtype=torch.bfloat16) * 3.2)(D, N) * 0.5),
            "A_imag": _w((lambda *s: torch.randn(*s, dtype=torch.bfloat16) * 0.05)(D, N) * 3.14),
            "C_real": _w((lambda *s: torch.randn(*s, dtype=torch.bfloat16) * 0.05)(D, N) / N ** 0.5),
            "C_imag": _w((lambda *s: torch.randn(*s, dtype=torch.bfloat16) * 0.05)(D, N) / N ** 0.5),
            "log_dt": _w((lambda *s: torch.randn(*s, dtype=torch.bfloat16) * 0.05)(D) * 0.5 - 4.0),
            "D_skip": _w((lambda *s: torch.randn(*s, dtype=torch.bfloat16) * 0.05)(D)),
        }
    _A_in = _A_setup()

    def _B_setup():
        B, S, D, H = 1, 2048, 640, 32
        Dh = D // H
        return {
            "x": _w((lambda *s: torch.randn(*s, dtype=torch.bfloat16) * 0.05)(B, S, D)),
            "wq": _w((lambda *s: torch.randn(*s, dtype=torch.bfloat16) * 0.05)(D, H * Dh)),
            "wk": _w((lambda *s: torch.randn(*s, dtype=torch.bfloat16) * 0.05)(D, Dh)),
            "wv": _w((lambda *s: torch.randn(*s, dtype=torch.bfloat16) * 0.05)(D, Dh)),
            "wo": _w((lambda *s: torch.randn(*s, dtype=torch.bfloat16) * 0.05)(H * Dh, D)),
        }
    _B_in = _B_setup()

    return {
        "A_u": _A_in["u"],
        "A_log_A_real": _A_in["log_A_real"],
        "A_A_imag": _A_in["A_imag"],
        "A_C_real": _A_in["C_real"],
        "A_C_imag": _A_in["C_imag"],
        "A_log_dt": _A_in["log_dt"],
        "A_D_skip": _A_in["D_skip"],
        "B_x": _B_in["x"],
        "B_wq": _B_in["wq"],
        "B_wk": _B_in["wk"],
        "B_wv": _B_in["wv"],
        "B_wo": _B_in["wo"],
    }

def reference(A_u, A_log_A_real, A_A_imag, A_C_real, A_C_imag, A_log_dt, A_D_skip, B_x, B_wq, B_wk, B_wv, B_wo):
    def _A_ref(u, log_A_real, A_imag, C_real, C_imag, log_dt, D_skip):
        L = u.shape[1]
        dt = torch.exp(log_dt)
        A = -torch.exp(log_A_real) + 1j * A_imag
        C = (C_real + 1j * C_imag) * dt[:, None]
        pos = (lambda x, dt: x.to(dt))(torch.arange(L), log_dt.dtype)
        P = torch.exp((A * dt[:, None])[:, :, None] * pos[None, None, :])
        K = 2.0 * torch.einsum("dn,dnl->dl", C, P).real
        L2 = 2 * L
        u_t = (lambda x, *d: x.permute(*d))(u, 0, 2, 1)
        Kf = (lambda x, *a, **k: torch.fft.rfft(x.float(), *a, **k))(K, L2)
        Uf = (lambda x, *a, **k: torch.fft.rfft(x.float(), *a, **k))(u_t, L2)
        y = (lambda x, *a, **k: torch.fft.irfft(x, *a, **k).to(torch.bfloat16))(Uf * Kf[None, :, :], L2)[:, :, :L]
        y = (lambda x, *d: x.permute(*d))(y, 0, 2, 1)
        return y + u * D_skip[None, None, :]

    def _B_ref(x, wq, wk, wv, wo):
        B, S, D = x.shape
        H = 32
        Dh = D // H
        q = (lambda x, *d: x.permute(*d))((x @ wq).reshape(B, S, H, Dh), 0, 2, 1, 3)
        k = x @ wk
        v = x @ wv
        scores = torch.einsum("bhqd,bkd->bhqk", q, k) * (Dh ** -0.5)
        p = _softmax(scores, axis=-1)
        o = torch.einsum("bhqk,bkd->bhqd", p, v)
        return (lambda x, *d: x.permute(*d))(o, 0, 2, 1, 3).reshape(B, S, H * Dh) @ wo

    x = A_u
    x = x + _A_ref(_layernorm(x, axis=-1), A_log_A_real, A_A_imag, A_C_real, A_C_imag, A_log_dt, A_D_skip)
    x = x + _B_ref(_layernorm(x, axis=-1), B_wq, B_wk, B_wv, B_wo)
    x = x + _A_ref(_layernorm(x, axis=-1), A_log_A_real, A_A_imag, A_C_real, A_C_imag, A_log_dt, A_D_skip)
    x = x + _B_ref(_layernorm(x, axis=-1), B_wq, B_wk, B_wv, B_wo)
    return x
```

```asm
; @launch kernel=prep_kernel grid=(980,1,1) block=(256,1,1) lds=28672
; @launch kernel=conv_kernel grid=(256,1,1) block=(512,1,1) lds=91488
; @launch kernel=qkv_kernel grid=(256,1,1) block=(512,1,1) lds=163840
; @launch kernel=attn_kernel grid=(256,1,1) block=(512,1,1) lds=163840
; @launch kernel=oprojt_kernel grid=(256,1,1) block=(512,1,1) lds=163840
; @launch kernel=conv2_kernel grid=(256,1,1) block=(512,1,1) lds=91488
; @launch kernel=qkv2_kernel grid=(256,1,1) block=(512,1,1) lds=163840
; @launch kernel=attn2_kernel grid=(256,1,1) block=(512,1,1) lds=163840
; @launch kernel=oprojf_kernel grid=(256,1,1) block=(512,1,1) lds=163840
.amdgcn_target "amdgcn-amd-amdhsa--gfx950"
.text
.globl prep_kernel
.p2align 8
.type prep_kernel,@function
prep_kernel:
    s_cmp_ge_u32 s2, 980
    s_cbranch_scc1 prep_end
    s_load_dwordx16 s[16:31], s[0:1], 0
    s_load_dwordx8 s[32:39], s[0:1], 64
    s_load_dwordx2 s[40:41], s[0:1], 112
    s_load_dwordx2 s[42:43], s[0:1], 96
    v_lshrrev_b32 v2, 6, v0
    v_and_b32 v1, 63, v0
    v_and_b32 v3, 31, v0
    v_readfirstlane_b32 s3, v2
    v_bfe_u32 v4, v0, 5, 1
    v_and_b32 v5, 15, v0
    v_bfe_u32 v6, v0, 4, 2
    s_waitcnt lgkmcnt(0)
    s_add_u32 s44, s18, 0
    s_addc_u32 s45, s19, 0
    s_mov_b32 s46, 163840
    s_mov_b32 s47, 0x00020000
    s_add_u32 s48, s20, 0
    s_addc_u32 s49, s21, 0
    s_mov_b32 s50, 163840
    s_mov_b32 s51, 0x00020000
    s_add_u32 s52, s22, 0
    s_addc_u32 s53, s23, 0
    s_mov_b32 s54, 163840
    s_mov_b32 s55, 0x00020000
    s_add_u32 s56, s24, 0
    s_addc_u32 s57, s25, 0
    s_mov_b32 s58, 163840
    s_mov_b32 s59, 0x00020000
    s_add_u32 s60, s40, 2097152
    s_addc_u32 s61, s41, 0
    s_mov_b32 s62, 2949120
    s_mov_b32 s63, 0x00020000
    s_add_u32 s64, s16, 0
    s_addc_u32 s65, s17, 0
    s_mov_b32 s66, 2621440
    s_mov_b32 s67, 0x00020000
    s_add_u32 s68, s40, 23068672
    s_addc_u32 s69, s41, 0
    s_mov_b32 s70, 2621440
    s_mov_b32 s71, 0x00020000
    s_add_u32 s72, s40, 11534336
    s_addc_u32 s73, s41, 0
    s_mov_b32 s74, 16384
    s_mov_b32 s75, 0x00020000
    s_cmp_ge_u32 s2, 640
    s_cbranch_scc1 prep_ln
    s_mov_b32 s33, s2
    s_lshl_b32 s4, s33, 1
    s_and_b32 s4, s4, 0xfffffffc
    s_load_dword s5, s[26:27], s4
    v_and_b32 v7, 127, v0
    s_lshl_b32 s6, s33, 8
    v_lshlrev_b32 v8, 1, v7
    buffer_load_ushort v10, v8, s[44:47], s6 offen
    buffer_load_ushort v11, v8, s[48:51], s6 offen
    buffer_load_ushort v12, v8, s[52:55], s6 offen
    buffer_load_ushort v13, v8, s[56:59], s6 offen
    v_lshlrev_b32 v20, 8, v3
    v_subrev_u32 v20, 3072, v20
    v_bfe_u32 v22, v3, 1, 1
    v_lshlrev_b32 v22, 8, v22
    v_and_b32 v23, 1, v3
    v_lshl_add_u32 v22, v23, 2, v22
    v_add_u32 v22, 512, v22
    v_cmp_gt_u32 vcc, 16, v3
    v_lshlrev_b32 v23, 1, v3
    v_add_u32 v23, 240, v23
    v_cndmask_b32 v20, v20, v22, vcc
    v_cmp_gt_u32 vcc, 12, v3
    s_nop 1
    v_cndmask_b32 v20, v20, v23, vcc
    v_cmp_gt_u32 vcc, 8, v3
    s_nop 1
    v_cndmask_b32 v20, v20, v3, vcc
    v_cvt_f32_u32 v20, v20
    v_lshlrev_b32 v21, 3, v3
    v_cvt_f32_u32 v21, v21
    v_lshrrev_b32 v24, 3, v0
    v_lshlrev_b32 v15, 8, v24
    v_subrev_u32 v15, 3072, v15
    v_bfe_u32 v22, v24, 1, 1
    v_lshlrev_b32 v22, 8, v22
    v_and_b32 v23, 1, v24
    v_lshl_add_u32 v22, v23, 2, v22
    v_add_u32 v22, 512, v22
    v_cmp_gt_u32 vcc, 16, v24
    v_lshlrev_b32 v23, 1, v24
    v_add_u32 v23, 240, v23
    v_cndmask_b32 v15, v15, v22, vcc
    v_cmp_gt_u32 vcc, 12, v24
    s_nop 1
    v_cndmask_b32 v15, v15, v23, vcc
    v_cmp_gt_u32 vcc, 8, v24
    s_nop 1
    v_cndmask_b32 v15, v15, v24, vcc
    v_and_b32 v22, 7, v0
    v_lshl_add_u32 v15, v22, 5, v15
    v_lshlrev_b32 v15, 2, v15
    v_mov_b32 v31, 257
    v_mov_b32 v24, v0
    v_mov_b32 v25, 66079
    v_mov_b32 v27, 33685504
    v_cmpx_le_u32 vcc, 72, v24
    v_mov_b32 v25, 67199
    v_mov_b32 v27, 394238
    v_cmpx_le_u32 vcc, 88, v24
    v_mov_b32 v25, 1061120
    v_mov_b32 v27, 32506376
    v_cmpx_le_u32 vcc, 96, v24
    v_mov_b32 v25, 1062136
    v_mov_b32 v27, 32506376
    v_cmpx_le_u32 vcc, 104, v24
    v_mov_b32 v25, 1063156
    v_mov_b32 v27, 33030660
    v_cmpx_le_u32 vcc, 112, v24
    v_mov_b32 v25, 1064188
    v_mov_b32 v27, 33030660
    v_cmpx_le_u32 vcc, 120, v24
    v_mov_b32 v25, 1065984
    v_mov_b32 v27, 66061328
    v_cmpx_le_u32 vcc, 130, v24
    v_mov_b32 v25, 1067256
    v_mov_b32 v27, 66061320
    s_mov_b64 exec, -1
    v_lshrrev_b32 v26, 16, v25
    v_lshrrev_b32 v28, 16, v27
    v_and_b32 v25, 0xffff, v25
    v_and_b32 v27, 0xffff, v27
    v_lshlrev_b32 v24, 3, v24
    v_mul_u32_u24 v24, v24, v26
    v_sub_u32 v25, v25, v24
    v_sub_u32 v29, v25, v27
    v_cmp_le_u32 vcc, v29, v28
    v_max_i32 v30, 0, v25
    v_cvt_f32_u32 v30, v30
    v_cvt_pk_bf16_f32 v30, v30, v30
    v_lshlrev_b32 v30, 16, v30
    v_cvt_u32_f32 v30, v30
    v_cndmask_b32 v48, v31, v30, vcc
    v_lshlrev_b32 v48, 2, v48
    v_sub_u32 v25, v25, v26
    v_sub_u32 v29, v25, v27
    v_cmp_le_u32 vcc, v29, v28
    v_max_i32 v30, 0, v25
    v_cvt_f32_u32 v30, v30
    v_cvt_pk_bf16_f32 v30, v30, v30
    v_lshlrev_b32 v30, 16, v30
    v_cvt_u32_f32 v30, v30
    v_cndmask_b32 v49, v31, v30, vcc
    v_lshlrev_b32 v49, 2, v49
    v_sub_u32 v25, v25, v26
    v_sub_u32 v29, v25, v27
    v_cmp_le_u32 vcc, v29, v28
    v_max_i32 v30, 0, v25
    v_cvt_f32_u32 v30, v30
    v_cvt_pk_bf16_f32 v30, v30, v30
    v_lshlrev_b32 v30, 16, v30
    v_cvt_u32_f32 v30, v30
    v_cndmask_b32 v50, v31, v30, vcc
    v_lshlrev_b32 v50, 2, v50
    v_sub_u32 v25, v25, v26
    v_sub_u32 v29, v25, v27
    v_cmp_le_u32 vcc, v29, v28
    v_max_i32 v30, 0, v25
    v_cvt_f32_u32 v30, v30
    v_cvt_pk_bf16_f32 v30, v30, v30
    v_lshlrev_b32 v30, 16, v30
    v_cvt_u32_f32 v30, v30
    v_cndmask_b32 v51, v31, v30, vcc
    v_lshlrev_b32 v51, 2, v51
    v_sub_u32 v25, v25, v26
    v_sub_u32 v29, v25, v27
    v_cmp_le_u32 vcc, v29, v28
    v_max_i32 v30, 0, v25
    v_cvt_f32_u32 v30, v30
    v_cvt_pk_bf16_f32 v30, v30, v30
    v_lshlrev_b32 v30, 16, v30
    v_cvt_u32_f32 v30, v30
    v_cndmask_b32 v52, v31, v30, vcc
    v_lshlrev_b32 v52, 2, v52
    v_sub_u32 v25, v25, v26
    v_sub_u32 v29, v25, v27
    v_cmp_le_u32 vcc, v29, v28
    v_max_i32 v30, 0, v25
    v_cvt_f32_u32 v30, v30
    v_cvt_pk_bf16_f32 v30, v30, v30
    v_lshlrev_b32 v30, 16, v30
    v_cvt_u32_f32 v30, v30
    v_cndmask_b32 v53, v31, v30, vcc
    v_lshlrev_b32 v53, 2, v53
    v_sub_u32 v25, v25, v26
    v_sub_u32 v29, v25, v27
    v_cmp_le_u32 vcc, v29, v28
    v_max_i32 v30, 0, v25
    v_cvt_f32_u32 v30, v30
    v_cvt_pk_bf16_f32 v30, v30, v30
    v_lshlrev_b32 v30, 16, v30
    v_cvt_u32_f32 v30, v30
    v_cndmask_b32 v54, v31, v30, vcc
    v_lshlrev_b32 v54, 2, v54
    v_sub_u32 v25, v25, v26
    v_sub_u32 v29, v25, v27
    v_cmp_le_u32 vcc, v29, v28
    v_max_i32 v30, 0, v25
    v_cvt_f32_u32 v30, v30
    v_cvt_pk_bf16_f32 v30, v30, v30
    v_lshlrev_b32 v30, 16, v30
    v_cvt_u32_f32 v30, v30
    v_cndmask_b32 v55, v31, v30, vcc
    v_lshlrev_b32 v55, 2, v55
    v_add_u32 v24, 1, v0
    v_mov_b32 v25, 66079
    v_mov_b32 v27, 33685504
    v_cmpx_le_u32 vcc, 72, v24
    v_mov_b32 v25, 67199
    v_mov_b32 v27, 394238
    v_cmpx_le_u32 vcc, 88, v24
    v_mov_b32 v25, 1061120
    v_mov_b32 v27, 32506376
    v_cmpx_le_u32 vcc, 96, v24
    v_mov_b32 v25, 1062136
    v_mov_b32 v27, 32506376
    v_cmpx_le_u32 vcc, 104, v24
    v_mov_b32 v25, 1063156
    v_mov_b32 v27, 33030660
    v_cmpx_le_u32 vcc, 112, v24
    v_mov_b32 v25, 1064188
    v_mov_b32 v27, 33030660
    v_cmpx_le_u32 vcc, 120, v24
    v_mov_b32 v25, 1065984
    v_mov_b32 v27, 66061328
    v_cmpx_le_u32 vcc, 130, v24
    v_mov_b32 v25, 1067256
    v_mov_b32 v27, 66061320
    s_mov_b64 exec, -1
    v_lshrrev_b32 v26, 16, v25
    v_lshrrev_b32 v28, 16, v27
    v_and_b32 v25, 0xffff, v25
    v_and_b32 v27, 0xffff, v27
    v_lshlrev_b32 v24, 3, v24
    v_mul_u32_u24 v24, v24, v26
    v_sub_u32 v25, v25, v24
    v_sub_u32 v29, v25, v27
    v_cmp_le_u32 vcc, v29, v28
    v_max_i32 v30, 0, v25
    v_cvt_f32_u32 v30, v30
    v_cvt_pk_bf16_f32 v30, v30, v30
    v_lshlrev_b32 v30, 16, v30
    v_cvt_u32_f32 v30, v30
    v_cndmask_b32 v23, v31, v30, vcc
    v_lshlrev_b32 v23, 2, v23
    s_load_dword s9, s[28:29], s4
    s_and_b32 s7, s33, 1
    s_lshl_b32 s7, s7, 4
    s_waitcnt lgkmcnt(0)
    s_lshr_b32 s9, s9, s7
    s_lshl_b32 s9, s9, 16
    s_lshr_b32 s5, s5, s7
    s_lshl_b32 s5, s5, 16
    v_mov_b32 v14, s5
    v_mul_f32 v14, 1069066811, v14
    v_exp_f32 v14, v14
    s_waitcnt vmcnt(0)
    v_cvt_pk_bf16_f32 v14, v14, v14
    v_lshlrev_b32 v14, 16, v14
    v_lshlrev_b32 v10, 16, v10
    v_lshlrev_b32 v11, 16, v11
    v_lshlrev_b32 v12, 16, v12
    v_lshlrev_b32 v13, 16, v13
    v_mul_f32 v10, 1069066811, v10
    v_exp_f32 v10, v10
    v_mul_f32 v17, v11, v14
    v_cvt_pk_bf16_f32 v10, v10, v10
    v_lshlrev_b32 v10, 16, v10
    v_mul_f32 v16, v10, v14
    v_mul_f32 v16, 0xbfb8aa3b, v16
    v_mul_f32 v17, 1042479491, v17
    v_mul_f32 v18, v12, v14
    v_mul_f32 v19, v13, v14
    v_mul_f32 v18, 0x46000000, v18
    v_mul_f32 v19, 0x46000000, v19
    v_lshlrev_b32 v9, 4, v7
    ds_write_b128 v9, v[16:19]
    s_waitcnt lgkmcnt(0)
    s_barrier
    s_lshl_b32 s8, s3, 9
    s_mul_i32 s11, s3, 3072
    s_add_u32 s11, s11, 4096
    v_lshlrev_b32 v9, 6, v4
    v_add_u32 v9, s8, v9
    ds_read_b128 v[88:91], v9 offset:0
    ds_read_b128 v[92:95], v9 offset:16
    ds_read_b128 v[96:99], v9 offset:32
    ds_read_b128 v[100:103], v9 offset:48
    ds_read_b128 v[104:107], v9 offset:128
    ds_read_b128 v[108:111], v9 offset:144
    ds_read_b128 v[112:115], v9 offset:160
    ds_read_b128 v[116:119], v9 offset:176
    s_waitcnt lgkmcnt(4)
    v_pk_mul_f32 v[56:57], v[88:89], v[20:21] op_sel:[0,0] op_sel_hi:[1,0]
    v_pk_mul_f32 v[60:61], v[92:93], v[20:21] op_sel:[0,0] op_sel_hi:[1,0]
    v_pk_mul_f32 v[64:65], v[96:97], v[20:21] op_sel:[0,0] op_sel_hi:[1,0]
    v_pk_mul_f32 v[68:69], v[100:101], v[20:21] op_sel:[0,0] op_sel_hi:[1,0]
    v_exp_f32 v56, v56
    v_fract_f32 v57, v57
    v_exp_f32 v60, v60
    v_fract_f32 v61, v61
    v_exp_f32 v64, v64
    v_fract_f32 v65, v65
    v_exp_f32 v68, v68
    v_fract_f32 v69, v69
    v_cos_f32 v58, v57
    v_sin_f32 v59, v57
    v_cos_f32 v62, v61
    v_sin_f32 v63, v61
    v_cos_f32 v66, v65
    v_sin_f32 v67, v65
    v_cos_f32 v70, v69
    v_sin_f32 v71, v69
    s_nop 0
    v_pk_mul_f32 v[32:33], v[90:91], v[58:59] op_sel:[0,0] op_sel_hi:[0,1]
    v_pk_mul_f32 v[34:35], v[94:95], v[62:63] op_sel:[0,0] op_sel_hi:[0,1]
    v_pk_mul_f32 v[36:37], v[98:99], v[66:67] op_sel:[0,0] op_sel_hi:[0,1]
    v_pk_mul_f32 v[38:39], v[102:103], v[70:71] op_sel:[0,0] op_sel_hi:[0,1]
    v_pk_fma_f32 v[32:33], v[90:91], v[58:59], v[32:33] op_sel:[1,1,0] op_sel_hi:[1,0,1] neg_lo:[1,0,0]
    v_pk_fma_f32 v[34:35], v[94:95], v[62:63], v[34:35] op_sel:[1,1,0] op_sel_hi:[1,0,1] neg_lo:[1,0,0]
    v_pk_fma_f32 v[36:37], v[98:99], v[66:67], v[36:37] op_sel:[1,1,0] op_sel_hi:[1,0,1] neg_lo:[1,0,0]
    v_pk_fma_f32 v[38:39], v[102:103], v[70:71], v[38:39] op_sel:[1,1,0] op_sel_hi:[1,0,1] neg_lo:[1,0,0]
    v_pk_mul_f32 v[32:33], v[32:33], v[56:57] op_sel:[0,0] op_sel_hi:[1,0]
    v_pk_mul_f32 v[34:35], v[34:35], v[60:61] op_sel:[0,0] op_sel_hi:[1,0]
    v_pk_mul_f32 v[36:37], v[36:37], v[64:65] op_sel:[0,0] op_sel_hi:[1,0]
    v_pk_mul_f32 v[38:39], v[38:39], v[68:69] op_sel:[0,0] op_sel_hi:[1,0]
    v_pk_mul_f32 v[56:57], v[88:89], v[20:21] op_sel:[0,1] op_sel_hi:[1,1]
    v_pk_mul_f32 v[60:61], v[92:93], v[20:21] op_sel:[0,1] op_sel_hi:[1,1]
    v_pk_mul_f32 v[64:65], v[96:97], v[20:21] op_sel:[0,1] op_sel_hi:[1,1]
    v_pk_mul_f32 v[68:69], v[100:101], v[20:21] op_sel:[0,1] op_sel_hi:[1,1]
    v_exp_f32 v56, v56
    v_fract_f32 v57, v57
    v_exp_f32 v60, v60
    v_fract_f32 v61, v61
    v_exp_f32 v64, v64
    v_fract_f32 v65, v65
    v_exp_f32 v68, v68
    v_fract_f32 v69, v69
    v_cos_f32 v58, v57
    v_sin_f32 v59, v57
    v_cos_f32 v62, v61
    v_sin_f32 v63, v61
    v_cos_f32 v66, v65
    v_sin_f32 v67, v65
    v_cos_f32 v70, v69
    v_sin_f32 v71, v69
    s_nop 0
    v_pk_mul_f32 v[40:41], v[56:57], v[58:59] op_sel:[0,0] op_sel_hi:[0,1] neg_hi:[1,0]
    v_pk_mul_f32 v[42:43], v[60:61], v[62:63] op_sel:[0,0] op_sel_hi:[0,1] neg_hi:[1,0]
    v_pk_mul_f32 v[44:45], v[64:65], v[66:67] op_sel:[0,0] op_sel_hi:[0,1] neg_hi:[1,0]
    v_pk_mul_f32 v[46:47], v[68:69], v[70:71] op_sel:[0,0] op_sel_hi:[0,1] neg_hi:[1,0]
    v_cvt_pk_f16_f32 v24, v32, v33
    v_cvt_pk_f16_f32 v25, v34, v35
    v_cvt_pk_f16_f32 v26, v36, v37
    v_cvt_pk_f16_f32 v27, v38, v39
    v_cvt_pk_f16_f32 v28, v40, v41
    v_cvt_pk_f16_f32 v29, v42, v43
    v_cvt_pk_f16_f32 v30, v44, v45
    v_cvt_pk_f16_f32 v31, v46, v47
    s_nop 1
    v_mfma_f32_32x32x16_f16 v[72:87], v[24:27], v[28:31], 0
    ds_read_b128 v[88:91], v9 offset:256
    ds_read_b128 v[92:95], v9 offset:272
    ds_read_b128 v[96:99], v9 offset:288
    ds_read_b128 v[100:103], v9 offset:304
    s_waitcnt lgkmcnt(4)
    v_pk_mul_f32 v[56:57], v[104:105], v[20:21] op_sel:[0,0] op_sel_hi:[1,0]
    v_pk_mul_f32 v[60:61], v[108:109], v[20:21] op_sel:[0,0] op_sel_hi:[1,0]
    v_pk_mul_f32 v[64:65], v[112:113], v[20:21] op_sel:[0,0] op_sel_hi:[1,0]
    v_pk_mul_f32 v[68:69], v[116:117], v[20:21] op_sel:[0,0] op_sel_hi:[1,0]
    v_exp_f32 v56, v56
    v_fract_f32 v57, v57
    v_exp_f32 v60, v60
    v_fract_f32 v61, v61
    v_exp_f32 v64, v64
    v_fract_f32 v65, v65
    v_exp_f32 v68, v68
    v_fract_f32 v69, v69
    v_cos_f32 v58, v57
    v_sin_f32 v59, v57
    v_cos_f32 v62, v61
    v_sin_f32 v63, v61
    v_cos_f32 v66, v65
    v_sin_f32 v67, v65
    v_cos_f32 v70, v69
    v_sin_f32 v71, v69
    s_nop 0
    v_pk_mul_f32 v[32:33], v[106:107], v[58:59] op_sel:[0,0] op_sel_hi:[0,1]
    v_pk_mul_f32 v[34:35], v[110:111], v[62:63] op_sel:[0,0] op_sel_hi:[0,1]
    v_pk_mul_f32 v[36:37], v[114:115], v[66:67] op_sel:[0,0] op_sel_hi:[0,1]
    v_pk_mul_f32 v[38:39], v[118:119], v[70:71] op_sel:[0,0] op_sel_hi:[0,1]
    v_pk_fma_f32 v[32:33], v[106:107], v[58:59], v[32:33] op_sel:[1,1,0] op_sel_hi:[1,0,1] neg_lo:[1,0,0]
    v_pk_fma_f32 v[34:35], v[110:111], v[62:63], v[34:35] op_sel:[1,1,0] op_sel_hi:[1,0,1] neg_lo:[1,0,0]
    v_pk_fma_f32 v[36:37], v[114:115], v[66:67], v[36:37] op_sel:[1,1,0] op_sel_hi:[1,0,1] neg_lo:[1,0,0]
    v_pk_fma_f32 v[38:39], v[118:119], v[70:71], v[38:39] op_sel:[1,1,0] op_sel_hi:[1,0,1] neg_lo:[1,0,0]
    v_pk_mul_f32 v[32:33], v[32:33], v[56:57] op_sel:[0,0] op_sel_hi:[1,0]
    v_pk_mul_f32 v[34:35], v[34:35], v[60:61] op_sel:[0,0] op_sel_hi:[1,0]
    v_pk_mul_f32 v[36:37], v[36:37], v[64:65] op_sel:[0,0] op_sel_hi:[1,0]
    v_pk_mul_f32 v[38:39], v[38:39], v[68:69] op_sel:[0,0] op_sel_hi:[1,0]
    v_pk_mul_f32 v[56:57], v[104:105], v[20:21] op_sel:[0,1] op_sel_hi:[1,1]
    v_pk_mul_f32 v[60:61], v[108:109], v[20:21] op_sel:[0,1] op_sel_hi:[1,1]
    v_pk_mul_f32 v[64:65], v[112:113], v[20:21] op_sel:[0,1] op_sel_hi:[1,1]
    v_pk_mul_f32 v[68:69], v[116:117], v[20:21] op_sel:[0,1] op_sel_hi:[1,1]
    v_exp_f32 v56, v56
    v_fract_f32 v57, v57
    v_exp_f32 v60, v60
    v_fract_f32 v61, v61
    v_exp_f32 v64, v64
    v_fract_f32 v65, v65
    v_exp_f32 v68, v68
    v_fract_f32 v69, v69
    v_cos_f32 v58, v57
    v_sin_f32 v59, v57
    v_cos_f32 v62, v61
    v_sin_f32 v63, v61
    v_cos_f32 v66, v65
    v_sin_f32 v67, v65
    v_cos_f32 v70, v69
    v_sin_f32 v71, v69
    s_nop 0
    v_pk_mul_f32 v[40:41], v[56:57], v[58:59] op_sel:[0,0] op_sel_hi:[0,1] neg_hi:[1,0]
    v_pk_mul_f32 v[42:43], v[60:61], v[62:63] op_sel:[0,0] op_sel_hi:[0,1] neg_hi:[1,0]
    v_pk_mul_f32 v[44:45], v[64:65], v[66:67] op_sel:[0,0] op_sel_hi:[0,1] neg_hi:[1,0]
    v_pk_mul_f32 v[46:47], v[68:69], v[70:71] op_sel:[0,0] op_sel_hi:[0,1] neg_hi:[1,0]
    v_cvt_pk_f16_f32 v24, v32, v33
    v_cvt_pk_f16_f32 v25, v34, v35
    v_cvt_pk_f16_f32 v26, v36, v37
    v_cvt_pk_f16_f32 v27, v38, v39
    v_cvt_pk_f16_f32 v28, v40, v41
    v_cvt_pk_f16_f32 v29, v42, v43
    v_cvt_pk_f16_f32 v30, v44, v45
    v_cvt_pk_f16_f32 v31, v46, v47
    s_nop 1
    v_mfma_f32_32x32x16_f16 v[72:87], v[24:27], v[28:31], v[72:87]
    ds_read_b128 v[104:107], v9 offset:384
    ds_read_b128 v[108:111], v9 offset:400
    ds_read_b128 v[112:115], v9 offset:416
    ds_read_b128 v[116:119], v9 offset:432
    s_waitcnt lgkmcnt(4)
    v_pk_mul_f32 v[56:57], v[88:89], v[20:21] op_sel:[0,0] op_sel_hi:[1,0]
    v_pk_mul_f32 v[60:61], v[92:93], v[20:21] op_sel:[0,0] op_sel_hi:[1,0]
    v_pk_mul_f32 v[64:65], v[96:97], v[20:21] op_sel:[0,0] op_sel_hi:[1,0]
    v_pk_mul_f32 v[68:69], v[100:101], v[20:21] op_sel:[0,0] op_sel_hi:[1,0]
    v_exp_f32 v56, v56
    v_fract_f32 v57, v57
    v_exp_f32 v60, v60
    v_fract_f32 v61, v61
    v_exp_f32 v64, v64
    v_fract_f32 v65, v65
    v_exp_f32 v68, v68
    v_fract_f32 v69, v69
    v_cos_f32 v58, v57
    v_sin_f32 v59, v57
    v_cos_f32 v62, v61
    v_sin_f32 v63, v61
    v_cos_f32 v66, v65
    v_sin_f32 v67, v65
    v_cos_f32 v70, v69
    v_sin_f32 v71, v69
    s_nop 0
    v_pk_mul_f32 v[32:33], v[90:91], v[58:59] op_sel:[0,0] op_sel_hi:[0,1]
    v_pk_mul_f32 v[34:35], v[94:95], v[62:63] op_sel:[0,0] op_sel_hi:[0,1]
    v_pk_mul_f32 v[36:37], v[98:99], v[66:67] op_sel:[0,0] op_sel_hi:[0,1]
    v_pk_mul_f32 v[38:39], v[102:103], v[70:71] op_sel:[0,0] op_sel_hi:[0,1]
    v_pk_fma_f32 v[32:33], v[90:91], v[58:59], v[32:33] op_sel:[1,1,0] op_sel_hi:[1,0,1] neg_lo:[1,0,0]
    v_pk_fma_f32 v[34:35], v[94:95], v[62:63], v[34:35] op_sel:[1,1,0] op_sel_hi:[1,0,1] neg_lo:[1,0,0]
    v_pk_fma_f32 v[36:37], v[98:99], v[66:67], v[36:37] op_sel:[1,1,0] op_sel_hi:[1,0,1] neg_lo:[1,0,0]
    v_pk_fma_f32 v[38:39], v[102:103], v[70:71], v[38:39] op_sel:[1,1,0] op_sel_hi:[1,0,1] neg_lo:[1,0,0]
    v_pk_mul_f32 v[32:33], v[32:33], v[56:57] op_sel:[0,0] op_sel_hi:[1,0]
    v_pk_mul_f32 v[34:35], v[34:35], v[60:61] op_sel:[0,0] op_sel_hi:[1,0]
    v_pk_mul_f32 v[36:37], v[36:37], v[64:65] op_sel:[0,0] op_sel_hi:[1,0]
    v_pk_mul_f32 v[38:39], v[38:39], v[68:69] op_sel:[0,0] op_sel_hi:[1,0]
    v_pk_mul_f32 v[56:57], v[88:89], v[20:21] op_sel:[0,1] op_sel_hi:[1,1]
    v_pk_mul_f32 v[60:61], v[92:93], v[20:21] op_sel:[0,1] op_sel_hi:[1,1]
    v_pk_mul_f32 v[64:65], v[96:97], v[20:21] op_sel:[0,1] op_sel_hi:[1,1]
    v_pk_mul_f32 v[68:69], v[100:101], v[20:21] op_sel:[0,1] op_sel_hi:[1,1]
    v_exp_f32 v56, v56
    v_fract_f32 v57, v57
    v_exp_f32 v60, v60
    v_fract_f32 v61, v61
    v_exp_f32 v64, v64
    v_fract_f32 v65, v65
    v_exp_f32 v68, v68
    v_fract_f32 v69, v69
    v_cos_f32 v58, v57
    v_sin_f32 v59, v57
    v_cos_f32 v62, v61
    v_sin_f32 v63, v61
    v_cos_f32 v66, v65
    v_sin_f32 v67, v65
    v_cos_f32 v70, v69
    v_sin_f32 v71, v69
    s_nop 0
    v_pk_mul_f32 v[40:41], v[56:57], v[58:59] op_sel:[0,0] op_sel_hi:[0,1] neg_hi:[1,0]
    v_pk_mul_f32 v[42:43], v[60:61], v[62:63] op_sel:[0,0] op_sel_hi:[0,1] neg_hi:[1,0]
    v_pk_mul_f32 v[44:45], v[64:65], v[66:67] op_sel:[0,0] op_sel_hi:[0,1] neg_hi:[1,0]
    v_pk_mul_f32 v[46:47], v[68:69], v[70:71] op_sel:[0,0] op_sel_hi:[0,1] neg_hi:[1,0]
    v_cvt_pk_f16_f32 v24, v32, v33
    v_cvt_pk_f16_f32 v25, v34, v35
    v_cvt_pk_f16_f32 v26, v36, v37
    v_cvt_pk_f16_f32 v27, v38, v39
    v_cvt_pk_f16_f32 v28, v40, v41
    v_cvt_pk_f16_f32 v29, v42, v43
    v_cvt_pk_f16_f32 v30, v44, v45
    v_cvt_pk_f16_f32 v31, v46, v47
    s_nop 1
    v_mfma_f32_32x32x16_f16 v[72:87], v[24:27], v[28:31], v[72:87]
    s_waitcnt lgkmcnt(0)
    v_pk_mul_f32 v[56:57], v[104:105], v[20:21] op_sel:[0,0] op_sel_hi:[1,0]
    v_pk_mul_f32 v[60:61], v[108:109], v[20:21] op_sel:[0,0] op_sel_hi:[1,0]
    v_pk_mul_f32 v[64:65], v[112:113], v[20:21] op_sel:[0,0] op_sel_hi:[1,0]
    v_pk_mul_f32 v[68:69], v[116:117], v[20:21] op_sel:[0,0] op_sel_hi:[1,0]
    v_exp_f32 v56, v56
    v_fract_f32 v57, v57
    v_exp_f32 v60, v60
    v_fract_f32 v61, v61
    v_exp_f32 v64, v64
    v_fract_f32 v65, v65
    v_exp_f32 v68, v68
    v_fract_f32 v69, v69
    v_cos_f32 v58, v57
    v_sin_f32 v59, v57
    v_cos_f32 v62, v61
    v_sin_f32 v63, v61
    v_cos_f32 v66, v65
    v_sin_f32 v67, v65
    v_cos_f32 v70, v69
    v_sin_f32 v71, v69
    s_nop 0
    v_pk_mul_f32 v[32:33], v[106:107], v[58:59] op_sel:[0,0] op_sel_hi:[0,1]
    v_pk_mul_f32 v[34:35], v[110:111], v[62:63] op_sel:[0,0] op_sel_hi:[0,1]
    v_pk_mul_f32 v[36:37], v[114:115], v[66:67] op_sel:[0,0] op_sel_hi:[0,1]
    v_pk_mul_f32 v[38:39], v[118:119], v[70:71] op_sel:[0,0] op_sel_hi:[0,1]
    v_pk_fma_f32 v[32:33], v[106:107], v[58:59], v[32:33] op_sel:[1,1,0] op_sel_hi:[1,0,1] neg_lo:[1,0,0]
    v_pk_fma_f32 v[34:35], v[110:111], v[62:63], v[34:35] op_sel:[1,1,0] op_sel_hi:[1,0,1] neg_lo:[1,0,0]
    v_pk_fma_f32 v[36:37], v[114:115], v[66:67], v[36:37] op_sel:[1,1,0] op_sel_hi:[1,0,1] neg_lo:[1,0,0]
    v_pk_fma_f32 v[38:39], v[118:119], v[70:71], v[38:39] op_sel:[1,1,0] op_sel_hi:[1,0,1] neg_lo:[1,0,0]
    v_pk_mul_f32 v[32:33], v[32:33], v[56:57] op_sel:[0,0] op_sel_hi:[1,0]
    v_pk_mul_f32 v[34:35], v[34:35], v[60:61] op_sel:[0,0] op_sel_hi:[1,0]
    v_pk_mul_f32 v[36:37], v[36:37], v[64:65] op_sel:[0,0] op_sel_hi:[1,0]
    v_pk_mul_f32 v[38:39], v[38:39], v[68:69] op_sel:[0,0] op_sel_hi:[1,0]
    v_pk_mul_f32 v[56:57], v[104:105], v[20:21] op_sel:[0,1] op_sel_hi:[1,1]
    v_pk_mul_f32 v[60:61], v[108:109], v[20:21] op_sel:[0,1] op_sel_hi:[1,1]
    v_pk_mul_f32 v[64:65], v[112:113], v[20:21] op_sel:[0,1] op_sel_hi:[1,1]
    v_pk_mul_f32 v[68:69], v[116:117], v[20:21] op_sel:[0,1] op_sel_hi:[1,1]
    v_exp_f32 v56, v56
    v_fract_f32 v57, v57
    v_exp_f32 v60, v60
    v_fract_f32 v61, v61
    v_exp_f32 v64, v64
    v_fract_f32 v65, v65
    v_exp_f32 v68, v68
    v_fract_f32 v69, v69
    v_cos_f32 v58, v57
    v_sin_f32 v59, v57
    v_cos_f32 v62, v61
    v_sin_f32 v63, v61
    v_cos_f32 v66, v65
    v_sin_f32 v67, v65
    v_cos_f32 v70, v69
    v_sin_f32 v71, v69
    s_nop 0
    v_pk_mul_f32 v[40:41], v[56:57], v[58:59] op_sel:[0,0] op_sel_hi:[0,1] neg_hi:[1,0]
    v_pk_mul_f32 v[42:43], v[60:61], v[62:63] op_sel:[0,0] op_sel_hi:[0,1] neg_hi:[1,0]
    v_pk_mul_f32 v[44:45], v[64:65], v[66:67] op_sel:[0,0] op_sel_hi:[0,1] neg_hi:[1,0]
    v_pk_mul_f32 v[46:47], v[68:69], v[70:71] op_sel:[0,0] op_sel_hi:[0,1] neg_hi:[1,0]
    v_cvt_pk_f16_f32 v24, v32, v33
    v_cvt_pk_f16_f32 v25, v34, v35
    v_cvt_pk_f16_f32 v26, v36, v37
    v_cvt_pk_f16_f32 v27, v38, v39
    v_cvt_pk_f16_f32 v28, v40, v41
    v_cvt_pk_f16_f32 v29, v42, v43
    v_cvt_pk_f16_f32 v30, v44, v45
    v_cvt_pk_f16_f32 v31, v46, v47
    s_nop 1
    v_mfma_f32_32x32x16_f16 v[72:87], v[24:27], v[28:31], v[72:87]
    v_lshlrev_b32 v9, 9, v4
    v_lshl_add_u32 v9, v3, 2, v9
    v_add_u32 v9, s11, v9
    v_mov_b32 v12, 0
    v_mov_b32 v13, 0
    s_nop 7
    s_nop 1
    ds_write_b32 v9, v72 offset:0
    ds_write_b32 v9, v73 offset:128
    ds_write_b32 v9, v74 offset:256
    ds_write_b32 v9, v75 offset:384
    ds_write_b32 v9, v76 offset:1024
    ds_write_b32 v9, v77 offset:1152
    ds_write_b32 v9, v78 offset:1280
    ds_write_b32 v9, v79 offset:1408
    ds_write_b32 v9, v80 offset:2048
    ds_write_b32 v9, v81 offset:2176
    ds_write_b32 v9, v82 offset:2304
    ds_write_b32 v9, v83 offset:2432
    ds_write_b32 v12, v13 offset:17412
    s_waitcnt lgkmcnt(0)
    s_barrier
    s_cmp_eq_u32 s3, 3
    s_cbranch_scc1 prep_kg_nored
    v_lshlrev_b32 v10, 4, v0
    ds_read_b128 v[32:35], v10 offset:4096
    ds_read_b128 v[36:39], v10 offset:7168
    ds_read_b128 v[40:43], v10 offset:10240
    ds_read_b128 v[44:47], v10 offset:13312
    s_waitcnt lgkmcnt(0)
    v_add_f32 v32, v32, v36
    v_add_f32 v40, v40, v44
    v_add_f32 v32, v32, v40
    v_add_f32 v33, v33, v37
    v_add_f32 v41, v41, v45
    v_add_f32 v33, v33, v41
    v_add_f32 v34, v34, v38
    v_add_f32 v42, v42, v46
    v_add_f32 v34, v34, v42
    v_add_f32 v35, v35, v39
    v_add_f32 v43, v43, v47
    v_add_f32 v35, v35, v43
    v_mov_b32 v36, s9
    v_mul_f32 v36, 0x45800000, v36
    v_cmp_eq_u32 vcc, 0, v0
    s_nop 1
    v_cndmask_b32 v36, 0, v36, vcc
    v_add_f32 v32, v32, v36
    ds_write_b32 v15, v32 offset:16384
    ds_write_b32 v15, v33 offset:16416
    ds_write_b32 v15, v34 offset:16448
    ds_write_b32 v15, v35 offset:16480
    s_waitcnt lgkmcnt(0)
prep_kg_nored:
    s_barrier
    s_cmp_eq_u32 s3, 3
    s_cbranch_scc1 prep_kg_done
    ds_read_b32 v32, v48 offset:16384
    ds_read_b32 v33, v49 offset:16384
    ds_read_b32 v34, v50 offset:16384
    ds_read_b32 v35, v51 offset:16384
    ds_read_b32 v36, v52 offset:16384
    ds_read_b32 v37, v53 offset:16384
    ds_read_b32 v38, v54 offset:16384
    ds_read_b32 v39, v55 offset:16384
    ds_read_b32 v40, v23 offset:16384
    s_waitcnt lgkmcnt(0)
    v_mul_f32 v32, 0x39800000, v32
    v_mul_f32 v33, 0x39800000, v33
    v_mul_f32 v34, 0x39800000, v34
    v_mul_f32 v35, 0x39800000, v35
    v_mul_f32 v36, 0x39800000, v36
    v_mul_f32 v37, 0x39800000, v37
    v_mul_f32 v38, 0x39800000, v38
    v_mul_f32 v39, 0x39800000, v39
    v_mul_f32 v40, 0x39800000, v40
    v_cvt_pk_bf16_f32 v64, v32, v33
    v_cvt_pk_bf16_f32 v72, v33, v34
    v_cvt_pk_bf16_f32 v65, v34, v35
    v_cvt_pk_bf16_f32 v73, v35, v36
    v_cvt_pk_bf16_f32 v66, v36, v37
    v_cvt_pk_bf16_f32 v74, v37, v38
    v_cvt_pk_bf16_f32 v67, v38, v39
    v_cvt_pk_bf16_f32 v75, v39, v40
    s_mul_i32 s12, s33, 4608
    v_lshlrev_b32 v11, 4, v0
    s_add_u32 s13, s12, 2304
    v_cmp_gt_u32 vcc, 144, v0
    s_and_saveexec_b64 s[14:15], vcc
    buffer_store_dwordx4 v[64:67], v11, s[60:63], s12 offen sc0 sc1
    buffer_store_dwordx4 v[72:75], v11, s[60:63], s13 offen sc0 sc1
prep_kg_done:
    s_endpgm
prep_ln:
    s_setprio 3
    s_movk_i32 s6, 1280
    s_cmp_ge_u32 s2, 896
    s_cbranch_scc1 prep_w
    s_cmp_ge_u32 s2, 768
    s_cbranch_scc1 prep_st
    s_and_b32 s4, s2, 31
    s_lshl_b32 s4, s4, 6
    s_lshl_b32 s5, s3, 4
    s_add_u32 s4, s4, s5
    v_add_u32 v8, s4, v5
    v_mul_lo_u32 v8, v8, s6
    v_lshl_add_u32 v8, v6, 4, v8
    s_bfe_u32 s9, s2, 0x20005
    s_mul_i32 s10, s9, 320
    buffer_load_dwordx4 v[64:67], v8, s[64:67], s10 offen offset:0
    buffer_load_dwordx4 v[68:71], v8, s[64:67], s10 offen offset:64
    buffer_load_dwordx4 v[72:75], v8, s[64:67], s10 offen offset:128
    buffer_load_dwordx4 v[76:79], v8, s[64:67], s10 offen offset:192
    buffer_load_dwordx4 v[80:83], v8, s[64:67], s10 offen offset:256
    v_lshlrev_b32 v9, 3, v6
    v_sub_u32 v9, v5, v9
    v_mov_b32 v12, 0x3f80
    v_mov_b32 v13, 0x3f800000
    v_cmp_eq_u32 vcc, 0, v9
    v_cmp_eq_u32 s[14:15], 1, v9
    s_nop 1
    v_cndmask_b32 v16, 0, v12, vcc
    v_cndmask_b32 v16, v16, v13, s[14:15]
    v_cmp_eq_u32 vcc, 2, v9
    v_cmp_eq_u32 s[14:15], 3, v9
    s_nop 1
    v_cndmask_b32 v17, 0, v12, vcc
    v_cndmask_b32 v17, v17, v13, s[14:15]
    v_cmp_eq_u32 vcc, 4, v9
    v_cmp_eq_u32 s[14:15], 5, v9
    s_nop 1
    v_cndmask_b32 v18, 0, v12, vcc
    v_cndmask_b32 v18, v18, v13, s[14:15]
    v_cmp_eq_u32 vcc, 6, v9
    v_cmp_eq_u32 s[14:15], 7, v9
    s_nop 1
    v_cndmask_b32 v19, 0, v12, vcc
    v_cndmask_b32 v19, v19, v13, s[14:15]
    v_cmp_eq_u32 vcc, -16, v9
    v_cmp_eq_u32 s[14:15], -15, v9
    s_nop 1
    v_cndmask_b32 v20, 0, v12, vcc
    v_cndmask_b32 v20, v20, v13, s[14:15]
    v_cmp_eq_u32 vcc, -14, v9
    v_cmp_eq_u32 s[14:15], -13, v9
    s_nop 1
    v_cndmask_b32 v21, 0, v12, vcc
    v_cndmask_b32 v21, v21, v13, s[14:15]
    v_cmp_eq_u32 vcc, -12, v9
    v_cmp_eq_u32 s[14:15], -11, v9
    s_nop 1
    v_cndmask_b32 v22, 0, v12, vcc
    v_cndmask_b32 v22, v22, v13, s[14:15]
    v_cmp_eq_u32 vcc, -10, v9
    v_cmp_eq_u32 s[14:15], -9, v9
    s_nop 1
    v_cndmask_b32 v23, 0, v12, vcc
    v_cndmask_b32 v23, v23, v13, s[14:15]
    v_mul_u32_u24 v10, 144, v5
    v_lshl_add_u32 v10, v6, 3, v10
    s_lshl_b32 s7, s3, 5
    v_add_u32 v10, s7, v10
    s_waitcnt vmcnt(4)
    v_mfma_f32_16x16x32_bf16 v[32:35], v[64:67], v[16:19], 0
    v_mfma_f32_16x16x32_bf16 v[36:39], v[64:67], v[20:23], 0
    s_nop 7
    v_cvt_pk_bf16_f32 v48, v32, v33
    v_cvt_pk_bf16_f32 v49, v34, v35
    ds_write_b64 v10, v[48:49] offset:0
    v_cvt_pk_bf16_f32 v50, v36, v37
    v_cvt_pk_bf16_f32 v51, v38, v39
    ds_write_b64 v10, v[50:51] offset:2304
    s_waitcnt vmcnt(3)
    v_mfma_f32_16x16x32_bf16 v[40:43], v[68:71], v[16:19], 0
    v_mfma_f32_16x16x32_bf16 v[44:47], v[68:71], v[20:23], 0
    s_nop 7
    v_cvt_pk_bf16_f32 v52, v40, v41
    v_cvt_pk_bf16_f32 v53, v42, v43
    ds_write_b64 v10, v[52:53] offset:4608
    v_cvt_pk_bf16_f32 v54, v44, v45
    v_cvt_pk_bf16_f32 v55, v46, v47
    ds_write_b64 v10, v[54:55] offset:6912
    s_waitcnt vmcnt(2)
    v_mfma_f32_16x16x32_bf16 v[32:35], v[72:75], v[16:19], 0
    v_mfma_f32_16x16x32_bf16 v[36:39], v[72:75], v[20:23], 0
    s_nop 7
    v_cvt_pk_bf16_f32 v48, v32, v33
    v_cvt_pk_bf16_f32 v49, v34, v35
    ds_write_b64 v10, v[48:49] offset:9216
    v_cvt_pk_bf16_f32 v50, v36, v37
    v_cvt_pk_bf16_f32 v51, v38, v39
    ds_write_b64 v10, v[50:51] offset:11520
    s_waitcnt vmcnt(1)
    v_mfma_f32_16x16x32_bf16 v[40:43], v[76:79], v[16:19], 0
    v_mfma_f32_16x16x32_bf16 v[44:47], v[76:79], v[20:23], 0
    s_nop 7
    v_cvt_pk_bf16_f32 v52, v40, v41
    v_cvt_pk_bf16_f32 v53, v42, v43
    ds_write_b64 v10, v[52:53] offset:13824
    v_cvt_pk_bf16_f32 v54, v44, v45
    v_cvt_pk_bf16_f32 v55, v46, v47
    ds_write_b64 v10, v[54:55] offset:16128
    s_waitcnt vmcnt(0)
    v_mfma_f32_16x16x32_bf16 v[32:35], v[80:83], v[16:19], 0
    v_mfma_f32_16x16x32_bf16 v[36:39], v[80:83], v[20:23], 0
    s_nop 7
    v_cvt_pk_bf16_f32 v48, v32, v33
    v_cvt_pk_bf16_f32 v49, v34, v35
    ds_write_b64 v10, v[48:49] offset:18432
    v_cvt_pk_bf16_f32 v50, v36, v37
    v_cvt_pk_bf16_f32 v51, v38, v39
    ds_write_b64 v10, v[50:51] offset:20736
    v_lshrrev_b32 v11, 3, v0
    v_and_b32 v12, 7, v0
    v_mul_u32_u24 v13, 144, v11
    v_lshl_add_u32 v13, v12, 4, v13
    v_lshlrev_b32 v11, 12, v11
    v_lshl_add_u32 v11, v12, 4, v11
    s_mul_i32 s8, s9, 655360
    s_and_b32 s7, s2, 31
    s_lshl_b32 s7, s7, 7
    s_add_u32 s8, s8, s7
    s_waitcnt lgkmcnt(0)
    s_barrier
    ds_read_b128 v[64:67], v13 offset:0
    ds_read_b128 v[68:71], v13 offset:4608
    ds_read_b128 v[72:75], v13 offset:9216
    ds_read_b128 v[76:79], v13 offset:13824
    ds_read_b128 v[80:83], v13 offset:18432
    s_waitcnt lgkmcnt(4)
    buffer_store_dwordx4 v[64:67], v11, s[68:71], s8 offen sc0 sc1
    s_add_u32 s8, s8, 131072
    s_waitcnt lgkmcnt(3)
    buffer_store_dwordx4 v[68:71], v11, s[68:71], s8 offen sc0 sc1
    s_add_u32 s8, s8, 131072
    s_waitcnt lgkmcnt(2)
    buffer_store_dwordx4 v[72:75], v11, s[68:71], s8 offen sc0 sc1
    s_add_u32 s8, s8, 131072
    s_waitcnt lgkmcnt(1)
    buffer_store_dwordx4 v[76:79], v11, s[68:71], s8 offen sc0 sc1
    s_add_u32 s8, s8, 131072
    s_waitcnt lgkmcnt(0)
    buffer_store_dwordx4 v[80:83], v11, s[68:71], s8 offen sc0 sc1
    s_add_u32 s8, s8, 131072
    s_endpgm
prep_st:
    s_sub_u32 s4, s2, 768
    s_lshl_b32 s4, s4, 4
    v_add_u32 v8, s4, v5
    v_bfe_u32 v12, v8, 1, 2
    v_lshlrev_b32 v12, 12, v12
    v_lshrrev_b32 v13, 3, v8
    v_lshl_add_u32 v12, v13, 4, v12
    v_and_b32 v13, 1, v8
    v_lshl_add_u32 v12, v13, 2, v12
    v_mul_lo_u32 v8, v8, s6
    v_lshl_add_u32 v8, v6, 4, v8
    s_mul_i32 s10, s3, 320
    buffer_load_dwordx4 v[64:67], v8, s[64:67], s10 offen offset:0
    buffer_load_dwordx4 v[68:71], v8, s[64:67], s10 offen offset:64
    buffer_load_dwordx4 v[72:75], v8, s[64:67], s10 offen offset:128
    buffer_load_dwordx4 v[76:79], v8, s[64:67], s10 offen offset:192
    buffer_load_dwordx4 v[80:83], v8, s[64:67], s10 offen offset:256
    s_getpc_b64 s[20:21]
prep_pc:
    s_add_u32 s20, s20, conv2_kernel-prep_pc
    s_addc_u32 s21, s21, 0
    s_bfe_u32 s22, s2, 0x40003
    s_lshl_b32 s22, s22, 12
    v_lshl_add_u32 v99, v0, 4, s22
    v_min_u32 v99, code_end-conv2_kernel-16, v99
    global_load_dwordx4 v[100:103], v99, s[20:21]
    v_mov_b32 v16, 0x3f803f80
    v_mov_b32 v17, 0x3f803f80
    v_mov_b32 v18, 0x3f803f80
    v_mov_b32 v19, 0x3f803f80
    v_and_b32 v10, 3, v5
    v_lshrrev_b32 v11, 2, v5
    v_cmp_eq_u32 s[8:9], 1, v10
    v_cmp_eq_u32 s[10:11], 2, v10
    v_cmp_eq_u32 s[12:13], 3, v10
    v_cmp_eq_u32 vcc, v11, v6
    v_lshlrev_b32 v13, 3, v5
    s_lshl_b32 s5, s3, 7
    v_add_u32 v14, s5, v13
    s_waitcnt vmcnt(5)
    v_mfma_f32_16x16x32_bf16 v[32:35], v[64:67], v[64:67], 0
    v_mfma_f32_16x16x32_bf16 v[36:39], v[16:19], v[64:67], 0
    s_waitcnt vmcnt(4)
    v_mfma_f32_16x16x32_bf16 v[32:35], v[68:71], v[68:71], v[32:35]
    v_mfma_f32_16x16x32_bf16 v[36:39], v[16:19], v[68:71], v[36:39]
    s_waitcnt vmcnt(3)
    v_mfma_f32_16x16x32_bf16 v[32:35], v[72:75], v[72:75], v[32:35]
    v_mfma_f32_16x16x32_bf16 v[36:39], v[16:19], v[72:75], v[36:39]
    s_waitcnt vmcnt(2)
    v_mfma_f32_16x16x32_bf16 v[32:35], v[76:79], v[76:79], v[32:35]
    v_mfma_f32_16x16x32_bf16 v[36:39], v[16:19], v[76:79], v[36:39]
    s_waitcnt vmcnt(1)
    v_mfma_f32_16x16x32_bf16 v[32:35], v[80:83], v[80:83], v[32:35]
    v_mfma_f32_16x16x32_bf16 v[36:39], v[16:19], v[80:83], v[36:39]
    s_nop 7
    s_nop 1
    v_cndmask_b32 v41, v32, v33, s[8:9]
    v_cndmask_b32 v41, v41, v34, s[10:11]
    v_cndmask_b32 v41, v41, v35, s[12:13]
    v_mov_b32 v40, v36
    s_and_saveexec_b64 s[14:15], vcc
    ds_write_b64 v14, v[40:41]
    s_mov_b64 exec, s[14:15]
    s_waitcnt lgkmcnt(0)
    s_barrier
    s_cmp_lg_u32 s3, 0
    s_cbranch_scc1 prep_end
    ds_read_b64 v[40:41], v13 offset:0
    ds_read_b64 v[42:43], v13 offset:128
    ds_read_b64 v[44:45], v13 offset:256
    ds_read_b64 v[46:47], v13 offset:384
    v_cmp_gt_u32 vcc, 16, v1
    s_waitcnt lgkmcnt(0)
    v_add_f32 v40, v40, v42
    v_add_f32 v44, v44, v46
    v_add_f32 v40, v40, v44
    v_add_f32 v41, v41, v43
    v_add_f32 v45, v45, v47
    v_add_f32 v41, v41, v45
    s_and_saveexec_b64 s[14:15], vcc
    buffer_store_dword v40, v12, s[72:75], 0 offen sc0 sc1
    buffer_store_dword v41, v12, s[72:75], 0 offen offset:8 sc0 sc1
    s_endpgm
prep_w:
    s_add_u32 s92, s40, 0
    s_addc_u32 s93, s41, 0
    s_mov_b32 s94, 2097152
    s_mov_b32 s95, 0x00020000
    s_sub_u32 s4, s2, 896
    s_and_b32 s13, s4, 3
    s_lshr_b32 s4, s4, 2
    s_cmp_eq_u32 s4, 0
    s_cbranch_scc1 prep_w_kv
    v_lshrrev_b32 v10, 3, v1
    v_mul_u32_u24 v8, 1280, v10
    v_bfe_u32 v10, v1, 1, 2
    v_bfe_u32 v11, v1, 4, 1
    v_xor_b32 v10, v10, v11
    v_and_b32 v11, 1, v1
    v_lshl_or_b32 v10, v10, 1, v11
    v_lshl_add_u32 v9, v10, 4, v8
    v_xor_b32 v9, 64, v9
    v_lshl_add_u32 v8, v10, 4, v8
    s_and_b32 s7, s3, 1
    s_lshl_b32 s7, s7, 6
    v_xor_b32 v8, s7, v8
    v_xor_b32 v9, s7, v9
    s_mul_i32 s9, s3, 5120
    s_mul_i32 s8, s13, 204800
    s_mul_i32 s7, s3, 51200
    s_add_u32 s8, s8, s7
    s_cmp_ge_u32 s4, 11
    s_cbranch_scc1 prep_w_o
    s_add_u32 s76, s32, 0
    s_addc_u32 s77, s33, 0
    s_mov_b32 s78, 819200
    s_mov_b32 s79, 0x00020000
    s_sub_u32 s4, s4, 1
    s_lshl_b32 s10, s4, 7
    s_add_u32 s8, s8, s10
    s_add_u32 s10, s9, 0
    s_add_u32 s11, s8, 0
    s_mov_b32 m0, s10
    s_nop 0
    buffer_load_dwordx4 v8, s[76:79], s11 offen lds
    s_add_u32 s10, s9, 1024
    s_add_u32 s11, s8, 10240
    s_mov_b32 m0, s10
    s_nop 0
    buffer_load_dwordx4 v9, s[76:79], s11 offen lds
    s_add_u32 s10, s9, 2048
    s_add_u32 s11, s8, 20480
    s_mov_b32 m0, s10
    s_nop 0
    buffer_load_dwordx4 v8, s[76:79], s11 offen lds
    s_add_u32 s10, s9, 3072
    s_add_u32 s11, s8, 30720
    s_mov_b32 m0, s10
    s_nop 0
    buffer_load_dwordx4 v9, s[76:79], s11 offen lds
    s_add_u32 s10, s9, 4096
    s_add_u32 s11, s8, 40960
    s_mov_b32 m0, s10
    s_nop 0
    buffer_load_dwordx4 v8, s[76:79], s11 offen lds
    s_lshl_b32 s5, s4, 2
    s_add_u32 s5, s5, s3
    s_cmp_ge_u32 s5, 37
    s_cselect_b32 s6, 2, 0
    s_add_u32 s5, s5, s6
    s_mul_i32 s6, s5, 20480
    s_mul_i32 s7, s5, 43
    s_lshr_b32 s7, s7, 8
    s_mul_i32 s7, s7, 6
    s_sub_u32 s7, s5, s7
    s_sub_u32 s10, s5, 4
    s_mul_i32 s11, s10, 52
    s_lshr_b32 s11, s11, 8
    s_mul_i32 s11, s11, 5
    s_sub_u32 s10, s10, s11
    s_cmp_lt_u32 s5, 24
    s_cselect_b32 s7, s7, s10
    s_mul_i32 s10, s7, 19456
    s_cmp_lt_u32 s7, 2
    s_cselect_b32 s10, s10, 0
    s_cselect_b32 s12, 2, 1
    s_sub_u32 s6, s6, s10
    s_lshl_b32 s12, s12, 10
    s_branch prep_w_common
prep_w_o:
    s_add_u32 s88, s38, 0
    s_addc_u32 s89, s39, 0
    s_mov_b32 s90, 819200
    s_mov_b32 s91, 0x00020000
    s_sub_u32 s4, s4, 11
    s_lshl_b32 s10, s4, 7
    s_add_u32 s8, s8, s10
    s_add_u32 s10, s9, 0
    s_add_u32 s11, s8, 0
    s_mov_b32 m0, s10
    s_nop 0
    buffer_load_dwordx4 v8, s[88:91], s11 offen lds
    s_add_u32 s10, s9, 1024
    s_add_u32 s11, s8, 10240
    s_mov_b32 m0, s10
    s_nop 0
    buffer_load_dwordx4 v9, s[88:91], s11 offen lds
    s_add_u32 s10, s9, 2048
    s_add_u32 s11, s8, 20480
    s_mov_b32 m0, s10
    s_nop 0
    buffer_load_dwordx4 v8, s[88:91], s11 offen lds
    s_add_u32 s10, s9, 3072
    s_add_u32 s11, s8, 30720
    s_mov_b32 m0, s10
    s_nop 0
    buffer_load_dwordx4 v9, s[88:91], s11 offen lds
    s_add_u32 s10, s9, 4096
    s_add_u32 s11, s8, 40960
    s_mov_b32 m0, s10
    s_nop 0
    buffer_load_dwordx4 v8, s[88:91], s11 offen lds
    s_lshl_b32 s5, s4, 2
    s_add_u32 s5, s5, s3
    s_mul_i32 s6, s5, 52
    s_lshr_b32 s6, s6, 8
    s_mul_i32 s7, s6, 5
    s_sub_u32 s5, s5, s7
    s_and_b32 s7, s6, 1
    s_sub_u32 s5, s5, s7
    s_cmp_lt_i32 s5, 0
    s_cselect_b32 s5, 4, s5
    s_mul_i32 s7, s5, 20
    s_cmp_lt_u32 s5, 2
    s_cselect_b32 s5, s5, s7
    s_cselect_b32 s12, 2, 1
    s_lshl_b32 s12, s12, 10
    s_mul_i32 s6, s6, 102400
    s_lshl_b32 s5, s5, 10
    s_add_u32 s6, s6, s5
    s_add_u32 s6, s6, 1048576
    s_movk_i32 s5, 60
    s_branch prep_w_common
prep_w_kv:
    s_add_u32 s80, s34, 0
    s_addc_u32 s81, s35, 0
    s_mov_b32 s82, 25600
    s_mov_b32 s83, 0x00020000
    s_add_u32 s84, s36, 0
    s_addc_u32 s85, s37, 0
    s_mov_b32 s86, 25600
    s_mov_b32 s87, 0x00020000
    v_mul_u32_u24 v15, 40, v0
    s_mul_i32 s7, s13, 6400
    v_add_u32 v15, s7, v15
    buffer_load_dwordx4 v[16:19], v15, s[80:83], 0 offen
    buffer_load_dwordx4 v[20:23], v15, s[80:83], 0 offen offset:16
    buffer_load_dwordx2 v[24:25], v15, s[80:83], 0 offen offset:32
    buffer_load_dwordx4 v[28:31], v15, s[84:87], 0 offen
    buffer_load_dwordx4 v[32:35], v15, s[84:87], 0 offen offset:16
    buffer_load_dwordx2 v[36:37], v15, s[84:87], 0 offen offset:32
    v_mov_b32 v40, 0
    v_mov_b32 v41, 0
    v_mov_b32 v42, 0
    v_mov_b32 v43, 0
    v_mov_b32 v26, 0
    v_mov_b32 v27, 0
    v_mov_b32 v38, 0
    v_mov_b32 v39, 0
    v_bfe_u32 v48, v0, 1, 1
    v_bfe_u32 v49, v0, 3, 1
    v_lshl_or_b32 v48, v49, 1, v48
    v_lshlrev_b32 v49, 7, v0
    v_xor_b32 v50, 0, v48
    v_lshl_add_u32 v50, v50, 5, v49
    v_xor_b32 v51, 1, v48
    v_lshl_add_u32 v51, v51, 5, v49
    v_xor_b32 v52, 2, v48
    v_lshl_add_u32 v52, v52, 5, v49
    v_xor_b32 v53, 3, v48
    v_lshl_add_u32 v53, v53, 5, v49
    v_cmp_gt_u32 vcc, 160, v0
    s_and_saveexec_b64 s[14:15], vcc
    s_waitcnt vmcnt(0)
    ds_write_b128 v50, v[16:19]
    ds_write_b128 v50, v[20:23] offset:16
    ds_write_b128 v51, v[24:27]
    ds_write_b128 v51, v[40:43] offset:16
    ds_write_b128 v52, v[28:31]
    ds_write_b128 v52, v[32:35] offset:16
    ds_write_b128 v53, v[36:39]
    ds_write_b128 v53, v[40:43] offset:16
    s_mov_b64 exec, s[14:15]
    s_lshr_b32 s5, s3, 1
    s_mul_i32 s5, s5, 5
    s_and_b32 s6, s3, 1
    s_add_u32 s5, s5, s6
    s_add_u32 s5, s5, 37
    s_mul_i32 s6, s5, 20480
    s_movk_i32 s12, 1024
prep_w_common:
    v_bfe_u32 v10, v1, 2, 2
    v_bfe_u32 v11, v1, 4, 2
    v_lshl_add_u32 v12, v11, 3, v10
    v_lshlrev_b32 v12, 7, v12
    v_lshrrev_b32 v10, 1, v10
    v_and_b32 v11, 1, v11
    v_lshl_or_b32 v10, v11, 1, v10
    v_xor_b32 v10, s3, v10
    v_lshl_add_u32 v12, v10, 5, v12
    v_and_b32 v11, 3, v1
    v_lshl_add_u32 v12, v11, 3, v12
    v_lshlrev_b32 v7, 4, v1
    s_mul_i32 s7, s13, 5
    s_mul_i32 s7, s7, s12
    s_add_u32 s6, s6, s7
    v_mov_b32 v16, 0x3f803f80
    v_mov_b32 v17, 0x3f803f80
    v_mov_b32 v18, 0x3f803f80
    v_mov_b32 v19, 0x3f803f80
    v_lshlrev_b32 v10, 4, v6
    s_lshl_b32 s5, s5, 6
    s_lshl_b32 s8, s13, 12
    s_add_u32 s5, s5, s8
    s_add_u32 s5, s5, 987136
    v_cmp_eq_u32 vcc, 0, v5
    s_waitcnt vmcnt(0) lgkmcnt(0)
    s_barrier
    ds_read_b64_tr_b16 v[64:65], v12 offset:0
    ds_read_b64_tr_b16 v[66:67], v12 offset:512
    ds_read_b64_tr_b16 v[68:69], v12 offset:4096
    ds_read_b64_tr_b16 v[70:71], v12 offset:4608
    ds_read_b64_tr_b16 v[72:73], v12 offset:8192
    ds_read_b64_tr_b16 v[74:75], v12 offset:8704
    ds_read_b64_tr_b16 v[76:77], v12 offset:12288
    ds_read_b64_tr_b16 v[78:79], v12 offset:12800
    ds_read_b64_tr_b16 v[80:81], v12 offset:16384
    ds_read_b64_tr_b16 v[82:83], v12 offset:16896
    s_waitcnt lgkmcnt(8)
    buffer_store_dwordx4 v[64:67], v7, s[92:95], s6 offen sc0 sc1
    s_add_u32 s6, s6, s12
    v_mfma_f32_16x16x32_bf16 v[20:23], v[64:67], v[16:19], 0
    s_waitcnt lgkmcnt(6)
    buffer_store_dwordx4 v[68:71], v7, s[92:95], s6 offen sc0 sc1
    s_add_u32 s6, s6, s12
    v_mfma_f32_16x16x32_bf16 v[20:23], v[68:71], v[16:19], v[20:23]
    s_waitcnt lgkmcnt(4)
    buffer_store_dwordx4 v[72:75], v7, s[92:95], s6 offen sc0 sc1
    s_add_u32 s6, s6, s12
    v_mfma_f32_16x16x32_bf16 v[20:23], v[72:75], v[16:19], v[20:23]
    s_waitcnt lgkmcnt(2)
    buffer_store_dwordx4 v[76:79], v7, s[92:95], s6 offen sc0 sc1
    s_add_u32 s6, s6, s12
    v_mfma_f32_16x16x32_bf16 v[20:23], v[76:79], v[16:19], v[20:23]
    s_waitcnt lgkmcnt(0)
    buffer_store_dwordx4 v[80:83], v7, s[92:95], s6 offen sc0 sc1
    s_add_u32 s6, s6, s12
    v_mfma_f32_16x16x32_bf16 v[20:23], v[80:83], v[16:19], v[20:23]
    s_and_saveexec_b64 s[14:15], vcc
    s_nop 6
    buffer_store_dwordx4 v[20:23], v10, s[92:95], s5 offen sc0 sc1
prep_end:
    s_endpgm
.section .rodata,"a"
.p2align 6
.amdhsa_kernel prep_kernel
  .amdhsa_next_free_vgpr 120
  .amdhsa_next_free_sgpr 102
  .amdhsa_accum_offset 120
  .amdhsa_group_segment_fixed_size 0
  .amdhsa_kernarg_size 120
  .amdhsa_user_sgpr_count 2
  .amdhsa_user_sgpr_kernarg_segment_ptr 1
  .amdhsa_system_sgpr_workgroup_id_x 1
.end_amdhsa_kernel
.text
.globl conv2_kernel
.p2align 8
.type conv2_kernel,@function
conv2_kernel:
    s_mov_b32 s83, 17825792
    s_branch conv_kernel_body
.globl conv_kernel
.p2align 8
.type conv_kernel,@function
conv_kernel:
    s_mov_b32 s83, 0
conv_kernel_body:
    s_cmp_ge_u32 s2, 256
    s_cbranch_scc1 conv_end
    s_load_dwordx16 s[16:31], s[0:1], 0
    s_load_dwordx8 s[32:39], s[0:1], 64
    s_load_dwordx2 s[40:41], s[0:1], 112
    s_load_dwordx2 s[42:43], s[0:1], 96
    v_lshrrev_b32 v2, 6, v0
    v_and_b32 v1, 63, v0
    v_and_b32 v3, 31, v0
    v_readfirstlane_b32 s3, v2
    v_bfe_u32 v4, v0, 5, 1
    s_lshr_b32 s11, s2, 1
    s_and_b32 s5, s2, 1
    s_mul_i32 s11, s11, 5
    s_lshl_b32 s6, s5, 1
    s_add_u32 s11, s11, s6
    s_mov_b32 s6, 0x86A94251
    s_cmp_eq_u32 s5, 0
    s_cmov_b32 s6, 0xA5982140
    s_lshl_b32 s7, s3, 2
    s_lshr_b32 s6, s6, s7
    s_and_b32 s5, s6, 3
    s_add_u32 s4, s11, s5
    v_lshlrev_b32 v6, 4, v1
    s_mul_i32 s8, s4, 4608
    s_mul_i32 s9, s5, 30496
    s_add_u32 s10, s9, 7680
    v_lshlrev_b32 v13, 4, v0
    s_cmp_ge_u32 s3, 4
    s_cbranch_scc1 conv_up
    v_lshrrev_b32 v15, 2, v0
    v_mul_u32_u24 v15, 80, v15
    v_and_b32 v16, 3, v0
    v_lshl_add_u32 v56, v16, 4, v15
    v_add_u32 v14, 26368, v13
    v_and_b32 v61, 3, v3
    v_sub_u32 v61, 3, v61
    v_mul_u32_u24 v61, 2368, v61
    v_add_u32 v61, s10, v61
    v_mul_u32_u24 v60, 80, v3
    v_lshl_add_u32 v60, v4, 4, v60
    v_add_u32 v60, s9, v60
    v_lshrrev_b32 v62, 2, v3
    v_lshlrev_b32 v62, 3, v62
    v_sub_u32 v62, 56, v62
    v_add_u32 v61, v61, v62
    v_lshl_add_u32 v61, v4, 4, v61
    v_mul_u32_u24 v19, 144, v3
    v_lshl_add_u32 v19, v4, 4, v19
    v_add_u32 v63, s9, v19
    v_lshrrev_b32 v7, 2, v3
    v_mul_u32_u24 v7, 163840, v7
    v_and_b32 v62, 2, v3
    v_lshl_add_u32 v7, v62, 3, v7
    v_cmp_eq_u32 s[74:75], 0, v62
    v_and_b32 v62, 1, v3
    v_lshl_add_u32 v7, v62, 6, v7
    v_lshl_add_u32 v7, v4, 5, v7
    s_lshl_b32 s70, s4, 7
    s_add_u32 s71, s70, 1310720
    s_movk_i32 s61, 4096
    s_movk_i32 s62, 8192
    s_movk_i32 s63, 12288
    s_mov_b32 s64, 0x3acccccd
    s_mov_b32 s65, 0x3acccccd
    s_mov_b32 s66, 0x3727c5ac
    s_mov_b32 s67, 0x3727c5ac
    s_lshl_b32 s7, s11, 12
    s_waitcnt lgkmcnt(0)
    s_add_u32 s56, s40, 11534336
    s_addc_u32 s57, s41, 0
    s_mov_b32 s58, 16384
    s_mov_b32 s59, 0x00020000
    buffer_load_dwordx4 v[64:67], v13, s[56:59], 0 offen
    buffer_load_dwordx4 v[68:71], v13, s[56:59], s61 offen
    buffer_load_dwordx4 v[72:75], v13, s[56:59], s62 offen
    buffer_load_dwordx4 v[76:79], v13, s[56:59], s63 offen
    s_add_u32 s46, s83, 23068672
    s_add_u32 s44, s40, s46
    s_addc_u32 s45, s41, 0
    s_mov_b32 s46, 2621440
    s_mov_b32 s47, 0x00020000
    buffer_load_dwordx4 v[112:115], v13, s[44:47], s7 offen
    s_add_u32 s7, s7, 4096
    buffer_load_dwordx4 v[116:119], v13, s[44:47], s7 offen
    s_add_u32 s7, s7, 4096
    buffer_load_dwordx4 v[120:123], v13, s[44:47], s7 offen
    s_add_u32 s50, s83, 8388608
    s_add_u32 s48, s40, s50
    s_addc_u32 s49, s41, 0
    s_mov_b32 s50, 2621440
    s_mov_b32 s51, 0x00020000
    s_waitcnt vmcnt(5)
    v_pk_mul_f32 v[64:65], v[64:65], s[64:65]
    v_pk_mul_f32 v[68:69], v[68:69], s[64:65]
    v_pk_mul_f32 v[66:67], v[66:67], s[64:65]
    v_pk_mul_f32 v[70:71], v[70:71], s[64:65]
    v_pk_fma_f32 v[66:67], v[64:65], v[64:65], v[66:67] neg_lo:[1,0,0] neg_hi:[1,0,0]
    v_pk_fma_f32 v[70:71], v[68:69], v[68:69], v[70:71] neg_lo:[1,0,0] neg_hi:[1,0,0]
    v_cvt_pk_bf16_f32 v80, v66, v67
    v_cvt_pk_bf16_f32 v81, v70, v71
    v_pk_max_i16 v80, v80, 0
    v_pk_max_i16 v81, v81, 0
    v_lshlrev_b32 v66, 16, v80
    v_lshlrev_b32 v70, 16, v81
    v_and_b32 v67, 0xffff0000, v80
    v_and_b32 v71, 0xffff0000, v81
    v_pk_add_f32 v[66:67], v[66:67], s[66:67]
    v_pk_add_f32 v[70:71], v[70:71], s[66:67]
    v_cvt_pk_bf16_f32 v80, v66, v67
    v_cvt_pk_bf16_f32 v81, v70, v71
    v_lshlrev_b32 v66, 16, v80
    v_lshlrev_b32 v70, 16, v81
    v_and_b32 v67, 0xffff0000, v80
    v_and_b32 v71, 0xffff0000, v81
    v_sqrt_f32 v66, v66
    v_sqrt_f32 v70, v70
    v_sqrt_f32 v67, v67
    v_sqrt_f32 v71, v71
    v_cvt_pk_bf16_f32 v84, v64, v65
    v_cvt_pk_bf16_f32 v85, v68, v69
    v_lshlrev_b32 v64, 16, v84
    v_lshlrev_b32 v68, 16, v85
    v_and_b32 v65, 0xffff0000, v84
    v_and_b32 v69, 0xffff0000, v85
    v_cvt_pk_bf16_f32 v80, v66, v67
    v_cvt_pk_bf16_f32 v81, v70, v71
    v_lshlrev_b32 v66, 16, v80
    v_lshlrev_b32 v70, 16, v81
    v_and_b32 v67, 0xffff0000, v80
    v_and_b32 v71, 0xffff0000, v81
    v_rcp_f32 v66, v66
    v_rcp_f32 v70, v70
    v_rcp_f32 v67, v67
    v_rcp_f32 v71, v71
    s_nop 0
    v_pk_mul_f32 v[64:65], v[64:65], v[66:67] neg_lo:[1,0] neg_hi:[1,0]
    v_pk_mul_f32 v[68:69], v[68:69], v[70:71] neg_lo:[1,0] neg_hi:[1,0]
    s_waitcnt vmcnt(3)
    v_pk_mul_f32 v[72:73], v[72:73], s[64:65]
    v_pk_mul_f32 v[76:77], v[76:77], s[64:65]
    v_pk_mul_f32 v[74:75], v[74:75], s[64:65]
    v_pk_mul_f32 v[78:79], v[78:79], s[64:65]
    v_pk_fma_f32 v[74:75], v[72:73], v[72:73], v[74:75] neg_lo:[1,0,0] neg_hi:[1,0,0]
    v_pk_fma_f32 v[78:79], v[76:77], v[76:77], v[78:79] neg_lo:[1,0,0] neg_hi:[1,0,0]
    v_cvt_pk_bf16_f32 v82, v74, v75
    v_cvt_pk_bf16_f32 v83, v78, v79
    v_pk_max_i16 v82, v82, 0
    v_pk_max_i16 v83, v83, 0
    v_lshlrev_b32 v74, 16, v82
    v_lshlrev_b32 v78, 16, v83
    v_and_b32 v75, 0xffff0000, v82
    v_and_b32 v79, 0xffff0000, v83
    v_pk_add_f32 v[74:75], v[74:75], s[66:67]
    v_pk_add_f32 v[78:79], v[78:79], s[66:67]
    v_cvt_pk_bf16_f32 v82, v74, v75
    v_cvt_pk_bf16_f32 v83, v78, v79
    v_lshlrev_b32 v74, 16, v82
    v_lshlrev_b32 v78, 16, v83
    v_and_b32 v75, 0xffff0000, v82
    v_and_b32 v79, 0xffff0000, v83
    v_sqrt_f32 v74, v74
    v_sqrt_f32 v78, v78
    v_sqrt_f32 v75, v75
    v_sqrt_f32 v79, v79
    v_cvt_pk_bf16_f32 v86, v72, v73
    v_cvt_pk_bf16_f32 v87, v76, v77
    v_lshlrev_b32 v72, 16, v86
    v_lshlrev_b32 v76, 16, v87
    v_and_b32 v73, 0xffff0000, v86
    v_and_b32 v77, 0xffff0000, v87
    v_cvt_pk_bf16_f32 v82, v74, v75
    v_cvt_pk_bf16_f32 v83, v78, v79
    v_lshlrev_b32 v74, 16, v82
    v_lshlrev_b32 v78, 16, v83
    v_and_b32 v75, 0xffff0000, v82
    v_and_b32 v79, 0xffff0000, v83
    v_rcp_f32 v74, v74
    v_rcp_f32 v78, v78
    v_rcp_f32 v75, v75
    v_rcp_f32 v79, v79
    s_nop 0
    v_pk_mul_f32 v[72:73], v[72:73], v[74:75] neg_lo:[1,0] neg_hi:[1,0]
    v_pk_mul_f32 v[76:77], v[76:77], v[78:79] neg_lo:[1,0] neg_hi:[1,0]
    s_waitcnt vmcnt(2)
    ds_write_b128 v14, v[112:115] offset:0
    v_lshlrev_b32 v48, 16, v112
    v_and_b32 v49, 0xffff0000, v112
    v_lshlrev_b32 v50, 16, v113
    v_and_b32 v51, 0xffff0000, v113
    v_lshlrev_b32 v52, 16, v114
    v_and_b32 v53, 0xffff0000, v114
    v_lshlrev_b32 v54, 16, v115
    v_and_b32 v55, 0xffff0000, v115
    v_pk_fma_f32 v[48:49], v[48:49], v[66:67], v[64:65]
    v_pk_fma_f32 v[50:51], v[50:51], v[70:71], v[68:69]
    v_pk_fma_f32 v[52:53], v[52:53], v[74:75], v[72:73]
    v_pk_fma_f32 v[54:55], v[54:55], v[78:79], v[76:77]
    v_cvt_pk_bf16_f32 v40, v48, v49
    v_cvt_pk_bf16_f32 v41, v50, v51
    v_cvt_pk_bf16_f32 v42, v52, v53
    v_cvt_pk_bf16_f32 v43, v54, v55
    ds_write_b128 v56, v[40:43] offset:2480
    s_waitcnt vmcnt(1)
    ds_write_b128 v14, v[116:119] offset:30496
    v_lshlrev_b32 v48, 16, v116
    v_and_b32 v49, 0xffff0000, v116
    v_lshlrev_b32 v50, 16, v117
    v_and_b32 v51, 0xffff0000, v117
    v_lshlrev_b32 v52, 16, v118
    v_and_b32 v53, 0xffff0000, v118
    v_lshlrev_b32 v54, 16, v119
    v_and_b32 v55, 0xffff0000, v119
    v_pk_fma_f32 v[48:49], v[48:49], v[66:67], v[64:65]
    v_pk_fma_f32 v[50:51], v[50:51], v[70:71], v[68:69]
    v_pk_fma_f32 v[52:53], v[52:53], v[74:75], v[72:73]
    v_pk_fma_f32 v[54:55], v[54:55], v[78:79], v[76:77]
    v_cvt_pk_bf16_f32 v44, v48, v49
    v_cvt_pk_bf16_f32 v45, v50, v51
    v_cvt_pk_bf16_f32 v46, v52, v53
    v_cvt_pk_bf16_f32 v47, v54, v55
    ds_write_b128 v56, v[44:47] offset:32976
    s_waitcnt vmcnt(0)
    ds_write_b128 v14, v[120:123] offset:60992
    v_lshlrev_b32 v48, 16, v120
    v_and_b32 v49, 0xffff0000, v120
    v_lshlrev_b32 v50, 16, v121
    v_and_b32 v51, 0xffff0000, v121
    v_lshlrev_b32 v52, 16, v122
    v_and_b32 v53, 0xffff0000, v122
    v_lshlrev_b32 v54, 16, v123
    v_and_b32 v55, 0xffff0000, v123
    v_pk_fma_f32 v[48:49], v[48:49], v[66:67], v[64:65]
    v_pk_fma_f32 v[50:51], v[50:51], v[70:71], v[68:69]
    v_pk_fma_f32 v[52:53], v[52:53], v[74:75], v[72:73]
    v_pk_fma_f32 v[54:55], v[54:55], v[78:79], v[76:77]
    v_cvt_pk_bf16_f32 v40, v48, v49
    v_cvt_pk_bf16_f32 v41, v50, v51
    v_cvt_pk_bf16_f32 v42, v52, v53
    v_cvt_pk_bf16_f32 v43, v54, v55
    ds_write_b128 v56, v[40:43] offset:63472
    s_waitcnt lgkmcnt(0)
conv_xm:
    s_and_b32 s7, s3, 3
    s_bitcmp1_b32 s6, 2
    s_barrier
    s_cbranch_scc1 conv_x1
    s_cmp_eq_u32 s7, 2
    ds_read_b64 v[64:65], v61 offset:0
    ds_read_b64 v[66:67], v61 offset:8
    ds_read_b128 v[68:71], v60 offset:1200
    ds_read_b64 v[72:73], v61 offset:32
    ds_read_b64 v[74:75], v61 offset:40
    ds_read_b128 v[76:79], v60 offset:1232
    ds_read_b64 v[80:81], v61 offset:64
    ds_read_b64 v[82:83], v61 offset:72
    ds_read_b128 v[84:87], v60 offset:1280
    ds_read_b64 v[88:89], v61 offset:96
    ds_read_b64 v[90:91], v61 offset:104
    ds_read_b128 v[92:95], v60 offset:1312
    ds_read_b64 v[96:97], v61 offset:128
    ds_read_b64 v[98:99], v61 offset:136
    ds_read_b128 v[100:103], v60 offset:1360
    s_waitcnt lgkmcnt(12)
    v_mfma_f32_32x32x16_bf16 v[128:143], v[64:67], v[68:71], 0
    ds_read_b64 v[64:65], v61 offset:160
    ds_read_b64 v[66:67], v61 offset:168
    ds_read_b128 v[68:71], v60 offset:1392
    s_waitcnt lgkmcnt(12)
    v_mfma_f32_32x32x16_bf16 v[128:143], v[72:75], v[76:79], v[128:143]
    ds_read_b64 v[72:73], v61 offset:192
    ds_read_b64 v[74:75], v61 offset:200
    ds_read_b128 v[76:79], v60 offset:1440
    s_waitcnt lgkmcnt(12)
    v_mfma_f32_32x32x16_bf16 v[128:143], v[80:83], v[84:87], v[128:143]
    ds_read_b64 v[80:81], v61 offset:224
    ds_read_b64 v[82:83], v61 offset:232
    ds_read_b128 v[84:87], v60 offset:1472
    s_waitcnt lgkmcnt(12)
    v_mfma_f32_32x32x16_bf16 v[128:143], v[88:91], v[92:95], v[128:143]
    ds_read_b64 v[88:89], v61 offset:256
    ds_read_b64 v[90:91], v61 offset:264
    ds_read_b128 v[92:95], v60 offset:1520
    s_waitcnt lgkmcnt(12)
    v_mfma_f32_32x32x16_bf16 v[128:143], v[96:99], v[100:103], v[128:143]
    ds_read_b64 v[96:97], v61 offset:288
    ds_read_b64 v[98:99], v61 offset:296
    ds_read_b128 v[100:103], v60 offset:1552
    s_waitcnt lgkmcnt(12)
    v_mfma_f32_32x32x16_bf16 v[128:143], v[64:67], v[68:71], v[128:143]
    ds_read_b64 v[64:65], v61 offset:320
    ds_read_b64 v[66:67], v61 offset:328
    ds_read_b128 v[68:71], v60 offset:1600
    s_waitcnt lgkmcnt(12)
    v_mfma_f32_32x32x16_bf16 v[128:143], v[72:75], v[76:79], v[128:143]
    ds_read_b64 v[72:73], v61 offset:352
    ds_read_b64 v[74:75], v61 offset:360
    ds_read_b128 v[76:79], v60 offset:1632
    s_waitcnt lgkmcnt(12)
    v_mfma_f32_32x32x16_bf16 v[128:143], v[80:83], v[84:87], v[128:143]
    ds_read_b64 v[80:81], v61 offset:384
    ds_read_b64 v[82:83], v61 offset:392
    ds_read_b128 v[84:87], v60 offset:1680
    s_waitcnt lgkmcnt(12)
    v_mfma_f32_32x32x16_bf16 v[128:143], v[88:91], v[92:95], v[128:143]
    ds_read_b64 v[88:89], v61 offset:416
    ds_read_b64 v[90:91], v61 offset:424
    ds_read_b128 v[92:95], v60 offset:1712
    s_waitcnt lgkmcnt(12)
    v_mfma_f32_32x32x16_bf16 v[128:143], v[96:99], v[100:103], v[128:143]
    ds_read_b64 v[96:97], v61 offset:448
    ds_read_b64 v[98:99], v61 offset:456
    ds_read_b128 v[100:103], v60 offset:1760
    s_waitcnt lgkmcnt(12)
    v_mfma_f32_32x32x16_bf16 v[128:143], v[64:67], v[68:71], v[128:143]
    ds_read_b64 v[64:65], v61 offset:480
    ds_read_b64 v[66:67], v61 offset:488
    ds_read_b128 v[68:71], v60 offset:1792
    s_waitcnt lgkmcnt(12)
    v_mfma_f32_32x32x16_bf16 v[128:143], v[72:75], v[76:79], v[128:143]
    ds_read_b64 v[72:73], v61 offset:512
    ds_read_b64 v[74:75], v61 offset:520
    ds_read_b128 v[76:79], v60 offset:1840
    s_waitcnt lgkmcnt(12)
    v_mfma_f32_32x32x16_bf16 v[128:143], v[80:83], v[84:87], v[128:143]
    ds_read_b64 v[80:81], v61 offset:544
    ds_read_b64 v[82:83], v61 offset:552
    ds_read_b128 v[84:87], v60 offset:1872
    s_waitcnt lgkmcnt(12)
    v_mfma_f32_32x32x16_bf16 v[128:143], v[88:91], v[92:95], v[128:143]
    ds_read_b64 v[88:89], v61 offset:576
    ds_read_b64 v[90:91], v61 offset:584
    ds_read_b128 v[92:95], v60 offset:1920
    s_waitcnt lgkmcnt(12)
    v_mfma_f32_32x32x16_bf16 v[128:143], v[96:99], v[100:103], v[128:143]
    ds_read_b64 v[96:97], v61 offset:608
    ds_read_b64 v[98:99], v61 offset:616
    ds_read_b128 v[100:103], v60 offset:1952
    s_waitcnt lgkmcnt(12)
    v_mfma_f32_32x32x16_bf16 v[128:143], v[64:67], v[68:71], v[128:143]
    ds_read_b64 v[64:65], v61 offset:640
    ds_read_b64 v[66:67], v61 offset:648
    ds_read_b128 v[68:71], v60 offset:2000
    s_waitcnt lgkmcnt(12)
    v_mfma_f32_32x32x16_bf16 v[128:143], v[72:75], v[76:79], v[128:143]
    ds_read_b64 v[72:73], v61 offset:672
    ds_read_b64 v[74:75], v61 offset:680
    ds_read_b128 v[76:79], v60 offset:2032
    s_waitcnt lgkmcnt(12)
    v_mfma_f32_32x32x16_bf16 v[128:143], v[80:83], v[84:87], v[128:143]
    ds_read_b64 v[80:81], v61 offset:704
    ds_read_b64 v[82:83], v61 offset:712
    ds_read_b128 v[84:87], v60 offset:2080
    s_waitcnt lgkmcnt(12)
    v_mfma_f32_32x32x16_bf16 v[128:143], v[88:91], v[92:95], v[128:143]
    ds_read_b64 v[88:89], v61 offset:736
    ds_read_b64 v[90:91], v61 offset:744
    ds_read_b128 v[92:95], v60 offset:2112
    s_waitcnt lgkmcnt(12)
    v_mfma_f32_32x32x16_bf16 v[128:143], v[96:99], v[100:103], v[128:143]
    ds_read_b64 v[96:97], v61 offset:768
    ds_read_b64 v[98:99], v61 offset:776
    ds_read_b128 v[100:103], v60 offset:2160
    s_waitcnt lgkmcnt(12)
    v_mfma_f32_32x32x16_bf16 v[128:143], v[64:67], v[68:71], v[128:143]
    ds_read_b64 v[64:65], v61 offset:800
    ds_read_b64 v[66:67], v61 offset:808
    ds_read_b128 v[68:71], v60 offset:2192
    s_waitcnt lgkmcnt(12)
    v_mfma_f32_32x32x16_bf16 v[128:143], v[72:75], v[76:79], v[128:143]
    ds_read_b64 v[72:73], v61 offset:832
    ds_read_b64 v[74:75], v61 offset:840
    ds_read_b128 v[76:79], v60 offset:2240
    s_waitcnt lgkmcnt(12)
    v_mfma_f32_32x32x16_bf16 v[128:143], v[80:83], v[84:87], v[128:143]
    ds_read_b64 v[80:81], v61 offset:864
    ds_read_b64 v[82:83], v61 offset:872
    ds_read_b128 v[84:87], v60 offset:2272
    s_waitcnt lgkmcnt(12)
    v_mfma_f32_32x32x16_bf16 v[128:143], v[88:91], v[92:95], v[128:143]
    ds_read_b64 v[88:89], v61 offset:896
    ds_read_b64 v[90:91], v61 offset:904
    ds_read_b128 v[92:95], v60 offset:2320
    s_waitcnt lgkmcnt(12)
    v_mfma_f32_32x32x16_bf16 v[128:143], v[96:99], v[100:103], v[128:143]
    ds_read_b64 v[96:97], v61 offset:928
    ds_read_b64 v[98:99], v61 offset:936
    ds_read_b128 v[100:103], v60 offset:2352
    s_waitcnt lgkmcnt(12)
    v_mfma_f32_32x32x16_bf16 v[128:143], v[64:67], v[68:71], v[128:143]
    ds_read_b64 v[64:65], v61 offset:1280
    ds_read_b64 v[66:67], v61 offset:1288
    ds_read_b128 v[68:71], v60 offset:0
    s_waitcnt lgkmcnt(12)
    v_mfma_f32_32x32x16_bf16 v[128:143], v[72:75], v[76:79], v[128:143]
    s_cbranch_scc1 conv_nb00
    s_barrier
conv_nb00:
    ds_read_b64 v[72:73], v61 offset:960
    ds_read_b64 v[74:75], v61 offset:968
    ds_read_b128 v[76:79], v60 offset:2400
    s_waitcnt lgkmcnt(12)
    v_mfma_f32_32x32x16_bf16 v[128:143], v[80:83], v[84:87], v[128:143]
    ds_read_b64 v[80:81], v61 offset:992
    ds_read_b64 v[82:83], v61 offset:1000
    ds_read_b128 v[84:87], v60 offset:2432
    s_waitcnt lgkmcnt(12)
    v_mfma_f32_32x32x16_bf16 v[128:143], v[88:91], v[92:95], v[128:143]
    ds_read_b64 v[88:89], v61 offset:1024
    ds_read_b64 v[90:91], v61 offset:1032
    ds_read_b128 v[92:95], v60 offset:2480
    s_waitcnt lgkmcnt(12)
    v_mfma_f32_32x32x16_bf16 v[128:143], v[96:99], v[100:103], v[128:143]
    s_cbranch_scc0 conv_nb01
    s_barrier
conv_nb01:
    ds_read_b64 v[96:97], v61 offset:1056
    ds_read_b64 v[98:99], v61 offset:1064
    ds_read_b128 v[100:103], v60 offset:2512
    s_waitcnt lgkmcnt(12)
    v_mfma_f32_32x32x16_bf16 v[128:143], v[64:67], v[68:71], v[128:143]
    ds_read_b128 v[160:163], v63 offset:17152
    s_waitcnt lgkmcnt(10)
    v_mfma_f32_32x32x16_bf16 v[128:143], v[72:75], v[76:79], v[128:143]
    ds_read_b128 v[164:167], v63 offset:17184
    s_waitcnt lgkmcnt(8)
    v_mfma_f32_32x32x16_bf16 v[128:143], v[80:83], v[84:87], v[128:143]
    ds_read_b128 v[168:171], v63 offset:17216
    s_waitcnt lgkmcnt(6)
    v_mfma_f32_32x32x16_bf16 v[128:143], v[88:91], v[92:95], v[128:143]
    ds_read_b128 v[172:175], v63 offset:17248
    s_waitcnt lgkmcnt(4)
    v_mfma_f32_32x32x16_bf16 v[128:143], v[96:99], v[100:103], v[128:143]
    s_nop 7
    s_nop 7
    s_waitcnt lgkmcnt(3)
    v_add_f32 v160, v160, v128
    v_add_f32 v161, v161, v129
    v_add_f32 v162, v162, v130
    v_add_f32 v163, v163, v131
    v_cvt_pk_bf16_f32 v40, v160, v161
    v_cvt_pk_bf16_f32 v41, v162, v163
    s_waitcnt lgkmcnt(2)
    v_add_f32 v164, v164, v132
    v_add_f32 v165, v165, v133
    v_add_f32 v166, v166, v134
    v_add_f32 v167, v167, v135
    v_cvt_pk_bf16_f32 v44, v164, v165
    v_cvt_pk_bf16_f32 v45, v166, v167
    s_waitcnt lgkmcnt(1)
    v_add_f32 v168, v168, v136
    v_add_f32 v169, v169, v137
    v_add_f32 v170, v170, v138
    v_add_f32 v171, v171, v139
    v_cvt_pk_bf16_f32 v42, v168, v169
    v_cvt_pk_bf16_f32 v43, v170, v171
    s_waitcnt lgkmcnt(0)
    v_add_f32 v172, v172, v140
    v_add_f32 v173, v173, v141
    v_add_f32 v174, v174, v142
    v_add_f32 v175, v175, v143
    v_cvt_pk_bf16_f32 v46, v172, v173
    v_cvt_pk_bf16_f32 v47, v174, v175
    s_nop 0
    v_permlane32_swap_b32 v40, v42
    v_permlane32_swap_b32 v41, v43
    v_permlane32_swap_b32 v44, v46
    v_permlane32_swap_b32 v45, v47
    s_mov_b64 vcc, s[74:75]
    s_add_u32 s76, s70, 81920
    s_nop 0
    v_cndmask_b32_dpp v48, v44, v40, vcc quad_perm:[2,3,0,1] row_mask:0xf bank_mask:0xf
    v_cndmask_b32_dpp v49, v45, v41, vcc quad_perm:[2,3,0,1] row_mask:0xf bank_mask:0xf
    v_cndmask_b32_dpp v50, v46, v42, vcc quad_perm:[2,3,0,1] row_mask:0xf bank_mask:0xf
    v_cndmask_b32_dpp v51, v47, v43, vcc quad_perm:[2,3,0,1] row_mask:0xf bank_mask:0xf
    s_not_b64 vcc, vcc
    buffer_store_dwordx4 v[48:51], v7, s[48:51], s70 offen sc0 sc1
    v_cndmask_b32_dpp v52, v40, v44, vcc quad_perm:[2,3,0,1] row_mask:0xf bank_mask:0xf
    v_cndmask_b32_dpp v53, v41, v45, vcc quad_perm:[2,3,0,1] row_mask:0xf bank_mask:0xf
    v_cndmask_b32_dpp v54, v42, v46, vcc quad_perm:[2,3,0,1] row_mask:0xf bank_mask:0xf
    v_cndmask_b32_dpp v55, v43, v47, vcc quad_perm:[2,3,0,1] row_mask:0xf bank_mask:0xf
    buffer_store_dwordx4 v[52:55], v7, s[48:51], s76 offen sc0 sc1
    s_endpgm
conv_x1:
    s_cmp_eq_u32 s7, 2
    ds_read_b64 v[64:65], v61 offset:0
    ds_read_b64 v[66:67], v61 offset:8
    ds_read_b128 v[68:71], v60 offset:3760
    ds_read_b64 v[72:73], v61 offset:32
    ds_read_b64 v[74:75], v61 offset:40
    ds_read_b128 v[76:79], v60 offset:3792
    ds_read_b64 v[80:81], v61 offset:64
    ds_read_b64 v[82:83], v61 offset:72
    ds_read_b128 v[84:87], v60 offset:3840
    ds_read_b64 v[88:89], v61 offset:96
    ds_read_b64 v[90:91], v61 offset:104
    ds_read_b128 v[92:95], v60 offset:3872
    ds_read_b64 v[96:97], v61 offset:128
    ds_read_b64 v[98:99], v61 offset:136
    ds_read_b128 v[100:103], v60 offset:3920
    s_waitcnt lgkmcnt(12)
    v_mfma_f32_32x32x16_bf16 v[128:143], v[64:67], v[68:71], 0
    ds_read_b64 v[64:65], v61 offset:160
    ds_read_b64 v[66:67], v61 offset:168
    ds_read_b128 v[68:71], v60 offset:3952
    s_waitcnt lgkmcnt(12)
    v_mfma_f32_32x32x16_bf16 v[128:143], v[72:75], v[76:79], v[128:143]
    ds_read_b64 v[72:73], v61 offset:192
    ds_read_b64 v[74:75], v61 offset:200
    ds_read_b128 v[76:79], v60 offset:4000
    s_waitcnt lgkmcnt(12)
    v_mfma_f32_32x32x16_bf16 v[128:143], v[80:83], v[84:87], v[128:143]
    ds_read_b64 v[80:81], v61 offset:224
    ds_read_b64 v[82:83], v61 offset:232
    ds_read_b128 v[84:87], v60 offset:4032
    s_waitcnt lgkmcnt(12)
    v_mfma_f32_32x32x16_bf16 v[128:143], v[88:91], v[92:95], v[128:143]
    ds_read_b64 v[88:89], v61 offset:256
    ds_read_b64 v[90:91], v61 offset:264
    ds_read_b128 v[92:95], v60 offset:4080
    s_waitcnt lgkmcnt(12)
    v_mfma_f32_32x32x16_bf16 v[128:143], v[96:99], v[100:103], v[128:143]
    ds_read_b64 v[96:97], v61 offset:288
    ds_read_b64 v[98:99], v61 offset:296
    ds_read_b128 v[100:103], v60 offset:4112
    s_waitcnt lgkmcnt(12)
    v_mfma_f32_32x32x16_bf16 v[128:143], v[64:67], v[68:71], v[128:143]
    ds_read_b64 v[64:65], v61 offset:320
    ds_read_b64 v[66:67], v61 offset:328
    ds_read_b128 v[68:71], v60 offset:4160
    s_waitcnt lgkmcnt(12)
    v_mfma_f32_32x32x16_bf16 v[128:143], v[72:75], v[76:79], v[128:143]
    ds_read_b64 v[72:73], v61 offset:352
    ds_read_b64 v[74:75], v61 offset:360
    ds_read_b128 v[76:79], v60 offset:4192
    s_waitcnt lgkmcnt(12)
    v_mfma_f32_32x32x16_bf16 v[128:143], v[80:83], v[84:87], v[128:143]
    ds_read_b64 v[80:81], v61 offset:384
    ds_read_b64 v[82:83], v61 offset:392
    ds_read_b128 v[84:87], v60 offset:4240
    s_waitcnt lgkmcnt(12)
    v_mfma_f32_32x32x16_bf16 v[128:143], v[88:91], v[92:95], v[128:143]
    ds_read_b64 v[88:89], v61 offset:416
    ds_read_b64 v[90:91], v61 offset:424
    ds_read_b128 v[92:95], v60 offset:4272
    s_waitcnt lgkmcnt(12)
    v_mfma_f32_32x32x16_bf16 v[128:143], v[96:99], v[100:103], v[128:143]
    ds_read_b64 v[96:97], v61 offset:448
    ds_read_b64 v[98:99], v61 offset:456
    ds_read_b128 v[100:103], v60 offset:4320
    s_waitcnt lgkmcnt(12)
    v_mfma_f32_32x32x16_bf16 v[128:143], v[64:67], v[68:71], v[128:143]
    ds_read_b64 v[64:65], v61 offset:480
    ds_read_b64 v[66:67], v61 offset:488
    ds_read_b128 v[68:71], v60 offset:4352
    s_waitcnt lgkmcnt(12)
    v_mfma_f32_32x32x16_bf16 v[128:143], v[72:75], v[76:79], v[128:143]
    ds_read_b64 v[72:73], v61 offset:512
    ds_read_b64 v[74:75], v61 offset:520
    ds_read_b128 v[76:79], v60 offset:4400
    s_waitcnt lgkmcnt(12)
    v_mfma_f32_32x32x16_bf16 v[128:143], v[80:83], v[84:87], v[128:143]
    ds_read_b64 v[80:81], v61 offset:544
    ds_read_b64 v[82:83], v61 offset:552
    ds_read_b128 v[84:87], v60 offset:4432
    s_waitcnt lgkmcnt(12)
    v_mfma_f32_32x32x16_bf16 v[128:143], v[88:91], v[92:95], v[128:143]
    ds_read_b64 v[88:89], v61 offset:576
    ds_read_b64 v[90:91], v61 offset:584
    ds_read_b128 v[92:95], v60 offset:4480
    s_waitcnt lgkmcnt(12)
    v_mfma_f32_32x32x16_bf16 v[128:143], v[96:99], v[100:103], v[128:143]
    ds_read_b64 v[96:97], v61 offset:608
    ds_read_b64 v[98:99], v61 offset:616
    ds_read_b128 v[100:103], v60 offset:4512
    s_waitcnt lgkmcnt(12)
    v_mfma_f32_32x32x16_bf16 v[128:143], v[64:67], v[68:71], v[128:143]
    ds_read_b64 v[64:65], v61 offset:640
    ds_read_b64 v[66:67], v61 offset:648
    ds_read_b128 v[68:71], v60 offset:4560
    s_waitcnt lgkmcnt(12)
    v_mfma_f32_32x32x16_bf16 v[128:143], v[72:75], v[76:79], v[128:143]
    ds_read_b64 v[72:73], v61 offset:672
    ds_read_b64 v[74:75], v61 offset:680
    ds_read_b128 v[76:79], v60 offset:4592
    s_waitcnt lgkmcnt(12)
    v_mfma_f32_32x32x16_bf16 v[128:143], v[80:83], v[84:87], v[128:143]
    ds_read_b64 v[80:81], v61 offset:704
    ds_read_b64 v[82:83], v61 offset:712
    ds_read_b128 v[84:87], v60 offset:4640
    s_waitcnt lgkmcnt(12)
    v_mfma_f32_32x32x16_bf16 v[128:143], v[88:91], v[92:95], v[128:143]
    ds_read_b64 v[88:89], v61 offset:736
    ds_read_b64 v[90:91], v61 offset:744
    ds_read_b128 v[92:95], v60 offset:4672
    s_waitcnt lgkmcnt(12)
    v_mfma_f32_32x32x16_bf16 v[128:143], v[96:99], v[100:103], v[128:143]
    ds_read_b64 v[96:97], v61 offset:768
    ds_read_b64 v[98:99], v61 offset:776
    ds_read_b128 v[100:103], v60 offset:4720
    s_waitcnt lgkmcnt(12)
    v_mfma_f32_32x32x16_bf16 v[128:143], v[64:67], v[68:71], v[128:143]
    ds_read_b64 v[64:65], v61 offset:800
    ds_read_b64 v[66:67], v61 offset:808
    ds_read_b128 v[68:71], v60 offset:4752
    s_waitcnt lgkmcnt(12)
    v_mfma_f32_32x32x16_bf16 v[128:143], v[72:75], v[76:79], v[128:143]
    ds_read_b64 v[72:73], v61 offset:832
    ds_read_b64 v[74:75], v61 offset:840
    ds_read_b128 v[76:79], v60 offset:4800
    s_waitcnt lgkmcnt(12)
    v_mfma_f32_32x32x16_bf16 v[128:143], v[80:83], v[84:87], v[128:143]
    ds_read_b64 v[80:81], v61 offset:864
    ds_read_b64 v[82:83], v61 offset:872
    ds_read_b128 v[84:87], v60 offset:4832
    s_waitcnt lgkmcnt(12)
    v_mfma_f32_32x32x16_bf16 v[128:143], v[88:91], v[92:95], v[128:143]
    ds_read_b64 v[88:89], v61 offset:896
    ds_read_b64 v[90:91], v61 offset:904
    ds_read_b128 v[92:95], v60 offset:4880
    s_waitcnt lgkmcnt(12)
    v_mfma_f32_32x32x16_bf16 v[128:143], v[96:99], v[100:103], v[128:143]
    ds_read_b64 v[96:97], v61 offset:928
    ds_read_b64 v[98:99], v61 offset:936
    ds_read_b128 v[100:103], v60 offset:4912
    s_waitcnt lgkmcnt(12)
    v_mfma_f32_32x32x16_bf16 v[128:143], v[64:67], v[68:71], v[128:143]
    ds_read_b64 v[64:65], v61 offset:1184
    ds_read_b64 v[66:67], v61 offset:1192
    ds_read_b128 v[68:71], v60 offset:2432
    s_waitcnt lgkmcnt(12)
    v_mfma_f32_32x32x16_bf16 v[128:143], v[72:75], v[76:79], v[128:143]
    s_cbranch_scc1 conv_nb10
    s_barrier
conv_nb10:
    ds_read_b64 v[72:73], v61 offset:1216
    ds_read_b64 v[74:75], v61 offset:1224
    ds_read_b128 v[76:79], v60 offset:2480
    s_waitcnt lgkmcnt(12)
    v_mfma_f32_32x32x16_bf16 v[128:143], v[80:83], v[84:87], v[128:143]
    ds_read_b64 v[80:81], v61 offset:1248
    ds_read_b64 v[82:83], v61 offset:1256
    ds_read_b128 v[84:87], v60 offset:2512
    s_waitcnt lgkmcnt(12)
    v_mfma_f32_32x32x16_bf16 v[128:143], v[88:91], v[92:95], v[128:143]
    ds_read_b64 v[88:89], v61 offset:1280
    ds_read_b64 v[90:91], v61 offset:1288
    ds_read_b128 v[92:95], v60 offset:2560
    s_waitcnt lgkmcnt(12)
    v_mfma_f32_32x32x16_bf16 v[128:143], v[96:99], v[100:103], v[128:143]
    ds_read_b64 v[96:97], v61 offset:960
    ds_read_b64 v[98:99], v61 offset:968
    ds_read_b128 v[100:103], v60 offset:4960
    s_waitcnt lgkmcnt(12)
    v_mfma_f32_32x32x16_bf16 v[128:143], v[64:67], v[68:71], v[128:143]
    ds_read_b64 v[64:65], v61 offset:992
    ds_read_b64 v[66:67], v61 offset:1000
    ds_read_b128 v[68:71], v60 offset:4992
    s_waitcnt lgkmcnt(12)
    v_mfma_f32_32x32x16_bf16 v[128:143], v[72:75], v[76:79], v[128:143]
    ds_read_b64 v[72:73], v61 offset:1024
    ds_read_b64 v[74:75], v61 offset:1032
    ds_read_b128 v[76:79], v60 offset:5040
    s_waitcnt lgkmcnt(12)
    v_mfma_f32_32x32x16_bf16 v[128:143], v[80:83], v[84:87], v[128:143]
    s_cbranch_scc0 conv_nb11
    s_barrier
conv_nb11:
    ds_read_b64 v[80:81], v61 offset:1056
    ds_read_b64 v[82:83], v61 offset:1064
    ds_read_b128 v[84:87], v60 offset:5072
    s_waitcnt lgkmcnt(12)
    v_mfma_f32_32x32x16_bf16 v[128:143], v[88:91], v[92:95], v[128:143]
    ds_read_b128 v[160:163], v63 offset:21760
    s_waitcnt lgkmcnt(10)
    v_mfma_f32_32x32x16_bf16 v[128:143], v[96:99], v[100:103], v[128:143]
    ds_read_b128 v[164:167], v63 offset:21792
    s_waitcnt lgkmcnt(8)
    v_mfma_f32_32x32x16_bf16 v[128:143], v[64:67], v[68:71], v[128:143]
    ds_read_b128 v[168:171], v63 offset:21824
    s_waitcnt lgkmcnt(6)
    v_mfma_f32_32x32x16_bf16 v[128:143], v[72:75], v[76:79], v[128:143]
    ds_read_b128 v[172:175], v63 offset:21856
    s_waitcnt lgkmcnt(4)
    v_mfma_f32_32x32x16_bf16 v[128:143], v[80:83], v[84:87], v[128:143]
    s_nop 7
    s_nop 7
    s_waitcnt lgkmcnt(3)
    v_add_f32 v160, v160, v128
    v_add_f32 v161, v161, v129
    v_add_f32 v162, v162, v130
    v_add_f32 v163, v163, v131
    v_cvt_pk_bf16_f32 v40, v160, v161
    v_cvt_pk_bf16_f32 v41, v162, v163
    s_waitcnt lgkmcnt(2)
    v_add_f32 v164, v164, v132
    v_add_f32 v165, v165, v133
    v_add_f32 v166, v166, v134
    v_add_f32 v167, v167, v135
    v_cvt_pk_bf16_f32 v44, v164, v165
    v_cvt_pk_bf16_f32 v45, v166, v167
    s_waitcnt lgkmcnt(1)
    v_add_f32 v168, v168, v136
    v_add_f32 v169, v169, v137
    v_add_f32 v170, v170, v138
    v_add_f32 v171, v171, v139
    v_cvt_pk_bf16_f32 v42, v168, v169
    v_cvt_pk_bf16_f32 v43, v170, v171
    s_waitcnt lgkmcnt(0)
    v_add_f32 v172, v172, v140
    v_add_f32 v173, v173, v141
    v_add_f32 v174, v174, v142
    v_add_f32 v175, v175, v143
    v_cvt_pk_bf16_f32 v46, v172, v173
    v_cvt_pk_bf16_f32 v47, v174, v175
    s_nop 0
    v_permlane32_swap_b32 v40, v42
    v_permlane32_swap_b32 v41, v43
    v_permlane32_swap_b32 v44, v46
    v_permlane32_swap_b32 v45, v47
    s_mov_b64 vcc, s[74:75]
    s_add_u32 s76, s71, 81920
    s_nop 0
    v_cndmask_b32_dpp v48, v44, v40, vcc quad_perm:[2,3,0,1] row_mask:0xf bank_mask:0xf
    v_cndmask_b32_dpp v49, v45, v41, vcc quad_perm:[2,3,0,1] row_mask:0xf bank_mask:0xf
    v_cndmask_b32_dpp v50, v46, v42, vcc quad_perm:[2,3,0,1] row_mask:0xf bank_mask:0xf
    v_cndmask_b32_dpp v51, v47, v43, vcc quad_perm:[2,3,0,1] row_mask:0xf bank_mask:0xf
    s_not_b64 vcc, vcc
    buffer_store_dwordx4 v[48:51], v7, s[48:51], s71 offen sc0 sc1
    v_cndmask_b32_dpp v52, v40, v44, vcc quad_perm:[2,3,0,1] row_mask:0xf bank_mask:0xf
    v_cndmask_b32_dpp v53, v41, v45, vcc quad_perm:[2,3,0,1] row_mask:0xf bank_mask:0xf
    v_cndmask_b32_dpp v54, v42, v46, vcc quad_perm:[2,3,0,1] row_mask:0xf bank_mask:0xf
    v_cndmask_b32_dpp v55, v43, v47, vcc quad_perm:[2,3,0,1] row_mask:0xf bank_mask:0xf
    buffer_store_dwordx4 v[52:55], v7, s[48:51], s76 offen sc0 sc1
    s_endpgm
conv_up:
    s_bitcmp1_b32 s6, 3
    s_cbranch_scc1 conv_y
    s_and_b32 s7, s3, 3
    s_mul_i32 s72, s7, 2368
    s_add_u32 s72, s72, 7680
    s_mul_i32 s73, s11, 4608
    s_and_b32 s12, s7, 1
    s_mul_i32 s12, s12, 2304
    s_add_u32 s73, s73, s12
    s_lshr_b32 s12, s7, 1
    s_lshl_b32 s12, s12, 2
    s_add_u32 s73, s73, s12
    s_waitcnt lgkmcnt(0)
    s_add_u32 s52, s40, 2097152
    s_addc_u32 s53, s41, 0
    s_mov_b32 s54, 2949120
    s_mov_b32 s55, 0x00020000
    s_add_u32 s12, s72, 0
    s_add_u32 s13, s73, 0
    s_mov_b32 m0, s12
    s_nop 0
    buffer_load_dwordx4 v6, s[52:55], s13 offen lds
    s_add_u32 s12, s72, 30496
    s_add_u32 s13, s73, 4608
    s_mov_b32 m0, s12
    s_nop 0
    buffer_load_dwordx4 v6, s[52:55], s13 offen lds
    s_add_u32 s12, s72, 60992
    s_add_u32 s13, s73, 9216
    s_mov_b32 m0, s12
    s_nop 0
    buffer_load_dwordx4 v6, s[52:55], s13 offen lds
    v_cmp_gt_u32 s[14:15], 24, v1
    s_mov_b64 exec, s[14:15]
    s_add_u32 s12, s72, 1024
    s_add_u32 s13, s73, 1024
    s_mov_b32 m0, s12
    s_nop 0
    buffer_load_dwordx4 v6, s[52:55], s13 offen lds
    s_add_u32 s12, s72, 31520
    s_add_u32 s13, s73, 5632
    s_mov_b32 m0, s12
    s_nop 0
    buffer_load_dwordx4 v6, s[52:55], s13 offen lds
    s_add_u32 s12, s72, 62016
    s_add_u32 s13, s73, 10240
    s_mov_b32 m0, s12
    s_nop 0
    buffer_load_dwordx4 v6, s[52:55], s13 offen lds
    s_mov_b64 exec, -1
    v_and_b32 v61, 3, v3
    v_sub_u32 v61, 3, v61
    v_mul_u32_u24 v61, 2368, v61
    v_add_u32 v61, s10, v61
    v_mul_u32_u24 v60, 80, v3
    v_lshl_add_u32 v60, v4, 4, v60
    v_add_u32 v60, s9, v60
    v_lshrrev_b32 v62, 2, v3
    v_lshlrev_b32 v62, 3, v62
    v_sub_u32 v62, 56, v62
    v_add_u32 v61, v61, v62
    v_lshl_add_u32 v61, v4, 4, v61
    v_mul_u32_u24 v19, 144, v3
    v_lshl_add_u32 v19, v4, 4, v19
    v_add_u32 v63, s9, v19
    v_lshrrev_b32 v7, 2, v3
    v_mul_u32_u24 v7, 163840, v7
    v_and_b32 v62, 2, v3
    v_lshl_add_u32 v7, v62, 3, v7
    v_cmp_eq_u32 s[74:75], 0, v62
    v_and_b32 v62, 1, v3
    v_lshl_add_u32 v7, v62, 6, v7
    v_lshl_add_u32 v7, v4, 5, v7
    s_lshl_b32 s70, s4, 7
    s_add_u32 s71, s70, 1310720
    s_add_u32 s50, s83, 8388608
    s_add_u32 s48, s40, s50
    s_addc_u32 s49, s41, 0
    s_mov_b32 s50, 2621440
    s_mov_b32 s51, 0x00020000
    s_cmp_ge_u32 s2, 3
    s_cbranch_scc1 conv_ncs
    s_add_u32 s92, s40, 983040
    s_addc_u32 s93, s41, 0
    s_mov_b32 s94, 20480
    s_mov_b32 s95, 0x00020000
    s_lshl_b32 s12, s2, 6
    v_add_u32 v8, s12, v1
    v_cmp_gt_u32 vcc, 176, v8
    v_lshlrev_b32 v8, 4, v8
    s_movk_i32 s12, 4096
    buffer_load_dwordx4 v[24:27], v8, s[92:95], s12 offen
    s_add_u32 s12, s12, 4096
    buffer_load_dwordx4 v[28:31], v8, s[92:95], s12 offen
    s_add_u32 s12, s12, 4096
    buffer_load_dwordx4 v[32:35], v8, s[92:95], s12 offen
    s_add_u32 s12, s12, 4096
    buffer_load_dwordx4 v[36:39], v8, s[92:95], s12 offen
    s_waitcnt vmcnt(0)
    v_add_f32 v24, v24, v28
    v_add_f32 v32, v32, v36
    v_add_f32 v24, v24, v32
    v_add_f32 v25, v25, v29
    v_add_f32 v33, v33, v37
    v_add_f32 v25, v25, v33
    v_add_f32 v26, v26, v30
    v_add_f32 v34, v34, v38
    v_add_f32 v26, v26, v34
    v_add_f32 v27, v27, v31
    v_add_f32 v35, v35, v39
    v_add_f32 v27, v27, v35
    s_and_saveexec_b64 s[14:15], vcc
    buffer_store_dwordx4 v[24:27], v8, s[92:95], 0 offen sc0 sc1
    s_mov_b64 exec, -1
    s_branch conv_xm
conv_ncs:
    s_waitcnt vmcnt(0)
    s_branch conv_xm
conv_y:
    v_and_b32 v17, 15, v1
    v_lshrrev_b32 v18, 4, v1
    v_lshlrev_b32 v126, 5, v17
    v_lshl_add_u32 v126, v18, 3, v126
    s_and_b32 s7, s3, 3
    s_mul_i32 s72, s7, 2368
    s_add_u32 s72, s72, 7680
    s_mul_i32 s73, s11, 4608
    s_and_b32 s12, s7, 1
    s_mul_i32 s12, s12, 2304
    s_add_u32 s73, s73, s12
    s_lshr_b32 s12, s7, 1
    s_lshl_b32 s12, s12, 2
    s_add_u32 s73, s73, s12
    s_waitcnt lgkmcnt(0)
    s_add_u32 s52, s40, 2097152
    s_addc_u32 s53, s41, 0
    s_mov_b32 s54, 2949120
    s_mov_b32 s55, 0x00020000
    s_add_u32 s12, s72, 0
    s_add_u32 s13, s73, 0
    s_mov_b32 m0, s12
    s_nop 0
    buffer_load_dwordx4 v6, s[52:55], s13 offen lds
    s_add_u32 s12, s72, 30496
    s_add_u32 s13, s73, 4608
    s_mov_b32 m0, s12
    s_nop 0
    buffer_load_dwordx4 v6, s[52:55], s13 offen lds
    s_add_u32 s12, s72, 60992
    s_add_u32 s13, s73, 9216
    s_mov_b32 m0, s12
    s_nop 0
    buffer_load_dwordx4 v6, s[52:55], s13 offen lds
    v_cmp_gt_u32 s[14:15], 24, v1
    s_mov_b64 exec, s[14:15]
    s_add_u32 s12, s72, 1024
    s_add_u32 s13, s73, 1024
    s_mov_b32 m0, s12
    s_nop 0
    buffer_load_dwordx4 v6, s[52:55], s13 offen lds
    s_add_u32 s12, s72, 31520
    s_add_u32 s13, s73, 5632
    s_mov_b32 m0, s12
    s_nop 0
    buffer_load_dwordx4 v6, s[52:55], s13 offen lds
    s_add_u32 s12, s72, 62016
    s_add_u32 s13, s73, 10240
    s_mov_b32 m0, s12
    s_nop 0
    buffer_load_dwordx4 v6, s[52:55], s13 offen lds
    s_mov_b64 exec, -1
    v_add_u32 v126, s9, v126
    v_cmp_gt_u32 s[14:15], 52, v1
    s_mov_b64 exec, s[14:15]
    s_add_u32 s12, s10, 1408
    s_add_u32 s13, s8, 1408
    s_mov_b32 m0, s12
    s_nop 0
    buffer_load_dwordx4 v6, s[52:55], s13 offen lds
    s_add_u32 s12, s10, 3776
    s_add_u32 s13, s8, 3712
    s_mov_b32 m0, s12
    s_nop 0
    buffer_load_dwordx4 v6, s[52:55], s13 offen lds
    s_add_u32 s12, s10, 6144
    s_add_u32 s13, s8, 1412
    s_mov_b32 m0, s12
    s_nop 0
    buffer_load_dwordx4 v6, s[52:55], s13 offen lds
    s_add_u32 s12, s10, 8512
    s_add_u32 s13, s8, 3716
    s_mov_b32 m0, s12
    s_nop 0
    buffer_load_dwordx4 v6, s[52:55], s13 offen lds
    s_mov_b64 exec, -1
    v_add_u32 v57, s9, v6
    v_mov_b32 v8, 0
    v_mov_b32 v9, 0
    v_mov_b32 v10, 0
    v_mov_b32 v11, 0
    ds_write_b128 v57, v[8:11] offset:0
    ds_write_b128 v57, v[8:11] offset:1024
    ds_write_b128 v57, v[8:11] offset:1456
    v_and_b32 v61, 3, v3
    v_sub_u32 v61, 3, v61
    v_mul_u32_u24 v61, 2368, v61
    v_add_u32 v61, s10, v61
    v_and_b32 v17, 15, v1
    v_lshrrev_b32 v18, 4, v1
    v_lshlrev_b32 v19, 5, v17
    v_lshl_add_u32 v19, v18, 3, v19
    v_lshrrev_b32 v20, 1, v17
    v_mul_u32_u24 v20, 144, v20
    v_and_b32 v21, 1, v17
    v_lshl_add_u32 v20, v21, 6, v20
    v_lshl_add_u32 v20, v18, 4, v20
    v_add_u32 v125, s9, v20
    v_lshrrev_b32 v62, 2, v17
    v_lshlrev_b32 v62, 3, v62
    v_sub_u32 v62, 24, v62
    v_lshl_add_u32 v62, v18, 3, v62
    v_add_u32 v124, v61, v62
    v_lshlrev_b32 v19, 4, v17
    v_lshl_add_u32 v19, v18, 3, v19
    v_add_u32 v21, 8, v19
    v_lshrrev_b32 v20, 5, v21
    v_mul_u32_u24 v20, 80, v20
    v_and_b32 v21, 31, v21
    v_lshl_add_u32 v20, v21, 1, v20
    v_add_u32 v120, s9, v20
    v_add_u32 v21, 16, v19
    v_lshrrev_b32 v20, 5, v21
    v_mul_u32_u24 v20, 80, v20
    v_and_b32 v21, 31, v21
    v_lshl_add_u32 v20, v21, 1, v20
    v_add_u32 v121, s9, v20
    v_lshlrev_b32 v19, 3, v18
    v_sub_u32 v19, v17, v19
    v_add_u32 v19, 24, v19
    v_mov_b32 v21, 0
    v_mov_b32 v20, 1984
    v_lshlrev_b64 v[52:53], v19, v[20:21]
    v_lshrrev_b32 v52, 24, v52
    v_lshl_or_b32 v52, v52, 15, v52
    v_and_b32 v224, 65537, v52
    v_and_b32 v225, 262148, v52
    v_and_b32 v226, 1048592, v52
    v_and_b32 v227, 4194368, v52
    v_mul_u32_u24 v224, 16256, v224
    v_mul_u32_u24 v225, 4064, v225
    v_mul_u32_u24 v226, 1016, v226
    v_mul_u32_u24 v227, 254, v227
    v_mov_b32 v20, 1984
    v_lshlrev_b64 v[52:53], v19, v[20:21]
    v_lshrrev_b32 v52, 24, v52
    v_lshl_or_b32 v52, v52, 15, v52
    v_and_b32 v228, 65537, v52
    v_and_b32 v229, 262148, v52
    v_and_b32 v230, 1048592, v52
    v_and_b32 v231, 4194368, v52
    v_mul_u32_u24 v228, 16256, v228
    v_mul_u32_u24 v229, 4064, v229
    v_mul_u32_u24 v230, 1016, v230
    v_mul_u32_u24 v231, 254, v231
    v_mov_b32 v20, 14336
    v_lshlrev_b64 v[52:53], v19, v[20:21]
    v_lshrrev_b32 v52, 24, v52
    v_lshl_or_b32 v52, v52, 15, v52
    v_and_b32 v232, 65537, v52
    v_and_b32 v233, 262148, v52
    v_and_b32 v234, 1048592, v52
    v_and_b32 v235, 4194368, v52
    v_mul_u32_u24 v232, 16256, v232
    v_mul_u32_u24 v233, 4064, v233
    v_mul_u32_u24 v234, 1016, v234
    v_mul_u32_u24 v235, 254, v235
    v_mov_b32 v20, 14336
    v_lshlrev_b64 v[52:53], v19, v[20:21]
    v_lshrrev_b32 v52, 24, v52
    v_lshl_or_b32 v52, v52, 15, v52
    v_and_b32 v236, 65537, v52
    v_and_b32 v237, 262148, v52
    v_and_b32 v238, 1048592, v52
    v_and_b32 v239, 4194368, v52
    v_mul_u32_u24 v236, 16256, v236
    v_mul_u32_u24 v237, 4064, v237
    v_mul_u32_u24 v238, 1016, v238
    v_mul_u32_u24 v239, 254, v239
    v_mov_b32 v20, 8176
    v_lshlrev_b64 v[52:53], v19, v[20:21]
    v_lshrrev_b32 v52, 24, v52
    v_lshl_or_b32 v52, v52, 15, v52
    v_and_b32 v240, 65537, v52
    v_and_b32 v241, 262148, v52
    v_and_b32 v242, 1048592, v52
    v_and_b32 v243, 4194368, v52
    v_mul_u32_u24 v240, 16256, v240
    v_mul_u32_u24 v241, 4064, v241
    v_mul_u32_u24 v242, 1016, v242
    v_mul_u32_u24 v243, 254, v243
    v_mov_b32 v20, 4064
    v_lshlrev_b64 v[52:53], v19, v[20:21]
    v_lshrrev_b32 v52, 24, v52
    v_lshl_or_b32 v52, v52, 15, v52
    v_and_b32 v244, 65537, v52
    v_and_b32 v245, 262148, v52
    v_and_b32 v246, 1048592, v52
    v_and_b32 v247, 4194368, v52
    v_mul_u32_u24 v244, 16256, v244
    v_mul_u32_u24 v245, 4064, v245
    v_mul_u32_u24 v246, 1016, v246
    v_mul_u32_u24 v247, 254, v247
    s_waitcnt vmcnt(0)
    ds_read_b64 v[128:129], v124 offset:2016
    ds_read_b64 v[130:131], v124 offset:2176
    ds_read_b64 v[132:133], v124 offset:1984
    ds_read_b64 v[134:135], v124 offset:2144
    ds_read_b64 v[136:137], v124 offset:1952
    ds_read_b64 v[138:139], v124 offset:2112
    ds_read_b64 v[140:141], v124 offset:1920
    ds_read_b64 v[142:143], v124 offset:2080
    ds_read_b64 v[144:145], v124 offset:1472
    ds_read_b64 v[146:147], v124 offset:1600
    ds_read_b64 v[148:149], v124 offset:1728
    ds_read_b64 v[150:151], v124 offset:1856
    ds_read_b64 v[152:153], v124 offset:1440
    ds_read_b64 v[154:155], v124 offset:1568
    ds_read_b64 v[156:157], v124 offset:1696
    ds_read_b64 v[158:159], v124 offset:1824
    ds_read_b64 v[160:161], v124 offset:1408
    ds_read_b64 v[162:163], v124 offset:1536
    ds_read_b64 v[164:165], v124 offset:1664
    ds_read_b64 v[166:167], v124 offset:1792
    s_waitcnt lgkmcnt(0)
    s_barrier
    s_setprio 1
    ds_read_b128 v[64:67], v120 offset:2400
    ds_read_b128 v[68:71], v121 offset:2400
    ds_read_b64 v[28:29], v126 offset:26368
    ds_read_b64 v[30:31], v126 offset:26880
    ds_read_b64 v[32:33], v126 offset:27392
    ds_read_b64 v[34:35], v126 offset:27904
    ds_read_b64 v[36:37], v126 offset:28416
    ds_read_b64 v[38:39], v126 offset:28928
    ds_read_b64 v[40:41], v126 offset:29440
    ds_read_b64 v[42:43], v126 offset:29952
    ds_read_b128 v[72:75], v120 offset:3040
    ds_read_b128 v[76:79], v121 offset:3040
    ds_read_b128 v[80:83], v120 offset:3680
    ds_read_b128 v[84:87], v121 offset:3680
    s_waitcnt lgkmcnt(12)
    v_mfma_f32_16x16x32_bf16 v[168:171], v[64:67], v[224:227], 0
    v_mfma_f32_16x16x32_bf16 v[172:175], v[68:71], v[228:231], 0
    v_mfma_f32_16x16x32_bf16 v[176:179], v[68:71], v[232:235], 0
    v_mfma_f32_16x16x32_bf16 v[180:183], v[64:67], v[236:239], 0
    v_mfma_f32_16x16x32_bf16 v[184:187], v[64:67], v[240:243], 0
    v_mfma_f32_16x16x32_bf16 v[188:191], v[68:71], v[244:247], 0
    s_waitcnt lgkmcnt(4)
    v_lshlrev_b32 v192, 16, v28
    v_and_b32 v193, 0xffff0000, v28
    v_lshlrev_b32 v194, 16, v29
    v_and_b32 v195, 0xffff0000, v29
    v_lshlrev_b32 v196, 16, v30
    v_and_b32 v197, 0xffff0000, v30
    v_lshlrev_b32 v198, 16, v31
    v_and_b32 v199, 0xffff0000, v31
    v_lshlrev_b32 v200, 16, v32
    v_and_b32 v201, 0xffff0000, v32
    v_lshlrev_b32 v202, 16, v33
    v_and_b32 v203, 0xffff0000, v33
    v_lshlrev_b32 v204, 16, v34
    v_and_b32 v205, 0xffff0000, v34
    v_lshlrev_b32 v206, 16, v35
    v_and_b32 v207, 0xffff0000, v35
    v_lshlrev_b32 v208, 16, v36
    v_and_b32 v209, 0xffff0000, v36
    v_lshlrev_b32 v210, 16, v37
    v_and_b32 v211, 0xffff0000, v37
    v_lshlrev_b32 v212, 16, v38
    v_and_b32 v213, 0xffff0000, v38
    v_lshlrev_b32 v214, 16, v39
    v_and_b32 v215, 0xffff0000, v39
    v_lshlrev_b32 v216, 16, v40
    v_and_b32 v217, 0xffff0000, v40
    v_lshlrev_b32 v218, 16, v41
    v_and_b32 v219, 0xffff0000, v41
    v_lshlrev_b32 v220, 16, v42
    v_and_b32 v221, 0xffff0000, v42
    v_lshlrev_b32 v222, 16, v43
    v_and_b32 v223, 0xffff0000, v43
    ds_write_b128 v125, v[192:195] offset:17152
    ds_write_b128 v125, v[196:199] offset:18304
    v_cvt_pk_bf16_f32 v16, v168, v169
    v_cvt_pk_bf16_f32 v17, v170, v171
    v_cvt_pk_bf16_f32 v18, v172, v173
    v_cvt_pk_bf16_f32 v19, v174, v175
    v_cvt_pk_bf16_f32 v20, v176, v177
    v_cvt_pk_bf16_f32 v21, v178, v179
    v_cvt_pk_bf16_f32 v22, v180, v181
    v_cvt_pk_bf16_f32 v23, v182, v183
    v_cvt_pk_bf16_f32 v24, v184, v185
    v_cvt_pk_bf16_f32 v25, v186, v187
    v_cvt_pk_bf16_f32 v26, v188, v189
    v_cvt_pk_bf16_f32 v27, v190, v191
    ds_read_b128 v[88:91], v120 offset:4320
    ds_read_b128 v[92:95], v121 offset:4320
    s_waitcnt lgkmcnt(6)
    v_mfma_f32_16x16x32_bf16 v[168:171], v[72:75], v[224:227], 0
    v_mfma_f32_16x16x32_bf16 v[172:175], v[76:79], v[228:231], 0
    v_mfma_f32_16x16x32_bf16 v[176:179], v[76:79], v[232:235], 0
    v_mfma_f32_16x16x32_bf16 v[180:183], v[72:75], v[236:239], 0
    v_mfma_f32_16x16x32_bf16 v[184:187], v[72:75], v[240:243], 0
    v_mfma_f32_16x16x32_bf16 v[188:191], v[76:79], v[244:247], 0
    v_mfma_f32_16x16x32_bf16 v[208:211], v[24:27], v[128:131], v[208:211]
    v_mfma_f32_16x16x32_bf16 v[212:215], v[24:27], v[132:135], v[212:215]
    s_nop 2
    v_cvt_pk_bf16_f32 v28, v168, v169
    v_cvt_pk_bf16_f32 v29, v170, v171
    v_mfma_f32_16x16x32_bf16 v[216:219], v[24:27], v[136:139], v[216:219]
    v_cvt_pk_bf16_f32 v30, v172, v173
    v_cvt_pk_bf16_f32 v31, v174, v175
    v_mfma_f32_16x16x32_bf16 v[220:223], v[24:27], v[140:143], v[220:223]
    v_cvt_pk_bf16_f32 v32, v176, v177
    v_cvt_pk_bf16_f32 v33, v178, v179
    v_mfma_f32_16x16x32_bf16 v[200:203], v[16:19], v[144:147], v[200:203]
    v_cvt_pk_bf16_f32 v34, v180, v181
    v_cvt_pk_bf16_f32 v35, v182, v183
    v_mfma_f32_16x16x32_bf16 v[204:207], v[16:19], v[152:155], v[204:207]
    v_cvt_pk_bf16_f32 v36, v184, v185
    v_cvt_pk_bf16_f32 v37, v186, v187
    v_mfma_f32_16x16x32_bf16 v[208:211], v[16:19], v[160:163], v[208:211]
    v_cvt_pk_bf16_f32 v38, v188, v189
    v_cvt_pk_bf16_f32 v39, v190, v191
    v_mfma_f32_16x16x32_bf16 v[200:203], v[20:23], v[148:151], v[200:203]
    v_mfma_f32_16x16x32_bf16 v[204:207], v[20:23], v[156:159], v[204:207]
    v_mfma_f32_16x16x32_bf16 v[208:211], v[20:23], v[164:167], v[208:211]
    ds_read_b128 v[96:99], v120 offset:4960
    ds_read_b128 v[100:103], v121 offset:4960
    s_waitcnt lgkmcnt(6)
    v_mfma_f32_16x16x32_bf16 v[168:171], v[80:83], v[224:227], 0
    v_mfma_f32_16x16x32_bf16 v[172:175], v[84:87], v[228:231], 0
    v_mfma_f32_16x16x32_bf16 v[176:179], v[84:87], v[232:235], 0
    v_mfma_f32_16x16x32_bf16 v[180:183], v[80:83], v[236:239], 0
    v_mfma_f32_16x16x32_bf16 v[184:187], v[80:83], v[240:243], 0
    v_mfma_f32_16x16x32_bf16 v[188:191], v[84:87], v[244:247], 0
    v_mfma_f32_16x16x32_bf16 v[212:215], v[36:39], v[128:131], v[212:215]
    v_mfma_f32_16x16x32_bf16 v[216:219], v[36:39], v[132:135], v[216:219]
    s_nop 2
    v_cvt_pk_bf16_f32 v40, v168, v169
    v_cvt_pk_bf16_f32 v41, v170, v171
    v_mfma_f32_16x16x32_bf16 v[220:223], v[36:39], v[136:139], v[220:223]
    v_cvt_pk_bf16_f32 v42, v172, v173
    v_cvt_pk_bf16_f32 v43, v174, v175
    v_mfma_f32_16x16x32_bf16 v[204:207], v[28:31], v[144:147], v[204:207]
    v_cvt_pk_bf16_f32 v44, v176, v177
    v_cvt_pk_bf16_f32 v45, v178, v179
    v_mfma_f32_16x16x32_bf16 v[208:211], v[28:31], v[152:155], v[208:211]
    v_cvt_pk_bf16_f32 v46, v180, v181
    v_cvt_pk_bf16_f32 v47, v182, v183
    v_mfma_f32_16x16x32_bf16 v[212:215], v[28:31], v[160:163], v[212:215]
    v_cvt_pk_bf16_f32 v48, v184, v185
    v_cvt_pk_bf16_f32 v49, v186, v187
    v_mfma_f32_16x16x32_bf16 v[204:207], v[32:35], v[148:151], v[204:207]
    v_cvt_pk_bf16_f32 v50, v188, v189
    v_cvt_pk_bf16_f32 v51, v190, v191
    v_mfma_f32_16x16x32_bf16 v[208:211], v[32:35], v[156:159], v[208:211]
    v_mfma_f32_16x16x32_bf16 v[212:215], v[32:35], v[164:167], v[212:215]
    ds_write_b128 v125, v[200:203] offset:19456
    ds_read_b128 v[104:107], v120 offset:5600
    ds_read_b128 v[108:111], v121 offset:5600
    s_waitcnt lgkmcnt(5)
    v_mfma_f32_16x16x32_bf16 v[168:171], v[88:91], v[224:227], 0
    v_mfma_f32_16x16x32_bf16 v[172:175], v[92:95], v[228:231], 0
    v_mfma_f32_16x16x32_bf16 v[176:179], v[92:95], v[232:235], 0
    v_mfma_f32_16x16x32_bf16 v[180:183], v[88:91], v[236:239], 0
    v_mfma_f32_16x16x32_bf16 v[184:187], v[88:91], v[240:243], 0
    v_mfma_f32_16x16x32_bf16 v[188:191], v[92:95], v[244:247], 0
    v_mfma_f32_16x16x32_bf16 v[216:219], v[48:51], v[128:131], v[216:219]
    v_mfma_f32_16x16x32_bf16 v[220:223], v[48:51], v[132:135], v[220:223]
    s_nop 2
    v_cvt_pk_bf16_f32 v16, v168, v169
    v_cvt_pk_bf16_f32 v17, v170, v171
    v_mfma_f32_16x16x32_bf16 v[208:211], v[40:43], v[144:147], v[208:211]
    v_cvt_pk_bf16_f32 v18, v172, v173
    v_cvt_pk_bf16_f32 v19, v174, v175
    v_mfma_f32_16x16x32_bf16 v[212:215], v[40:43], v[152:155], v[212:215]
    v_cvt_pk_bf16_f32 v20, v176, v177
    v_cvt_pk_bf16_f32 v21, v178, v179
    v_mfma_f32_16x16x32_bf16 v[216:219], v[40:43], v[160:163], v[216:219]
    v_cvt_pk_bf16_f32 v22, v180, v181
    v_cvt_pk_bf16_f32 v23, v182, v183
    v_mfma_f32_16x16x32_bf16 v[208:211], v[44:47], v[148:151], v[208:211]
    v_cvt_pk_bf16_f32 v24, v184, v185
    v_cvt_pk_bf16_f32 v25, v186, v187
    v_mfma_f32_16x16x32_bf16 v[212:215], v[44:47], v[156:159], v[212:215]
    v_cvt_pk_bf16_f32 v26, v188, v189
    v_cvt_pk_bf16_f32 v27, v190, v191
    v_mfma_f32_16x16x32_bf16 v[216:219], v[44:47], v[164:167], v[216:219]
    ds_write_b128 v125, v[204:207] offset:20608
    s_waitcnt lgkmcnt(4)
    v_mfma_f32_16x16x32_bf16 v[168:171], v[96:99], v[224:227], 0
    v_mfma_f32_16x16x32_bf16 v[172:175], v[100:103], v[228:231], 0
    v_mfma_f32_16x16x32_bf16 v[176:179], v[100:103], v[232:235], 0
    v_mfma_f32_16x16x32_bf16 v[180:183], v[96:99], v[236:239], 0
    v_mfma_f32_16x16x32_bf16 v[220:223], v[24:27], v[128:131], v[220:223]
    v_mfma_f32_16x16x32_bf16 v[212:215], v[16:19], v[144:147], v[212:215]
    s_nop 2
    v_cvt_pk_bf16_f32 v28, v168, v169
    v_cvt_pk_bf16_f32 v29, v170, v171
    v_mfma_f32_16x16x32_bf16 v[216:219], v[16:19], v[152:155], v[216:219]
    v_cvt_pk_bf16_f32 v30, v172, v173
    v_cvt_pk_bf16_f32 v31, v174, v175
    v_mfma_f32_16x16x32_bf16 v[220:223], v[16:19], v[160:163], v[220:223]
    v_cvt_pk_bf16_f32 v32, v176, v177
    v_cvt_pk_bf16_f32 v33, v178, v179
    v_mfma_f32_16x16x32_bf16 v[212:215], v[20:23], v[148:151], v[212:215]
    v_cvt_pk_bf16_f32 v34, v180, v181
    v_cvt_pk_bf16_f32 v35, v182, v183
    v_mfma_f32_16x16x32_bf16 v[216:219], v[20:23], v[156:159], v[216:219]
    v_mfma_f32_16x16x32_bf16 v[220:223], v[20:23], v[164:167], v[220:223]
    ds_write_b128 v125, v[208:211] offset:21760
    s_waitcnt lgkmcnt(2)
    v_mfma_f32_16x16x32_bf16 v[168:171], v[104:107], v[224:227], 0
    v_mfma_f32_16x16x32_bf16 v[172:175], v[108:111], v[228:231], 0
    v_mfma_f32_16x16x32_bf16 v[176:179], v[108:111], v[232:235], 0
    v_mfma_f32_16x16x32_bf16 v[180:183], v[104:107], v[236:239], 0
    v_mfma_f32_16x16x32_bf16 v[216:219], v[28:31], v[144:147], v[216:219]
    v_mfma_f32_16x16x32_bf16 v[220:223], v[28:31], v[152:155], v[220:223]
    s_nop 2
    v_cvt_pk_bf16_f32 v40, v168, v169
    v_cvt_pk_bf16_f32 v41, v170, v171
    v_mfma_f32_16x16x32_bf16 v[216:219], v[32:35], v[148:151], v[216:219]
    v_cvt_pk_bf16_f32 v42, v172, v173
    v_cvt_pk_bf16_f32 v43, v174, v175
    v_mfma_f32_16x16x32_bf16 v[220:223], v[32:35], v[156:159], v[220:223]
    v_cvt_pk_bf16_f32 v44, v176, v177
    v_cvt_pk_bf16_f32 v45, v178, v179
    v_cvt_pk_bf16_f32 v46, v180, v181
    v_cvt_pk_bf16_f32 v47, v182, v183
    ds_write_b128 v125, v[212:215] offset:22912
    v_mfma_f32_16x16x32_bf16 v[220:223], v[40:43], v[144:147], v[220:223]
    v_mfma_f32_16x16x32_bf16 v[220:223], v[44:47], v[148:151], v[220:223]
    s_nop 2
    ds_write_b128 v125, v[216:219] offset:24064
    s_nop 7
    ds_write_b128 v125, v[220:223] offset:25216
    s_waitcnt lgkmcnt(0)
    s_barrier
conv_end:
    s_endpgm
.section .rodata,"a"
.p2align 6
.amdhsa_kernel conv_kernel
  .amdhsa_next_free_vgpr 248
  .amdhsa_next_free_sgpr 102
  .amdhsa_accum_offset 248
  .amdhsa_group_segment_fixed_size 0
  .amdhsa_kernarg_size 120
  .amdhsa_user_sgpr_count 2
  .amdhsa_user_sgpr_kernarg_segment_ptr 1
  .amdhsa_system_sgpr_workgroup_id_x 1
.end_amdhsa_kernel
.text
.section .rodata,"a"
.p2align 6
.amdhsa_kernel conv2_kernel
  .amdhsa_next_free_vgpr 248
  .amdhsa_next_free_sgpr 102
  .amdhsa_accum_offset 248
  .amdhsa_group_segment_fixed_size 0
  .amdhsa_kernarg_size 120
  .amdhsa_user_sgpr_count 2
  .amdhsa_user_sgpr_kernarg_segment_ptr 1
  .amdhsa_system_sgpr_workgroup_id_x 1
.end_amdhsa_kernel
.text
.globl qkv2_kernel
.p2align 8
.type qkv2_kernel,@function
qkv2_kernel:
    s_mov_b32 s83, 17825792
    s_branch qkv_kernel_body
.globl qkv_kernel
.p2align 8
.type qkv_kernel,@function
qkv_kernel:
    s_mov_b32 s83, 0
qkv_kernel_body:
    s_cmp_ge_u32 s2, 256
    s_cbranch_scc1 qkv_end
    s_load_dwordx16 s[16:31], s[0:1], 0
    s_load_dwordx8 s[32:39], s[0:1], 64
    s_load_dwordx2 s[40:41], s[0:1], 112
    s_load_dwordx2 s[42:43], s[0:1], 96
    v_lshrrev_b32 v2, 6, v0
    v_and_b32 v1, 63, v0
    v_and_b32 v5, 15, v0
    v_readfirstlane_b32 s3, v2
    v_bfe_u32 v6, v0, 4, 2
    v_lshlrev_b32 v7, 4, v1
    s_and_b32 s4, s2, 7
    s_lshl_b32 s4, s4, 2
    s_bfe_u32 s5, s2, 0x20003
    s_add_u32 s4, s4, s5
    s_lshr_b32 s5, s2, 5
    s_mul_i32 s6, s5, 6
    s_mul_i32 s7, s5, 5
    s_add_u32 s7, s7, 4
    s_cmp_lt_u32 s5, 4
    s_cselect_b32 s6, s6, s7
    s_cmp_lt_u32 s3, 4
    s_cbranch_scc1 qkv_ld
    s_sub_u32 s3, s3, 4
    s_setprio 2
    v_bfe_u32 v10, v1, 2, 2
    v_bfe_u32 v11, v1, 4, 2
    v_lshl_add_u32 v12, v11, 3, v10
    v_lshlrev_b32 v12, 7, v12
    v_lshrrev_b32 v10, 1, v10
    v_and_b32 v11, 1, v11
    v_lshl_or_b32 v10, v11, 1, v10
    v_xor_b32 v10, s3, v10
    v_lshl_add_u32 v12, v10, 5, v12
    v_and_b32 v11, 3, v1
    v_lshl_add_u32 v12, v11, 3, v12
    v_add_u32 v13, 40960, v12
    s_lshl_b32 s15, s4, 6
    s_lshl_b32 s10, s3, 4
    s_add_u32 s15, s15, s10
    v_mov_b32 v16, 0x3f803f80
    v_mov_b32 v17, 0x3f803f80
    v_mov_b32 v18, 0x3f803f80
    v_mov_b32 v19, 0x3f803f80
    v_add_u32 v14, s15, v5
    v_and_b32 v10, 3, v5
    v_cmp_eq_u32 s[80:81], 1, v10
    s_movk_i32 s77, 1280
    v_cmp_eq_u32 s[68:69], 2, v10
    v_cmp_eq_u32 s[70:71], 3, v10
    v_lshrrev_b32 v15, 2, v5
    v_lshl_add_u32 v15, v15, 4, v5
    v_lshlrev_b32 v15, 2, v15
    s_cmp_eq_u32 s5, 7
    s_cselect_b32 s79, 2, 0
    s_sub_u32 s78, s6, s79
    s_lshl_b32 s78, s78, 2
    v_add_u32 v28, s78, v6
    v_and_b32 v29, 31, v14
    v_lshlrev_b32 v30, 3, v29
    v_add_u32 v31, 1024, v30
    v_lshlrev_b32 v29, 4, v29
    s_lshr_b32 s78, s15, 5
    s_mul_i32 s78, s78, 40960
    v_mul_u32_u24 v32, 205, v28
    v_lshrrev_b32 v32, 10, v32
    v_mul_u32_u24 v33, 5, v32
    v_sub_u32 v33, v28, v33
    v_cmp_eq_u32 vcc, 4, v33
    v_lshrrev_b32 v34, 1, v33
    v_lshl_add_u32 v34, v34, 9, v29
    v_and_b32 v35, 1, v33
    v_lshl_add_u32 v34, v35, 3, v34
    v_cndmask_b32 v34, v34, v31, vcc
    v_mad_u32_u24 v54, v32, s77, v34
    v_add_u32 v28, 4, v28
    v_mul_u32_u24 v32, 205, v28
    v_lshrrev_b32 v32, 10, v32
    v_mul_u32_u24 v33, 5, v32
    v_sub_u32 v33, v28, v33
    v_cmp_eq_u32 vcc, 4, v33
    v_lshrrev_b32 v34, 1, v33
    v_lshl_add_u32 v34, v34, 9, v29
    v_and_b32 v35, 1, v33
    v_lshl_add_u32 v34, v35, 3, v34
    v_cndmask_b32 v34, v34, v31, vcc
    v_mad_u32_u24 v55, v32, s77, v34
    v_add_u32 v28, 4, v28
    v_mul_u32_u24 v32, 205, v28
    v_lshrrev_b32 v32, 10, v32
    v_mul_u32_u24 v33, 5, v32
    v_sub_u32 v33, v28, v33
    v_cmp_eq_u32 vcc, 4, v33
    v_lshrrev_b32 v34, 1, v33
    v_lshl_add_u32 v34, v34, 9, v29
    v_and_b32 v35, 1, v33
    v_lshl_add_u32 v34, v35, 3, v34
    v_cndmask_b32 v34, v34, v31, vcc
    v_mad_u32_u24 v56, v32, s77, v34
    v_add_u32 v28, 4, v28
    v_mul_u32_u24 v32, 205, v28
    v_lshrrev_b32 v32, 10, v32
    v_mul_u32_u24 v33, 5, v32
    v_sub_u32 v33, v28, v33
    v_cmp_eq_u32 vcc, 4, v33
    v_lshrrev_b32 v34, 1, v33
    v_lshl_add_u32 v34, v34, 9, v29
    v_and_b32 v35, 1, v33
    v_lshl_add_u32 v34, v35, 3, v34
    v_cndmask_b32 v34, v34, v31, vcc
    v_mad_u32_u24 v57, v32, s77, v34
    v_add_u32 v28, 4, v28
    v_mul_u32_u24 v32, 205, v28
    v_lshrrev_b32 v32, 10, v32
    v_mul_u32_u24 v33, 5, v32
    v_sub_u32 v33, v28, v33
    v_cmp_eq_u32 vcc, 4, v33
    v_lshrrev_b32 v34, 1, v33
    v_lshl_add_u32 v34, v34, 9, v29
    v_and_b32 v35, 1, v33
    v_lshl_add_u32 v34, v35, 3, v34
    v_cndmask_b32 v34, v34, v31, vcc
    v_mad_u32_u24 v58, v32, s77, v34
    v_add_u32 v28, 4, v28
    v_mul_u32_u24 v32, 205, v28
    v_lshrrev_b32 v32, 10, v32
    v_mul_u32_u24 v33, 5, v32
    v_sub_u32 v33, v28, v33
    v_cmp_eq_u32 vcc, 4, v33
    v_lshrrev_b32 v34, 1, v33
    v_lshl_add_u32 v34, v34, 9, v29
    v_and_b32 v35, 1, v33
    v_lshl_add_u32 v34, v35, 3, v34
    v_cndmask_b32 v34, v34, v31, vcc
    v_mad_u32_u24 v59, v32, s77, v34
    s_lshr_b32 s79, s15, 7
    s_mul_i32 s79, s79, 10240
    v_add_u32 v8, 81920, v7
    v_add_u32 v9, 147456, v7
    v_lshlrev_b32 v10, 4, v6
    s_lshl_b32 s14, s6, 6
    s_waitcnt lgkmcnt(0)
    s_add_u32 s64, s40, 983040
    s_addc_u32 s65, s41, 0
    s_mov_b32 s66, 33792
    s_mov_b32 s67, 0x00020000
    buffer_load_dwordx4 v[192:195], v10, s[64:67], s14 offen offset:0
    buffer_load_dwordx4 v[196:199], v10, s[64:67], s14 offen offset:64
    buffer_load_dwordx4 v[200:203], v10, s[64:67], s14 offen offset:128
    buffer_load_dwordx4 v[204:207], v10, s[64:67], s14 offen offset:192
    buffer_load_dwordx4 v[208:211], v10, s[64:67], s14 offen offset:256
    buffer_load_dwordx4 v[212:215], v10, s[64:67], s14 offen offset:320
    s_add_u32 s52, s40, 12582912
    s_addc_u32 s53, s41, 0
    s_mov_b32 s54, 2621440
    s_mov_b32 s55, 0x00020000
    s_add_u32 s56, s40, 15728640
    s_addc_u32 s57, s41, 0
    s_mov_b32 s58, 163840
    s_mov_b32 s59, 0x00020000
    s_cmp_eq_u32 s5, 6
    s_cbranch_scc1 qkv_k
    s_cmp_eq_u32 s5, 7
    s_cbranch_scc1 qkv_v
    s_cmp_ge_u32 s5, 4
    s_cbranch_scc1 qkv_b
    s_barrier
    ds_read_b64_tr_b16 v[64:65], v12 offset:0
    ds_read_b64_tr_b16 v[66:67], v12 offset:512
    ds_read_b128 v[144:147], v8 offset:0
    ds_read_b128 v[148:151], v8 offset:1024
    ds_read_b64_tr_b16 v[68:69], v12 offset:4096
    ds_read_b64_tr_b16 v[70:71], v12 offset:4608
    ds_read_b128 v[152:155], v8 offset:2048
    ds_read_b128 v[156:159], v8 offset:3072
    s_barrier
    ds_read_b64_tr_b16 v[72:73], v12 offset:8192
    ds_read_b64_tr_b16 v[74:75], v12 offset:8704
    ds_read_b128 v[160:163], v8 offset:4096
    ds_read_b128 v[164:167], v8 offset:5120
    s_waitcnt lgkmcnt(9)
    v_mfma_f32_16x16x32_bf16 v[216:219], v[64:67], v[64:67], 0
    v_mfma_f32_16x16x32_bf16 v[220:223], v[16:19], v[64:67], 0
    ds_read_b64_tr_b16 v[76:77], v12 offset:12288
    ds_read_b64_tr_b16 v[78:79], v12 offset:12800
    v_mfma_f32_16x16x32_bf16 v[224:227], v[144:147], v[64:67], 0
    ds_read_b128 v[168:171], v8 offset:6144
    s_waitcnt lgkmcnt(9)
    v_mfma_f32_16x16x32_bf16 v[228:231], v[148:151], v[64:67], 0
    ds_read_b128 v[172:175], v8 offset:7168
    v_mfma_f32_16x16x32_bf16 v[216:219], v[68:71], v[68:71], v[216:219]
    v_mfma_f32_16x16x32_bf16 v[220:223], v[16:19], v[68:71], v[220:223]
    s_barrier
    ds_read_b64_tr_b16 v[80:81], v12 offset:16384
    ds_read_b64_tr_b16 v[82:83], v12 offset:16896
    s_waitcnt lgkmcnt(10)
    v_mfma_f32_16x16x32_bf16 v[224:227], v[152:155], v[68:71], v[224:227]
    ds_read_b128 v[176:179], v8 offset:8192
    v_mfma_f32_16x16x32_bf16 v[228:231], v[156:159], v[68:71], v[228:231]
    ds_read_b128 v[180:183], v8 offset:9216
    s_waitcnt lgkmcnt(9)
    v_mfma_f32_16x16x32_bf16 v[216:219], v[72:75], v[72:75], v[216:219]
    v_mfma_f32_16x16x32_bf16 v[220:223], v[16:19], v[72:75], v[220:223]
    ds_read_b64_tr_b16 v[84:85], v12 offset:20480
    ds_read_b64_tr_b16 v[86:87], v12 offset:20992
    v_mfma_f32_16x16x32_bf16 v[224:227], v[160:163], v[72:75], v[224:227]
    ds_read_b128 v[184:187], v8 offset:10240
    s_waitcnt lgkmcnt(9)
    v_mfma_f32_16x16x32_bf16 v[228:231], v[164:167], v[72:75], v[228:231]
    ds_read_b128 v[188:191], v8 offset:11264
    v_mfma_f32_16x16x32_bf16 v[216:219], v[76:79], v[76:79], v[216:219]
    v_mfma_f32_16x16x32_bf16 v[220:223], v[16:19], v[76:79], v[220:223]
    ds_read_b64_tr_b16 v[88:89], v12 offset:24576
    ds_read_b64_tr_b16 v[90:91], v12 offset:25088
    s_waitcnt lgkmcnt(10)
    v_mfma_f32_16x16x32_bf16 v[224:227], v[168:171], v[76:79], v[224:227]
    ds_read_b128 v[144:147], v8 offset:12288
    v_mfma_f32_16x16x32_bf16 v[228:231], v[172:175], v[76:79], v[228:231]
    ds_read_b128 v[148:151], v8 offset:13312
    s_waitcnt lgkmcnt(9)
    v_mfma_f32_16x16x32_bf16 v[216:219], v[80:83], v[80:83], v[216:219]
    v_mfma_f32_16x16x32_bf16 v[220:223], v[16:19], v[80:83], v[220:223]
    ds_read_b64_tr_b16 v[92:93], v12 offset:28672
    ds_read_b64_tr_b16 v[94:95], v12 offset:29184
    v_mfma_f32_16x16x32_bf16 v[224:227], v[176:179], v[80:83], v[224:227]
    ds_read_b128 v[152:155], v8 offset:14336
    s_waitcnt lgkmcnt(9)
    v_mfma_f32_16x16x32_bf16 v[228:231], v[180:183], v[80:83], v[228:231]
    ds_read_b128 v[156:159], v8 offset:15360
    v_mfma_f32_16x16x32_bf16 v[216:219], v[84:87], v[84:87], v[216:219]
    v_mfma_f32_16x16x32_bf16 v[220:223], v[16:19], v[84:87], v[220:223]
    s_barrier
    ds_read_b64_tr_b16 v[96:97], v12 offset:32768
    ds_read_b64_tr_b16 v[98:99], v12 offset:33280
    s_waitcnt lgkmcnt(10)
    v_mfma_f32_16x16x32_bf16 v[224:227], v[184:187], v[84:87], v[224:227]
    ds_read_b128 v[160:163], v8 offset:16384
    v_mfma_f32_16x16x32_bf16 v[228:231], v[188:191], v[84:87], v[228:231]
    ds_read_b128 v[164:167], v8 offset:17408
    s_waitcnt lgkmcnt(9)
    v_mfma_f32_16x16x32_bf16 v[216:219], v[88:91], v[88:91], v[216:219]
    v_mfma_f32_16x16x32_bf16 v[220:223], v[16:19], v[88:91], v[220:223]
    ds_read_b64_tr_b16 v[100:101], v12 offset:36864
    ds_read_b64_tr_b16 v[102:103], v12 offset:37376
    v_mfma_f32_16x16x32_bf16 v[224:227], v[144:147], v[88:91], v[224:227]
    ds_read_b128 v[168:171], v8 offset:18432
    s_waitcnt lgkmcnt(9)
    v_mfma_f32_16x16x32_bf16 v[228:231], v[148:151], v[88:91], v[228:231]
    ds_read_b128 v[172:175], v8 offset:19456
    v_mfma_f32_16x16x32_bf16 v[216:219], v[92:95], v[92:95], v[216:219]
    v_mfma_f32_16x16x32_bf16 v[220:223], v[16:19], v[92:95], v[220:223]
    ds_read_b64_tr_b16 v[104:105], v13 offset:0
    ds_read_b64_tr_b16 v[106:107], v13 offset:512
    s_waitcnt lgkmcnt(10)
    v_mfma_f32_16x16x32_bf16 v[224:227], v[152:155], v[92:95], v[224:227]
    ds_read_b128 v[176:179], v8 offset:20480
    v_mfma_f32_16x16x32_bf16 v[228:231], v[156:159], v[92:95], v[228:231]
    ds_read_b128 v[180:183], v8 offset:21504
    s_waitcnt lgkmcnt(9)
    v_mfma_f32_16x16x32_bf16 v[216:219], v[96:99], v[96:99], v[216:219]
    v_mfma_f32_16x16x32_bf16 v[220:223], v[16:19], v[96:99], v[220:223]
    ds_read_b64_tr_b16 v[108:109], v13 offset:4096
    ds_read_b64_tr_b16 v[110:111], v13 offset:4608
    v_mfma_f32_16x16x32_bf16 v[224:227], v[160:163], v[96:99], v[224:227]
    ds_read_b128 v[184:187], v8 offset:22528
    s_waitcnt lgkmcnt(9)
    v_mfma_f32_16x16x32_bf16 v[228:231], v[164:167], v[96:99], v[228:231]
    ds_read_b128 v[188:191], v8 offset:23552
    v_mfma_f32_16x16x32_bf16 v[216:219], v[100:103], v[100:103], v[216:219]
    v_mfma_f32_16x16x32_bf16 v[220:223], v[16:19], v[100:103], v[220:223]
    s_barrier
    ds_read_b64_tr_b16 v[112:113], v13 offset:8192
    ds_read_b64_tr_b16 v[114:115], v13 offset:8704
    s_waitcnt lgkmcnt(10)
    v_mfma_f32_16x16x32_bf16 v[224:227], v[168:171], v[100:103], v[224:227]
    ds_read_b128 v[144:147], v8 offset:24576
    v_mfma_f32_16x16x32_bf16 v[228:231], v[172:175], v[100:103], v[228:231]
    ds_read_b128 v[148:151], v8 offset:25600
    s_waitcnt lgkmcnt(9)
    v_mfma_f32_16x16x32_bf16 v[216:219], v[104:107], v[104:107], v[216:219]
    v_mfma_f32_16x16x32_bf16 v[220:223], v[16:19], v[104:107], v[220:223]
    ds_read_b64_tr_b16 v[116:117], v13 offset:12288
    ds_read_b64_tr_b16 v[118:119], v13 offset:12800
    v_mfma_f32_16x16x32_bf16 v[224:227], v[176:179], v[104:107], v[224:227]
    ds_read_b128 v[152:155], v8 offset:26624
    s_waitcnt lgkmcnt(9)
    v_mfma_f32_16x16x32_bf16 v[228:231], v[180:183], v[104:107], v[228:231]
    ds_read_b128 v[156:159], v8 offset:27648
    v_mfma_f32_16x16x32_bf16 v[216:219], v[108:111], v[108:111], v[216:219]
    v_mfma_f32_16x16x32_bf16 v[220:223], v[16:19], v[108:111], v[220:223]
    ds_read_b64_tr_b16 v[120:121], v13 offset:16384
    ds_read_b64_tr_b16 v[122:123], v13 offset:16896
    s_waitcnt lgkmcnt(10)
    v_mfma_f32_16x16x32_bf16 v[224:227], v[184:187], v[108:111], v[224:227]
    ds_read_b128 v[160:163], v8 offset:28672
    v_mfma_f32_16x16x32_bf16 v[228:231], v[188:191], v[108:111], v[228:231]
    ds_read_b128 v[164:167], v8 offset:29696
    s_waitcnt lgkmcnt(9)
    v_mfma_f32_16x16x32_bf16 v[216:219], v[112:115], v[112:115], v[216:219]
    v_mfma_f32_16x16x32_bf16 v[220:223], v[16:19], v[112:115], v[220:223]
    ds_read_b64_tr_b16 v[124:125], v13 offset:20480
    ds_read_b64_tr_b16 v[126:127], v13 offset:20992
    v_mfma_f32_16x16x32_bf16 v[224:227], v[144:147], v[112:115], v[224:227]
    ds_read_b128 v[168:171], v8 offset:30720
    s_waitcnt lgkmcnt(9)
    v_mfma_f32_16x16x32_bf16 v[228:231], v[148:151], v[112:115], v[228:231]
    ds_read_b128 v[172:175], v8 offset:31744
    v_mfma_f32_16x16x32_bf16 v[216:219], v[116:119], v[116:119], v[216:219]
    v_mfma_f32_16x16x32_bf16 v[220:223], v[16:19], v[116:119], v[220:223]
    s_barrier
    ds_read_b64_tr_b16 v[128:129], v13 offset:24576
    ds_read_b64_tr_b16 v[130:131], v13 offset:25088
    s_waitcnt lgkmcnt(10)
    v_mfma_f32_16x16x32_bf16 v[224:227], v[152:155], v[116:119], v[224:227]
    ds_read_b128 v[176:179], v8 offset:32768
    v_mfma_f32_16x16x32_bf16 v[228:231], v[156:159], v[116:119], v[228:231]
    ds_read_b128 v[180:183], v8 offset:33792
    s_waitcnt lgkmcnt(9)
    v_mfma_f32_16x16x32_bf16 v[216:219], v[120:123], v[120:123], v[216:219]
    v_mfma_f32_16x16x32_bf16 v[220:223], v[16:19], v[120:123], v[220:223]
    ds_read_b64_tr_b16 v[132:133], v13 offset:28672
    ds_read_b64_tr_b16 v[134:135], v13 offset:29184
    v_mfma_f32_16x16x32_bf16 v[224:227], v[160:163], v[120:123], v[224:227]
    ds_read_b128 v[184:187], v8 offset:34816
    s_waitcnt lgkmcnt(9)
    v_mfma_f32_16x16x32_bf16 v[228:231], v[164:167], v[120:123], v[228:231]
    ds_read_b128 v[188:191], v8 offset:35840
    v_mfma_f32_16x16x32_bf16 v[216:219], v[124:127], v[124:127], v[216:219]
    v_mfma_f32_16x16x32_bf16 v[220:223], v[16:19], v[124:127], v[220:223]
    ds_read_b64_tr_b16 v[136:137], v13 offset:32768
    ds_read_b64_tr_b16 v[138:139], v13 offset:33280
    s_waitcnt lgkmcnt(10)
    v_mfma_f32_16x16x32_bf16 v[224:227], v[168:171], v[124:127], v[224:227]
    ds_read_b128 v[144:147], v8 offset:36864
    v_mfma_f32_16x16x32_bf16 v[228:231], v[172:175], v[124:127], v[228:231]
    ds_read_b128 v[148:151], v8 offset:37888
    s_waitcnt lgkmcnt(9)
    v_mfma_f32_16x16x32_bf16 v[216:219], v[128:131], v[128:131], v[216:219]
    v_mfma_f32_16x16x32_bf16 v[220:223], v[16:19], v[128:131], v[220:223]
    ds_read_b64_tr_b16 v[140:141], v13 offset:36864
    ds_read_b64_tr_b16 v[142:143], v13 offset:37376
    v_mfma_f32_16x16x32_bf16 v[224:227], v[176:179], v[128:131], v[224:227]
    ds_read_b128 v[152:155], v8 offset:38912
    s_waitcnt lgkmcnt(9)
    v_mfma_f32_16x16x32_bf16 v[228:231], v[180:183], v[128:131], v[228:231]
    ds_read_b128 v[156:159], v8 offset:39936
    v_mfma_f32_16x16x32_bf16 v[216:219], v[132:135], v[132:135], v[216:219]
    v_mfma_f32_16x16x32_bf16 v[220:223], v[16:19], v[132:135], v[220:223]
    s_barrier
    ds_read_b128 v[160:163], v8 offset:40960
    s_waitcnt lgkmcnt(9)
    v_mfma_f32_16x16x32_bf16 v[224:227], v[184:187], v[132:135], v[224:227]
    ds_read_b128 v[164:167], v8 offset:41984
    v_mfma_f32_16x16x32_bf16 v[228:231], v[188:191], v[132:135], v[228:231]
    ds_read_b128 v[168:171], v8 offset:43008
    s_waitcnt lgkmcnt(8)
    v_mfma_f32_16x16x32_bf16 v[216:219], v[136:139], v[136:139], v[216:219]
    v_mfma_f32_16x16x32_bf16 v[220:223], v[16:19], v[136:139], v[220:223]
    ds_read_b128 v[172:175], v8 offset:44032
    v_mfma_f32_16x16x32_bf16 v[224:227], v[144:147], v[136:139], v[224:227]
    ds_read_b128 v[176:179], v8 offset:45056
    s_waitcnt lgkmcnt(7)
    v_mfma_f32_16x16x32_bf16 v[228:231], v[148:151], v[136:139], v[228:231]
    ds_read_b128 v[180:183], v8 offset:46080
    v_mfma_f32_16x16x32_bf16 v[216:219], v[140:143], v[140:143], v[216:219]
    v_mfma_f32_16x16x32_bf16 v[220:223], v[16:19], v[140:143], v[220:223]
    ds_read_b128 v[184:187], v8 offset:47104
    s_waitcnt lgkmcnt(7)
    v_mfma_f32_16x16x32_bf16 v[224:227], v[152:155], v[140:143], v[224:227]
    ds_read_b128 v[188:191], v8 offset:48128
    v_mfma_f32_16x16x32_bf16 v[228:231], v[156:159], v[140:143], v[228:231]
    ds_read_b128 v[144:147], v8 offset:49152
    s_waitcnt lgkmcnt(7)
    v_mfma_f32_16x16x32_bf16 v[232:235], v[160:163], v[64:67], 0
    ds_read_b128 v[148:151], v8 offset:50176
    v_mfma_f32_16x16x32_bf16 v[232:235], v[164:167], v[68:71], v[232:235]
    v_cndmask_b32 v20, v216, v217, s[80:81]
    v_cndmask_b32 v20, v20, v218, s[68:69]
    v_cndmask_b32 v20, v20, v219, s[70:71]
    ds_bpermute_b32 v22, v15, v20
    ds_read_b128 v[152:155], v8 offset:51200
    s_waitcnt lgkmcnt(8)
    v_mfma_f32_16x16x32_bf16 v[232:235], v[168:171], v[72:75], v[232:235]
    ds_read_b128 v[156:159], v8 offset:52224
    v_mfma_f32_16x16x32_bf16 v[232:235], v[172:175], v[76:79], v[232:235]
    ds_read_b128 v[160:163], v8 offset:53248
    s_waitcnt lgkmcnt(8)
    v_mfma_f32_16x16x32_bf16 v[232:235], v[176:179], v[80:83], v[232:235]
    ds_read_b128 v[164:167], v8 offset:54272
    v_mfma_f32_16x16x32_bf16 v[232:235], v[180:183], v[84:87], v[232:235]
    s_waitcnt lgkmcnt(4)
    v_mul_f32 v24, 0x3acccccd, v220
    v_mul_f32 v26, 0x3acccccd, v22
    v_fma_f32 v26, -v24, v24, v26
    v_max_f32 v26, 0, v26
    v_cvt_pk_bf16_f32 v26, v26, v26
    v_lshlrev_b32 v26, 16, v26
    v_add_f32 v26, 0x3727c5ac, v26
    v_cvt_pk_bf16_f32 v26, v26, v26
    v_lshlrev_b32 v26, 16, v26
    v_sqrt_f32 v26, v26
    v_cvt_pk_bf16_f32 v24, v24, v24
    v_lshlrev_b32 v24, 16, v24
    v_cvt_pk_bf16_f32 v26, v26, v26
    v_lshlrev_b32 v26, 16, v26
    v_rcp_f32 v25, v26
    s_nop 0
    v_mul_f32 v26, 1051011932, v25
    s_waitcnt vmcnt(0)
    v_fma_f32 v32, -v24, v192, v224
    v_fma_f32 v33, -v24, v193, v225
    v_fma_f32 v34, -v24, v194, v226
    v_fma_f32 v35, -v24, v195, v227
    v_mul_f32 v32, v26, v32
    v_mul_f32 v33, v26, v33
    v_mul_f32 v34, v26, v34
    v_mul_f32 v35, v26, v35
    v_cvt_pk_bf16_f32 v30, v32, v33
    v_cvt_pk_bf16_f32 v31, v34, v35
    buffer_store_dwordx2 v[30:31], v54, s[52:55], s78 offen sc0 sc1
    v_fma_f32 v32, -v24, v196, v228
    v_fma_f32 v33, -v24, v197, v229
    v_fma_f32 v34, -v24, v198, v230
    v_fma_f32 v35, -v24, v199, v231
    v_mul_f32 v32, v26, v32
    v_mul_f32 v33, v26, v33
    v_mul_f32 v34, v26, v34
    v_mul_f32 v35, v26, v35
    v_cvt_pk_bf16_f32 v30, v32, v33
    v_cvt_pk_bf16_f32 v31, v34, v35
    buffer_store_dwordx2 v[30:31], v55, s[52:55], s78 offen sc0 sc1
    ds_read_b128 v[168:171], v8 offset:55296
    v_mfma_f32_16x16x32_bf16 v[232:235], v[184:187], v[88:91], v[232:235]
    ds_read_b128 v[172:175], v8 offset:56320
    v_mfma_f32_16x16x32_bf16 v[232:235], v[188:191], v[92:95], v[232:235]
    ds_read_b128 v[176:179], v8 offset:57344
    v_mfma_f32_16x16x32_bf16 v[232:235], v[144:147], v[96:99], v[232:235]
    ds_read_b128 v[180:183], v8 offset:58368
    v_mfma_f32_16x16x32_bf16 v[232:235], v[148:151], v[100:103], v[232:235]
    ds_read_b128 v[184:187], v8 offset:59392
    s_waitcnt lgkmcnt(7)
    v_mfma_f32_16x16x32_bf16 v[232:235], v[152:155], v[104:107], v[232:235]
    ds_read_b128 v[188:191], v8 offset:60416
    v_mfma_f32_16x16x32_bf16 v[232:235], v[156:159], v[108:111], v[232:235]
    s_barrier
    ds_read_b128 v[144:147], v8 offset:61440
    s_waitcnt lgkmcnt(7)
    v_mfma_f32_16x16x32_bf16 v[232:235], v[160:163], v[112:115], v[232:235]
    ds_read_b128 v[148:151], v8 offset:62464
    v_mfma_f32_16x16x32_bf16 v[232:235], v[164:167], v[116:119], v[232:235]
    ds_read_b128 v[152:155], v8 offset:63488
    s_waitcnt lgkmcnt(7)
    v_mfma_f32_16x16x32_bf16 v[232:235], v[168:171], v[120:123], v[232:235]
    ds_read_b128 v[156:159], v8 offset:64512
    v_mfma_f32_16x16x32_bf16 v[232:235], v[172:175], v[124:127], v[232:235]
    ds_read_b128 v[160:163], v9 offset:0
    s_waitcnt lgkmcnt(7)
    v_mfma_f32_16x16x32_bf16 v[232:235], v[176:179], v[128:131], v[232:235]
    ds_read_b128 v[164:167], v9 offset:1024
    v_mfma_f32_16x16x32_bf16 v[232:235], v[180:183], v[132:135], v[232:235]
    ds_read_b128 v[168:171], v9 offset:2048
    s_waitcnt lgkmcnt(7)
    v_mfma_f32_16x16x32_bf16 v[232:235], v[184:187], v[136:139], v[232:235]
    ds_read_b128 v[172:175], v9 offset:3072
    v_mfma_f32_16x16x32_bf16 v[232:235], v[188:191], v[140:143], v[232:235]
    ds_read_b128 v[176:179], v9 offset:4096
    s_waitcnt lgkmcnt(7)
    v_mfma_f32_16x16x32_bf16 v[236:239], v[144:147], v[64:67], 0
    ds_read_b128 v[180:183], v9 offset:5120
    v_mfma_f32_16x16x32_bf16 v[236:239], v[148:151], v[68:71], v[236:239]
    ds_read_b128 v[184:187], v9 offset:6144
    s_waitcnt lgkmcnt(7)
    v_mfma_f32_16x16x32_bf16 v[236:239], v[152:155], v[72:75], v[236:239]
    ds_read_b128 v[188:191], v9 offset:7168
    v_mfma_f32_16x16x32_bf16 v[236:239], v[156:159], v[76:79], v[236:239]
    v_fma_f32 v32, -v24, v200, v232
    v_fma_f32 v33, -v24, v201, v233
    v_fma_f32 v34, -v24, v202, v234
    v_fma_f32 v35, -v24, v203, v235
    v_mul_f32 v32, v26, v32
    v_mul_f32 v33, v26, v33
    v_mul_f32 v34, v26, v34
    v_mul_f32 v35, v26, v35
    v_cvt_pk_bf16_f32 v30, v32, v33
    v_cvt_pk_bf16_f32 v31, v34, v35
    buffer_store_dwordx2 v[30:31], v56, s[52:55], s78 offen sc0 sc1
    ds_read_b128 v[144:147], v9 offset:8192
    s_waitcnt lgkmcnt(7)
    v_mfma_f32_16x16x32_bf16 v[236:239], v[160:163], v[80:83], v[236:239]
    ds_read_b128 v[148:151], v9 offset:9216
    v_mfma_f32_16x16x32_bf16 v[236:239], v[164:167], v[84:87], v[236:239]
    ds_read_b128 v[152:155], v9 offset:10240
    s_waitcnt lgkmcnt(7)
    v_mfma_f32_16x16x32_bf16 v[236:239], v[168:171], v[88:91], v[236:239]
    ds_read_b128 v[156:159], v9 offset:11264
    v_mfma_f32_16x16x32_bf16 v[236:239], v[172:175], v[92:95], v[236:239]
    ds_read_b128 v[160:163], v9 offset:12288
    s_waitcnt lgkmcnt(7)
    v_mfma_f32_16x16x32_bf16 v[236:239], v[176:179], v[96:99], v[236:239]
    ds_read_b128 v[164:167], v9 offset:13312
    v_mfma_f32_16x16x32_bf16 v[236:239], v[180:183], v[100:103], v[236:239]
    ds_read_b128 v[168:171], v9 offset:14336
    s_waitcnt lgkmcnt(7)
    v_mfma_f32_16x16x32_bf16 v[236:239], v[184:187], v[104:107], v[236:239]
    ds_read_b128 v[172:175], v9 offset:15360
    v_mfma_f32_16x16x32_bf16 v[236:239], v[188:191], v[108:111], v[236:239]
    s_barrier
    ds_read_b128 v[176:179], v7 offset:0
    s_waitcnt lgkmcnt(7)
    v_mfma_f32_16x16x32_bf16 v[236:239], v[144:147], v[112:115], v[236:239]
    ds_read_b128 v[180:183], v7 offset:1024
    v_mfma_f32_16x16x32_bf16 v[236:239], v[148:151], v[116:119], v[236:239]
    ds_read_b128 v[184:187], v7 offset:2048
    s_waitcnt lgkmcnt(7)
    v_mfma_f32_16x16x32_bf16 v[236:239], v[152:155], v[120:123], v[236:239]
    ds_read_b128 v[188:191], v7 offset:3072
    v_mfma_f32_16x16x32_bf16 v[236:239], v[156:159], v[124:127], v[236:239]
    ds_read_b128 v[144:147], v7 offset:4096
    s_waitcnt lgkmcnt(7)
    v_mfma_f32_16x16x32_bf16 v[236:239], v[160:163], v[128:131], v[236:239]
    ds_read_b128 v[148:151], v7 offset:5120
    v_mfma_f32_16x16x32_bf16 v[236:239], v[164:167], v[132:135], v[236:239]
    ds_read_b128 v[152:155], v7 offset:6144
    s_waitcnt lgkmcnt(7)
    v_mfma_f32_16x16x32_bf16 v[236:239], v[168:171], v[136:139], v[236:239]
    ds_read_b128 v[156:159], v7 offset:7168
    v_mfma_f32_16x16x32_bf16 v[236:239], v[172:175], v[140:143], v[236:239]
    ds_read_b128 v[160:163], v7 offset:8192
    s_waitcnt lgkmcnt(7)
    v_mfma_f32_16x16x32_bf16 v[240:243], v[176:179], v[64:67], 0
    ds_read_b128 v[164:167], v7 offset:9216
    v_mfma_f32_16x16x32_bf16 v[240:243], v[180:183], v[68:71], v[240:243]
    ds_read_b128 v[168:171], v7 offset:10240
    s_waitcnt lgkmcnt(7)
    v_mfma_f32_16x16x32_bf16 v[240:243], v[184:187], v[72:75], v[240:243]
    ds_read_b128 v[172:175], v7 offset:11264
    v_mfma_f32_16x16x32_bf16 v[240:243], v[188:191], v[76:79], v[240:243]
    v_fma_f32 v32, -v24, v204, v236
    v_fma_f32 v33, -v24, v205, v237
    v_fma_f32 v34, -v24, v206, v238
    v_fma_f32 v35, -v24, v207, v239
    v_mul_f32 v32, v26, v32
    v_mul_f32 v33, v26, v33
    v_mul_f32 v34, v26, v34
    v_mul_f32 v35, v26, v35
    v_cvt_pk_bf16_f32 v30, v32, v33
    v_cvt_pk_bf16_f32 v31, v34, v35
    buffer_store_dwordx2 v[30:31], v57, s[52:55], s78 offen sc0 sc1
    ds_read_b128 v[176:179], v7 offset:12288
    s_waitcnt lgkmcnt(7)
    v_mfma_f32_16x16x32_bf16 v[240:243], v[144:147], v[80:83], v[240:243]
    ds_read_b128 v[180:183], v7 offset:13312
    v_mfma_f32_16x16x32_bf16 v[240:243], v[148:151], v[84:87], v[240:243]
    ds_read_b128 v[184:187], v7 offset:14336
    s_waitcnt lgkmcnt(7)
    v_mfma_f32_16x16x32_bf16 v[240:243], v[152:155], v[88:91], v[240:243]
    ds_read_b128 v[188:191], v7 offset:15360
    v_mfma_f32_16x16x32_bf16 v[240:243], v[156:159], v[92:95], v[240:243]
    ds_read_b128 v[144:147], v7 offset:16384
    s_waitcnt lgkmcnt(7)
    v_mfma_f32_16x16x32_bf16 v[240:243], v[160:163], v[96:99], v[240:243]
    ds_read_b128 v[148:151], v7 offset:17408
    v_mfma_f32_16x16x32_bf16 v[240:243], v[164:167], v[100:103], v[240:243]
    ds_read_b128 v[152:155], v7 offset:18432
    s_waitcnt lgkmcnt(7)
    v_mfma_f32_16x16x32_bf16 v[240:243], v[168:171], v[104:107], v[240:243]
    ds_read_b128 v[156:159], v7 offset:19456
    v_mfma_f32_16x16x32_bf16 v[240:243], v[172:175], v[108:111], v[240:243]
    s_barrier
    ds_read_b128 v[160:163], v7 offset:20480
    s_waitcnt lgkmcnt(7)
    v_mfma_f32_16x16x32_bf16 v[240:243], v[176:179], v[112:115], v[240:243]
    ds_read_b128 v[164:167], v7 offset:21504
    v_mfma_f32_16x16x32_bf16 v[240:243], v[180:183], v[116:119], v[240:243]
    ds_read_b128 v[168:171], v7 offset:22528
    s_waitcnt lgkmcnt(7)
    v_mfma_f32_16x16x32_bf16 v[240:243], v[184:187], v[120:123], v[240:243]
    ds_read_b128 v[172:175], v7 offset:23552
    v_mfma_f32_16x16x32_bf16 v[240:243], v[188:191], v[124:127], v[240:243]
    ds_read_b128 v[176:179], v7 offset:24576
    s_waitcnt lgkmcnt(7)
    v_mfma_f32_16x16x32_bf16 v[240:243], v[144:147], v[128:131], v[240:243]
    ds_read_b128 v[180:183], v7 offset:25600
    v_mfma_f32_16x16x32_bf16 v[240:243], v[148:151], v[132:135], v[240:243]
    ds_read_b128 v[184:187], v7 offset:26624
    s_waitcnt lgkmcnt(7)
    v_mfma_f32_16x16x32_bf16 v[240:243], v[152:155], v[136:139], v[240:243]
    ds_read_b128 v[188:191], v7 offset:27648
    v_mfma_f32_16x16x32_bf16 v[240:243], v[156:159], v[140:143], v[240:243]
    ds_read_b128 v[144:147], v7 offset:28672
    s_waitcnt lgkmcnt(7)
    v_mfma_f32_16x16x32_bf16 v[244:247], v[160:163], v[64:67], 0
    ds_read_b128 v[148:151], v7 offset:29696
    v_mfma_f32_16x16x32_bf16 v[244:247], v[164:167], v[68:71], v[244:247]
    ds_read_b128 v[152:155], v7 offset:30720
    s_waitcnt lgkmcnt(7)
    v_mfma_f32_16x16x32_bf16 v[244:247], v[168:171], v[72:75], v[244:247]
    ds_read_b128 v[156:159], v7 offset:31744
    v_mfma_f32_16x16x32_bf16 v[244:247], v[172:175], v[76:79], v[244:247]
    v_fma_f32 v32, -v24, v208, v240
    v_fma_f32 v33, -v24, v209, v241
    v_fma_f32 v34, -v24, v210, v242
    v_fma_f32 v35, -v24, v211, v243
    v_mul_f32 v32, v26, v32
    v_mul_f32 v33, v26, v33
    v_mul_f32 v34, v26, v34
    v_mul_f32 v35, v26, v35
    v_cvt_pk_bf16_f32 v30, v32, v33
    v_cvt_pk_bf16_f32 v31, v34, v35
    buffer_store_dwordx2 v[30:31], v58, s[52:55], s78 offen sc0 sc1
    s_barrier
    ds_read_b128 v[160:163], v7 offset:32768
    s_waitcnt lgkmcnt(7)
    v_mfma_f32_16x16x32_bf16 v[244:247], v[176:179], v[80:83], v[244:247]
    ds_read_b128 v[164:167], v7 offset:33792
    v_mfma_f32_16x16x32_bf16 v[244:247], v[180:183], v[84:87], v[244:247]
    ds_read_b128 v[168:171], v7 offset:34816
    s_waitcnt lgkmcnt(7)
    v_mfma_f32_16x16x32_bf16 v[244:247], v[184:187], v[88:91], v[244:247]
    ds_read_b128 v[172:175], v7 offset:35840
    v_mfma_f32_16x16x32_bf16 v[244:247], v[188:191], v[92:95], v[244:247]
    ds_read_b128 v[176:179], v7 offset:36864
    s_waitcnt lgkmcnt(7)
    v_mfma_f32_16x16x32_bf16 v[244:247], v[144:147], v[96:99], v[244:247]
    ds_read_b128 v[180:183], v7 offset:37888
    v_mfma_f32_16x16x32_bf16 v[244:247], v[148:151], v[100:103], v[244:247]
    ds_read_b128 v[184:187], v7 offset:38912
    s_waitcnt lgkmcnt(7)
    v_mfma_f32_16x16x32_bf16 v[244:247], v[152:155], v[104:107], v[244:247]
    ds_read_b128 v[188:191], v7 offset:39936
    v_mfma_f32_16x16x32_bf16 v[244:247], v[156:159], v[108:111], v[244:247]
    s_waitcnt lgkmcnt(6)
    v_mfma_f32_16x16x32_bf16 v[244:247], v[160:163], v[112:115], v[244:247]
    v_mfma_f32_16x16x32_bf16 v[244:247], v[164:167], v[116:119], v[244:247]
    s_waitcnt lgkmcnt(4)
    v_mfma_f32_16x16x32_bf16 v[244:247], v[168:171], v[120:123], v[244:247]
    v_mfma_f32_16x16x32_bf16 v[244:247], v[172:175], v[124:127], v[244:247]
    s_waitcnt lgkmcnt(2)
    v_mfma_f32_16x16x32_bf16 v[244:247], v[176:179], v[128:131], v[244:247]
    v_mfma_f32_16x16x32_bf16 v[244:247], v[180:183], v[132:135], v[244:247]
    s_waitcnt lgkmcnt(0)
    v_mfma_f32_16x16x32_bf16 v[244:247], v[184:187], v[136:139], v[244:247]
    v_mfma_f32_16x16x32_bf16 v[244:247], v[188:191], v[140:143], v[244:247]
    s_nop 7
    v_fma_f32 v32, -v24, v212, v244
    v_fma_f32 v33, -v24, v213, v245
    v_fma_f32 v34, -v24, v214, v246
    v_fma_f32 v35, -v24, v215, v247
    v_mul_f32 v32, v26, v32
    v_mul_f32 v33, v26, v33
    v_mul_f32 v34, v26, v34
    v_mul_f32 v35, v26, v35
    v_cvt_pk_bf16_f32 v30, v32, v33
    v_cvt_pk_bf16_f32 v31, v34, v35
    buffer_store_dwordx2 v[30:31], v59, s[52:55], s78 offen
    s_endpgm
qkv_b:
    s_add_u32 s72, s40, 11534336
    s_addc_u32 s73, s41, 0
    s_mov_b32 s74, 16384
    s_mov_b32 s75, 0x00020000
    s_cmp_lg_u32 s5, 5
    s_cbranch_scc1 qkv_nz
    v_lshlrev_b32 v10, 3, v14
    v_mov_b32 v20, 0
    v_mov_b32 v21, 0
    buffer_store_dwordx2 v[20:21], v10, s[72:75], 0 offen sc0 sc1
qkv_nz:
    s_barrier
    ds_read_b64_tr_b16 v[64:65], v12 offset:0
    ds_read_b64_tr_b16 v[66:67], v12 offset:512
    ds_read_b128 v[144:147], v8 offset:0
    ds_read_b128 v[148:151], v8 offset:1024
    ds_read_b64_tr_b16 v[68:69], v12 offset:4096
    ds_read_b64_tr_b16 v[70:71], v12 offset:4608
    ds_read_b128 v[152:155], v8 offset:2048
    ds_read_b128 v[156:159], v8 offset:3072
    s_barrier
    ds_read_b64_tr_b16 v[72:73], v12 offset:8192
    ds_read_b64_tr_b16 v[74:75], v12 offset:8704
    ds_read_b128 v[160:163], v8 offset:4096
    ds_read_b128 v[164:167], v8 offset:5120
    s_waitcnt lgkmcnt(9)
    v_mfma_f32_16x16x32_bf16 v[216:219], v[64:67], v[64:67], 0
    v_mfma_f32_16x16x32_bf16 v[220:223], v[16:19], v[64:67], 0
    ds_read_b64_tr_b16 v[76:77], v12 offset:12288
    ds_read_b64_tr_b16 v[78:79], v12 offset:12800
    v_mfma_f32_16x16x32_bf16 v[224:227], v[144:147], v[64:67], 0
    ds_read_b128 v[168:171], v8 offset:6144
    s_waitcnt lgkmcnt(9)
    v_mfma_f32_16x16x32_bf16 v[228:231], v[148:151], v[64:67], 0
    ds_read_b128 v[172:175], v8 offset:7168
    v_mfma_f32_16x16x32_bf16 v[216:219], v[68:71], v[68:71], v[216:219]
    v_mfma_f32_16x16x32_bf16 v[220:223], v[16:19], v[68:71], v[220:223]
    s_barrier
    ds_read_b64_tr_b16 v[80:81], v12 offset:16384
    ds_read_b64_tr_b16 v[82:83], v12 offset:16896
    s_waitcnt lgkmcnt(10)
    v_mfma_f32_16x16x32_bf16 v[224:227], v[152:155], v[68:71], v[224:227]
    ds_read_b128 v[176:179], v8 offset:8192
    v_mfma_f32_16x16x32_bf16 v[228:231], v[156:159], v[68:71], v[228:231]
    ds_read_b128 v[180:183], v8 offset:9216
    s_waitcnt lgkmcnt(9)
    v_mfma_f32_16x16x32_bf16 v[216:219], v[72:75], v[72:75], v[216:219]
    v_mfma_f32_16x16x32_bf16 v[220:223], v[16:19], v[72:75], v[220:223]
    ds_read_b64_tr_b16 v[84:85], v12 offset:20480
    ds_read_b64_tr_b16 v[86:87], v12 offset:20992
    v_mfma_f32_16x16x32_bf16 v[224:227], v[160:163], v[72:75], v[224:227]
    ds_read_b128 v[184:187], v8 offset:10240
    s_waitcnt lgkmcnt(9)
    v_mfma_f32_16x16x32_bf16 v[228:231], v[164:167], v[72:75], v[228:231]
    ds_read_b128 v[188:191], v8 offset:11264
    v_mfma_f32_16x16x32_bf16 v[216:219], v[76:79], v[76:79], v[216:219]
    v_mfma_f32_16x16x32_bf16 v[220:223], v[16:19], v[76:79], v[220:223]
    ds_read_b64_tr_b16 v[88:89], v12 offset:24576
    ds_read_b64_tr_b16 v[90:91], v12 offset:25088
    s_waitcnt lgkmcnt(10)
    v_mfma_f32_16x16x32_bf16 v[224:227], v[168:171], v[76:79], v[224:227]
    ds_read_b128 v[144:147], v8 offset:12288
    v_mfma_f32_16x16x32_bf16 v[228:231], v[172:175], v[76:79], v[228:231]
    ds_read_b128 v[148:151], v8 offset:13312
    s_waitcnt lgkmcnt(9)
    v_mfma_f32_16x16x32_bf16 v[216:219], v[80:83], v[80:83], v[216:219]
    v_mfma_f32_16x16x32_bf16 v[220:223], v[16:19], v[80:83], v[220:223]
    ds_read_b64_tr_b16 v[92:93], v12 offset:28672
    ds_read_b64_tr_b16 v[94:95], v12 offset:29184
    v_mfma_f32_16x16x32_bf16 v[224:227], v[176:179], v[80:83], v[224:227]
    ds_read_b128 v[152:155], v8 offset:14336
    s_waitcnt lgkmcnt(9)
    v_mfma_f32_16x16x32_bf16 v[228:231], v[180:183], v[80:83], v[228:231]
    ds_read_b128 v[156:159], v8 offset:15360
    v_mfma_f32_16x16x32_bf16 v[216:219], v[84:87], v[84:87], v[216:219]
    v_mfma_f32_16x16x32_bf16 v[220:223], v[16:19], v[84:87], v[220:223]
    s_barrier
    ds_read_b64_tr_b16 v[96:97], v12 offset:32768
    ds_read_b64_tr_b16 v[98:99], v12 offset:33280
    s_waitcnt lgkmcnt(10)
    v_mfma_f32_16x16x32_bf16 v[224:227], v[184:187], v[84:87], v[224:227]
    ds_read_b128 v[160:163], v8 offset:16384
    v_mfma_f32_16x16x32_bf16 v[228:231], v[188:191], v[84:87], v[228:231]
    ds_read_b128 v[164:167], v8 offset:17408
    s_waitcnt lgkmcnt(9)
    v_mfma_f32_16x16x32_bf16 v[216:219], v[88:91], v[88:91], v[216:219]
    v_mfma_f32_16x16x32_bf16 v[220:223], v[16:19], v[88:91], v[220:223]
    ds_read_b64_tr_b16 v[100:101], v12 offset:36864
    ds_read_b64_tr_b16 v[102:103], v12 offset:37376
    v_mfma_f32_16x16x32_bf16 v[224:227], v[144:147], v[88:91], v[224:227]
    ds_read_b128 v[168:171], v8 offset:18432
    s_waitcnt lgkmcnt(9)
    v_mfma_f32_16x16x32_bf16 v[228:231], v[148:151], v[88:91], v[228:231]
    ds_read_b128 v[172:175], v8 offset:19456
    v_mfma_f32_16x16x32_bf16 v[216:219], v[92:95], v[92:95], v[216:219]
    v_mfma_f32_16x16x32_bf16 v[220:223], v[16:19], v[92:95], v[220:223]
    ds_read_b64_tr_b16 v[104:105], v13 offset:0
    ds_read_b64_tr_b16 v[106:107], v13 offset:512
    s_waitcnt lgkmcnt(10)
    v_mfma_f32_16x16x32_bf16 v[224:227], v[152:155], v[92:95], v[224:227]
    ds_read_b128 v[176:179], v8 offset:20480
    v_mfma_f32_16x16x32_bf16 v[228:231], v[156:159], v[92:95], v[228:231]
    ds_read_b128 v[180:183], v8 offset:21504
    s_waitcnt lgkmcnt(9)
    v_mfma_f32_16x16x32_bf16 v[216:219], v[96:99], v[96:99], v[216:219]
    v_mfma_f32_16x16x32_bf16 v[220:223], v[16:19], v[96:99], v[220:223]
    ds_read_b64_tr_b16 v[108:109], v13 offset:4096
    ds_read_b64_tr_b16 v[110:111], v13 offset:4608
    v_mfma_f32_16x16x32_bf16 v[224:227], v[160:163], v[96:99], v[224:227]
    ds_read_b128 v[184:187], v8 offset:22528
    s_waitcnt lgkmcnt(9)
    v_mfma_f32_16x16x32_bf16 v[228:231], v[164:167], v[96:99], v[228:231]
    ds_read_b128 v[188:191], v8 offset:23552
    v_mfma_f32_16x16x32_bf16 v[216:219], v[100:103], v[100:103], v[216:219]
    v_mfma_f32_16x16x32_bf16 v[220:223], v[16:19], v[100:103], v[220:223]
    s_barrier
    ds_read_b64_tr_b16 v[112:113], v13 offset:8192
    ds_read_b64_tr_b16 v[114:115], v13 offset:8704
    s_waitcnt lgkmcnt(10)
    v_mfma_f32_16x16x32_bf16 v[224:227], v[168:171], v[100:103], v[224:227]
    ds_read_b128 v[144:147], v8 offset:24576
    v_mfma_f32_16x16x32_bf16 v[228:231], v[172:175], v[100:103], v[228:231]
    ds_read_b128 v[148:151], v8 offset:25600
    s_waitcnt lgkmcnt(9)
    v_mfma_f32_16x16x32_bf16 v[216:219], v[104:107], v[104:107], v[216:219]
    v_mfma_f32_16x16x32_bf16 v[220:223], v[16:19], v[104:107], v[220:223]
    ds_read_b64_tr_b16 v[116:117], v13 offset:12288
    ds_read_b64_tr_b16 v[118:119], v13 offset:12800
    v_mfma_f32_16x16x32_bf16 v[224:227], v[176:179], v[104:107], v[224:227]
    ds_read_b128 v[152:155], v8 offset:26624
    s_waitcnt lgkmcnt(9)
    v_mfma_f32_16x16x32_bf16 v[228:231], v[180:183], v[104:107], v[228:231]
    ds_read_b128 v[156:159], v8 offset:27648
    v_mfma_f32_16x16x32_bf16 v[216:219], v[108:111], v[108:111], v[216:219]
    v_mfma_f32_16x16x32_bf16 v[220:223], v[16:19], v[108:111], v[220:223]
    ds_read_b64_tr_b16 v[120:121], v13 offset:16384
    ds_read_b64_tr_b16 v[122:123], v13 offset:16896
    s_waitcnt lgkmcnt(10)
    v_mfma_f32_16x16x32_bf16 v[224:227], v[184:187], v[108:111], v[224:227]
    ds_read_b128 v[160:163], v8 offset:28672
    v_mfma_f32_16x16x32_bf16 v[228:231], v[188:191], v[108:111], v[228:231]
    ds_read_b128 v[164:167], v8 offset:29696
    s_waitcnt lgkmcnt(9)
    v_mfma_f32_16x16x32_bf16 v[216:219], v[112:115], v[112:115], v[216:219]
    v_mfma_f32_16x16x32_bf16 v[220:223], v[16:19], v[112:115], v[220:223]
    ds_read_b64_tr_b16 v[124:125], v13 offset:20480
    ds_read_b64_tr_b16 v[126:127], v13 offset:20992
    v_mfma_f32_16x16x32_bf16 v[224:227], v[144:147], v[112:115], v[224:227]
    ds_read_b128 v[168:171], v8 offset:30720
    s_waitcnt lgkmcnt(9)
    v_mfma_f32_16x16x32_bf16 v[228:231], v[148:151], v[112:115], v[228:231]
    ds_read_b128 v[172:175], v8 offset:31744
    v_mfma_f32_16x16x32_bf16 v[216:219], v[116:119], v[116:119], v[216:219]
    v_mfma_f32_16x16x32_bf16 v[220:223], v[16:19], v[116:119], v[220:223]
    s_barrier
    ds_read_b64_tr_b16 v[128:129], v13 offset:24576
    ds_read_b64_tr_b16 v[130:131], v13 offset:25088
    s_waitcnt lgkmcnt(10)
    v_mfma_f32_16x16x32_bf16 v[224:227], v[152:155], v[116:119], v[224:227]
    ds_read_b128 v[176:179], v8 offset:32768
    v_mfma_f32_16x16x32_bf16 v[228:231], v[156:159], v[116:119], v[228:231]
    ds_read_b128 v[180:183], v8 offset:33792
    s_waitcnt lgkmcnt(9)
    v_mfma_f32_16x16x32_bf16 v[216:219], v[120:123], v[120:123], v[216:219]
    v_mfma_f32_16x16x32_bf16 v[220:223], v[16:19], v[120:123], v[220:223]
    ds_read_b64_tr_b16 v[132:133], v13 offset:28672
    ds_read_b64_tr_b16 v[134:135], v13 offset:29184
    v_mfma_f32_16x16x32_bf16 v[224:227], v[160:163], v[120:123], v[224:227]
    ds_read_b128 v[184:187], v8 offset:34816
    s_waitcnt lgkmcnt(9)
    v_mfma_f32_16x16x32_bf16 v[228:231], v[164:167], v[120:123], v[228:231]
    ds_read_b128 v[188:191], v8 offset:35840
    v_mfma_f32_16x16x32_bf16 v[216:219], v[124:127], v[124:127], v[216:219]
    v_mfma_f32_16x16x32_bf16 v[220:223], v[16:19], v[124:127], v[220:223]
    ds_read_b64_tr_b16 v[136:137], v13 offset:32768
    ds_read_b64_tr_b16 v[138:139], v13 offset:33280
    s_waitcnt lgkmcnt(10)
    v_mfma_f32_16x16x32_bf16 v[224:227], v[168:171], v[124:127], v[224:227]
    ds_read_b128 v[144:147], v8 offset:36864
    v_mfma_f32_16x16x32_bf16 v[228:231], v[172:175], v[124:127], v[228:231]
    ds_read_b128 v[148:151], v8 offset:37888
    s_waitcnt lgkmcnt(9)
    v_mfma_f32_16x16x32_bf16 v[216:219], v[128:131], v[128:131], v[216:219]
    v_mfma_f32_16x16x32_bf16 v[220:223], v[16:19], v[128:131], v[220:223]
    ds_read_b64_tr_b16 v[140:141], v13 offset:36864
    ds_read_b64_tr_b16 v[142:143], v13 offset:37376
    v_mfma_f32_16x16x32_bf16 v[224:227], v[176:179], v[128:131], v[224:227]
    ds_read_b128 v[152:155], v8 offset:38912
    s_waitcnt lgkmcnt(9)
    v_mfma_f32_16x16x32_bf16 v[228:231], v[180:183], v[128:131], v[228:231]
    ds_read_b128 v[156:159], v8 offset:39936
    v_mfma_f32_16x16x32_bf16 v[216:219], v[132:135], v[132:135], v[216:219]
    v_mfma_f32_16x16x32_bf16 v[220:223], v[16:19], v[132:135], v[220:223]
    s_barrier
    ds_read_b128 v[160:163], v8 offset:40960
    s_waitcnt lgkmcnt(9)
    v_mfma_f32_16x16x32_bf16 v[224:227], v[184:187], v[132:135], v[224:227]
    ds_read_b128 v[164:167], v8 offset:41984
    v_mfma_f32_16x16x32_bf16 v[228:231], v[188:191], v[132:135], v[228:231]
    ds_read_b128 v[168:171], v8 offset:43008
    s_waitcnt lgkmcnt(8)
    v_mfma_f32_16x16x32_bf16 v[216:219], v[136:139], v[136:139], v[216:219]
    v_mfma_f32_16x16x32_bf16 v[220:223], v[16:19], v[136:139], v[220:223]
    ds_read_b128 v[172:175], v8 offset:44032
    v_mfma_f32_16x16x32_bf16 v[224:227], v[144:147], v[136:139], v[224:227]
    ds_read_b128 v[176:179], v8 offset:45056
    s_waitcnt lgkmcnt(7)
    v_mfma_f32_16x16x32_bf16 v[228:231], v[148:151], v[136:139], v[228:231]
    ds_read_b128 v[180:183], v8 offset:46080
    v_mfma_f32_16x16x32_bf16 v[216:219], v[140:143], v[140:143], v[216:219]
    v_mfma_f32_16x16x32_bf16 v[220:223], v[16:19], v[140:143], v[220:223]
    ds_read_b128 v[184:187], v8 offset:47104
    s_waitcnt lgkmcnt(7)
    v_mfma_f32_16x16x32_bf16 v[224:227], v[152:155], v[140:143], v[224:227]
    ds_read_b128 v[188:191], v8 offset:48128
    v_mfma_f32_16x16x32_bf16 v[228:231], v[156:159], v[140:143], v[228:231]
    ds_read_b128 v[144:147], v8 offset:49152
    s_waitcnt lgkmcnt(7)
    v_mfma_f32_16x16x32_bf16 v[232:235], v[160:163], v[64:67], 0
    ds_read_b128 v[148:151], v8 offset:50176
    v_mfma_f32_16x16x32_bf16 v[232:235], v[164:167], v[68:71], v[232:235]
    v_cndmask_b32 v20, v216, v217, s[80:81]
    v_cndmask_b32 v20, v20, v218, s[68:69]
    v_cndmask_b32 v20, v20, v219, s[70:71]
    ds_bpermute_b32 v22, v15, v20
    ds_read_b128 v[152:155], v8 offset:51200
    s_waitcnt lgkmcnt(8)
    v_mfma_f32_16x16x32_bf16 v[232:235], v[168:171], v[72:75], v[232:235]
    ds_read_b128 v[156:159], v8 offset:52224
    v_mfma_f32_16x16x32_bf16 v[232:235], v[172:175], v[76:79], v[232:235]
    ds_read_b128 v[160:163], v8 offset:53248
    s_waitcnt lgkmcnt(8)
    v_mfma_f32_16x16x32_bf16 v[232:235], v[176:179], v[80:83], v[232:235]
    ds_read_b128 v[164:167], v8 offset:54272
    v_mfma_f32_16x16x32_bf16 v[232:235], v[180:183], v[84:87], v[232:235]
    s_waitcnt lgkmcnt(4)
    v_mul_f32 v24, 0x3acccccd, v220
    v_mul_f32 v26, 0x3acccccd, v22
    v_fma_f32 v26, -v24, v24, v26
    v_max_f32 v26, 0, v26
    v_cvt_pk_bf16_f32 v26, v26, v26
    v_lshlrev_b32 v26, 16, v26
    v_add_f32 v26, 0x3727c5ac, v26
    v_cvt_pk_bf16_f32 v26, v26, v26
    v_lshlrev_b32 v26, 16, v26
    v_sqrt_f32 v26, v26
    v_cvt_pk_bf16_f32 v24, v24, v24
    v_lshlrev_b32 v24, 16, v24
    v_cvt_pk_bf16_f32 v26, v26, v26
    v_lshlrev_b32 v26, 16, v26
    v_rcp_f32 v25, v26
    s_nop 0
    v_mul_f32 v26, 1051011932, v25
    s_waitcnt vmcnt(0)
    v_fma_f32 v32, -v24, v192, v224
    v_fma_f32 v33, -v24, v193, v225
    v_fma_f32 v34, -v24, v194, v226
    v_fma_f32 v35, -v24, v195, v227
    v_mul_f32 v32, v26, v32
    v_mul_f32 v33, v26, v33
    v_mul_f32 v34, v26, v34
    v_mul_f32 v35, v26, v35
    v_cvt_pk_bf16_f32 v30, v32, v33
    v_cvt_pk_bf16_f32 v31, v34, v35
    buffer_store_dwordx2 v[30:31], v54, s[52:55], s78 offen sc0 sc1
    v_fma_f32 v32, -v24, v196, v228
    v_fma_f32 v33, -v24, v197, v229
    v_fma_f32 v34, -v24, v198, v230
    v_fma_f32 v35, -v24, v199, v231
    v_mul_f32 v32, v26, v32
    v_mul_f32 v33, v26, v33
    v_mul_f32 v34, v26, v34
    v_mul_f32 v35, v26, v35
    v_cvt_pk_bf16_f32 v30, v32, v33
    v_cvt_pk_bf16_f32 v31, v34, v35
    buffer_store_dwordx2 v[30:31], v55, s[52:55], s78 offen sc0 sc1
    ds_read_b128 v[168:171], v8 offset:55296
    v_mfma_f32_16x16x32_bf16 v[232:235], v[184:187], v[88:91], v[232:235]
    ds_read_b128 v[172:175], v8 offset:56320
    v_mfma_f32_16x16x32_bf16 v[232:235], v[188:191], v[92:95], v[232:235]
    ds_read_b128 v[176:179], v8 offset:57344
    v_mfma_f32_16x16x32_bf16 v[232:235], v[144:147], v[96:99], v[232:235]
    ds_read_b128 v[180:183], v8 offset:58368
    v_mfma_f32_16x16x32_bf16 v[232:235], v[148:151], v[100:103], v[232:235]
    ds_read_b128 v[184:187], v8 offset:59392
    s_waitcnt lgkmcnt(7)
    v_mfma_f32_16x16x32_bf16 v[232:235], v[152:155], v[104:107], v[232:235]
    ds_read_b128 v[188:191], v8 offset:60416
    v_mfma_f32_16x16x32_bf16 v[232:235], v[156:159], v[108:111], v[232:235]
    s_barrier
    ds_read_b128 v[144:147], v8 offset:61440
    s_waitcnt lgkmcnt(7)
    v_mfma_f32_16x16x32_bf16 v[232:235], v[160:163], v[112:115], v[232:235]
    ds_read_b128 v[148:151], v8 offset:62464
    v_mfma_f32_16x16x32_bf16 v[232:235], v[164:167], v[116:119], v[232:235]
    ds_read_b128 v[152:155], v8 offset:63488
    s_waitcnt lgkmcnt(7)
    v_mfma_f32_16x16x32_bf16 v[232:235], v[168:171], v[120:123], v[232:235]
    ds_read_b128 v[156:159], v8 offset:64512
    v_mfma_f32_16x16x32_bf16 v[232:235], v[172:175], v[124:127], v[232:235]
    ds_read_b128 v[160:163], v9 offset:0
    s_waitcnt lgkmcnt(7)
    v_mfma_f32_16x16x32_bf16 v[232:235], v[176:179], v[128:131], v[232:235]
    ds_read_b128 v[164:167], v9 offset:1024
    v_mfma_f32_16x16x32_bf16 v[232:235], v[180:183], v[132:135], v[232:235]
    ds_read_b128 v[168:171], v9 offset:2048
    s_waitcnt lgkmcnt(7)
    v_mfma_f32_16x16x32_bf16 v[232:235], v[184:187], v[136:139], v[232:235]
    ds_read_b128 v[172:175], v9 offset:3072
    v_mfma_f32_16x16x32_bf16 v[232:235], v[188:191], v[140:143], v[232:235]
    ds_read_b128 v[176:179], v9 offset:4096
    s_waitcnt lgkmcnt(7)
    v_mfma_f32_16x16x32_bf16 v[236:239], v[144:147], v[64:67], 0
    ds_read_b128 v[180:183], v9 offset:5120
    v_mfma_f32_16x16x32_bf16 v[236:239], v[148:151], v[68:71], v[236:239]
    ds_read_b128 v[184:187], v9 offset:6144
    s_waitcnt lgkmcnt(7)
    v_mfma_f32_16x16x32_bf16 v[236:239], v[152:155], v[72:75], v[236:239]
    ds_read_b128 v[188:191], v9 offset:7168
    v_mfma_f32_16x16x32_bf16 v[236:239], v[156:159], v[76:79], v[236:239]
    v_fma_f32 v32, -v24, v200, v232
    v_fma_f32 v33, -v24, v201, v233
    v_fma_f32 v34, -v24, v202, v234
    v_fma_f32 v35, -v24, v203, v235
    v_mul_f32 v32, v26, v32
    v_mul_f32 v33, v26, v33
    v_mul_f32 v34, v26, v34
    v_mul_f32 v35, v26, v35
    v_cvt_pk_bf16_f32 v30, v32, v33
    v_cvt_pk_bf16_f32 v31, v34, v35
    buffer_store_dwordx2 v[30:31], v56, s[52:55], s78 offen sc0 sc1
    ds_read_b128 v[144:147], v9 offset:8192
    s_waitcnt lgkmcnt(7)
    v_mfma_f32_16x16x32_bf16 v[236:239], v[160:163], v[80:83], v[236:239]
    ds_read_b128 v[148:151], v9 offset:9216
    v_mfma_f32_16x16x32_bf16 v[236:239], v[164:167], v[84:87], v[236:239]
    ds_read_b128 v[152:155], v9 offset:10240
    s_waitcnt lgkmcnt(7)
    v_mfma_f32_16x16x32_bf16 v[236:239], v[168:171], v[88:91], v[236:239]
    ds_read_b128 v[156:159], v9 offset:11264
    v_mfma_f32_16x16x32_bf16 v[236:239], v[172:175], v[92:95], v[236:239]
    ds_read_b128 v[160:163], v9 offset:12288
    s_waitcnt lgkmcnt(7)
    v_mfma_f32_16x16x32_bf16 v[236:239], v[176:179], v[96:99], v[236:239]
    ds_read_b128 v[164:167], v9 offset:13312
    v_mfma_f32_16x16x32_bf16 v[236:239], v[180:183], v[100:103], v[236:239]
    ds_read_b128 v[168:171], v9 offset:14336
    s_waitcnt lgkmcnt(7)
    v_mfma_f32_16x16x32_bf16 v[236:239], v[184:187], v[104:107], v[236:239]
    ds_read_b128 v[172:175], v9 offset:15360
    v_mfma_f32_16x16x32_bf16 v[236:239], v[188:191], v[108:111], v[236:239]
    s_barrier
    ds_read_b128 v[176:179], v7 offset:0
    s_waitcnt lgkmcnt(7)
    v_mfma_f32_16x16x32_bf16 v[236:239], v[144:147], v[112:115], v[236:239]
    ds_read_b128 v[180:183], v7 offset:1024
    v_mfma_f32_16x16x32_bf16 v[236:239], v[148:151], v[116:119], v[236:239]
    ds_read_b128 v[184:187], v7 offset:2048
    s_waitcnt lgkmcnt(7)
    v_mfma_f32_16x16x32_bf16 v[236:239], v[152:155], v[120:123], v[236:239]
    ds_read_b128 v[188:191], v7 offset:3072
    v_mfma_f32_16x16x32_bf16 v[236:239], v[156:159], v[124:127], v[236:239]
    ds_read_b128 v[144:147], v7 offset:4096
    s_waitcnt lgkmcnt(7)
    v_mfma_f32_16x16x32_bf16 v[236:239], v[160:163], v[128:131], v[236:239]
    ds_read_b128 v[148:151], v7 offset:5120
    v_mfma_f32_16x16x32_bf16 v[236:239], v[164:167], v[132:135], v[236:239]
    ds_read_b128 v[152:155], v7 offset:6144
    s_waitcnt lgkmcnt(7)
    v_mfma_f32_16x16x32_bf16 v[236:239], v[168:171], v[136:139], v[236:239]
    ds_read_b128 v[156:159], v7 offset:7168
    v_mfma_f32_16x16x32_bf16 v[236:239], v[172:175], v[140:143], v[236:239]
    ds_read_b128 v[160:163], v7 offset:8192
    s_waitcnt lgkmcnt(7)
    v_mfma_f32_16x16x32_bf16 v[240:243], v[176:179], v[64:67], 0
    ds_read_b128 v[164:167], v7 offset:9216
    v_mfma_f32_16x16x32_bf16 v[240:243], v[180:183], v[68:71], v[240:243]
    ds_read_b128 v[168:171], v7 offset:10240
    s_waitcnt lgkmcnt(7)
    v_mfma_f32_16x16x32_bf16 v[240:243], v[184:187], v[72:75], v[240:243]
    ds_read_b128 v[172:175], v7 offset:11264
    v_mfma_f32_16x16x32_bf16 v[240:243], v[188:191], v[76:79], v[240:243]
    v_fma_f32 v32, -v24, v204, v236
    v_fma_f32 v33, -v24, v205, v237
    v_fma_f32 v34, -v24, v206, v238
    v_fma_f32 v35, -v24, v207, v239
    v_mul_f32 v32, v26, v32
    v_mul_f32 v33, v26, v33
    v_mul_f32 v34, v26, v34
    v_mul_f32 v35, v26, v35
    v_cvt_pk_bf16_f32 v30, v32, v33
    v_cvt_pk_bf16_f32 v31, v34, v35
    buffer_store_dwordx2 v[30:31], v57, s[52:55], s78 offen sc0 sc1
    s_barrier
    ds_read_b128 v[176:179], v7 offset:12288
    s_waitcnt lgkmcnt(7)
    v_mfma_f32_16x16x32_bf16 v[240:243], v[144:147], v[80:83], v[240:243]
    ds_read_b128 v[180:183], v7 offset:13312
    v_mfma_f32_16x16x32_bf16 v[240:243], v[148:151], v[84:87], v[240:243]
    ds_read_b128 v[184:187], v7 offset:14336
    s_waitcnt lgkmcnt(7)
    v_mfma_f32_16x16x32_bf16 v[240:243], v[152:155], v[88:91], v[240:243]
    ds_read_b128 v[188:191], v7 offset:15360
    v_mfma_f32_16x16x32_bf16 v[240:243], v[156:159], v[92:95], v[240:243]
    ds_read_b128 v[144:147], v7 offset:16384
    s_waitcnt lgkmcnt(7)
    v_mfma_f32_16x16x32_bf16 v[240:243], v[160:163], v[96:99], v[240:243]
    ds_read_b128 v[148:151], v7 offset:17408
    v_mfma_f32_16x16x32_bf16 v[240:243], v[164:167], v[100:103], v[240:243]
    ds_read_b128 v[152:155], v7 offset:18432
    s_waitcnt lgkmcnt(7)
    v_mfma_f32_16x16x32_bf16 v[240:243], v[168:171], v[104:107], v[240:243]
    ds_read_b128 v[156:159], v7 offset:19456
    v_mfma_f32_16x16x32_bf16 v[240:243], v[172:175], v[108:111], v[240:243]
    s_waitcnt lgkmcnt(6)
    v_mfma_f32_16x16x32_bf16 v[240:243], v[176:179], v[112:115], v[240:243]
    v_mfma_f32_16x16x32_bf16 v[240:243], v[180:183], v[116:119], v[240:243]
    s_waitcnt lgkmcnt(4)
    v_mfma_f32_16x16x32_bf16 v[240:243], v[184:187], v[120:123], v[240:243]
    v_mfma_f32_16x16x32_bf16 v[240:243], v[188:191], v[124:127], v[240:243]
    s_waitcnt lgkmcnt(2)
    v_mfma_f32_16x16x32_bf16 v[240:243], v[144:147], v[128:131], v[240:243]
    v_mfma_f32_16x16x32_bf16 v[240:243], v[148:151], v[132:135], v[240:243]
    s_waitcnt lgkmcnt(0)
    v_mfma_f32_16x16x32_bf16 v[240:243], v[152:155], v[136:139], v[240:243]
    v_mfma_f32_16x16x32_bf16 v[240:243], v[156:159], v[140:143], v[240:243]
    s_nop 7
    v_fma_f32 v32, -v24, v208, v240
    v_fma_f32 v33, -v24, v209, v241
    v_fma_f32 v34, -v24, v210, v242
    v_fma_f32 v35, -v24, v211, v243
    v_mul_f32 v32, v26, v32
    v_mul_f32 v33, v26, v33
    v_mul_f32 v34, v26, v34
    v_mul_f32 v35, v26, v35
    v_cvt_pk_bf16_f32 v30, v32, v33
    v_cvt_pk_bf16_f32 v31, v34, v35
    buffer_store_dwordx2 v[30:31], v58, s[52:55], s78 offen
    s_endpgm
qkv_k:
    v_and_b32 v39, 127, v14
    v_lshlrev_b32 v11, 5, v39
    v_lshl_add_u32 v11, v6, 3, v11
    v_lshlrev_b32 v23, 3, v39
    v_add_u32 v23, 4096, v23
    s_lshl_b32 s19, s4, 4
    s_lshl_b32 s20, s3, 2
    s_add_u32 s19, s19, s20
    v_mov_b32 v38, 33024
    v_cmp_eq_u32 s[72:73], 0, v6
    v_cmp_eq_u32 s[74:75], 0, v1
    s_barrier
    ds_read_b64_tr_b16 v[64:65], v12 offset:0
    ds_read_b64_tr_b16 v[66:67], v12 offset:512
    ds_read_b128 v[144:147], v8 offset:0
    ds_read_b128 v[148:151], v8 offset:1024
    ds_read_b64_tr_b16 v[68:69], v12 offset:4096
    ds_read_b64_tr_b16 v[70:71], v12 offset:4608
    ds_read_b128 v[152:155], v8 offset:2048
    ds_read_b128 v[156:159], v8 offset:3072
    s_barrier
    ds_read_b64_tr_b16 v[72:73], v12 offset:8192
    ds_read_b64_tr_b16 v[74:75], v12 offset:8704
    ds_read_b128 v[160:163], v8 offset:4096
    ds_read_b128 v[164:167], v8 offset:5120
    s_waitcnt lgkmcnt(9)
    v_mfma_f32_16x16x32_bf16 v[216:219], v[64:67], v[64:67], 0
    v_mfma_f32_16x16x32_bf16 v[220:223], v[16:19], v[64:67], 0
    ds_read_b64_tr_b16 v[76:77], v12 offset:12288
    ds_read_b64_tr_b16 v[78:79], v12 offset:12800
    v_mfma_f32_16x16x32_bf16 v[224:227], v[144:147], v[64:67], 0
    ds_read_b128 v[168:171], v8 offset:6144
    s_waitcnt lgkmcnt(9)
    v_mfma_f32_16x16x32_bf16 v[228:231], v[148:151], v[64:67], 0
    ds_read_b128 v[172:175], v8 offset:7168
    v_mfma_f32_16x16x32_bf16 v[216:219], v[68:71], v[68:71], v[216:219]
    v_mfma_f32_16x16x32_bf16 v[220:223], v[16:19], v[68:71], v[220:223]
    s_barrier
    ds_read_b64_tr_b16 v[80:81], v12 offset:16384
    ds_read_b64_tr_b16 v[82:83], v12 offset:16896
    s_waitcnt lgkmcnt(10)
    v_mfma_f32_16x16x32_bf16 v[224:227], v[152:155], v[68:71], v[224:227]
    ds_read_b128 v[176:179], v8 offset:8192
    v_mfma_f32_16x16x32_bf16 v[228:231], v[156:159], v[68:71], v[228:231]
    ds_read_b128 v[180:183], v8 offset:9216
    s_waitcnt lgkmcnt(9)
    v_mfma_f32_16x16x32_bf16 v[216:219], v[72:75], v[72:75], v[216:219]
    v_mfma_f32_16x16x32_bf16 v[220:223], v[16:19], v[72:75], v[220:223]
    ds_read_b64_tr_b16 v[84:85], v12 offset:20480
    ds_read_b64_tr_b16 v[86:87], v12 offset:20992
    v_mfma_f32_16x16x32_bf16 v[224:227], v[160:163], v[72:75], v[224:227]
    ds_read_b128 v[184:187], v8 offset:10240
    s_waitcnt lgkmcnt(9)
    v_mfma_f32_16x16x32_bf16 v[228:231], v[164:167], v[72:75], v[228:231]
    ds_read_b128 v[188:191], v8 offset:11264
    v_mfma_f32_16x16x32_bf16 v[216:219], v[76:79], v[76:79], v[216:219]
    v_mfma_f32_16x16x32_bf16 v[220:223], v[16:19], v[76:79], v[220:223]
    ds_read_b64_tr_b16 v[88:89], v12 offset:24576
    ds_read_b64_tr_b16 v[90:91], v12 offset:25088
    s_waitcnt lgkmcnt(10)
    v_mfma_f32_16x16x32_bf16 v[224:227], v[168:171], v[76:79], v[224:227]
    ds_read_b128 v[144:147], v8 offset:12288
    v_mfma_f32_16x16x32_bf16 v[228:231], v[172:175], v[76:79], v[228:231]
    ds_read_b128 v[148:151], v8 offset:13312
    s_waitcnt lgkmcnt(9)
    v_mfma_f32_16x16x32_bf16 v[216:219], v[80:83], v[80:83], v[216:219]
    v_mfma_f32_16x16x32_bf16 v[220:223], v[16:19], v[80:83], v[220:223]
    ds_read_b64_tr_b16 v[92:93], v12 offset:28672
    ds_read_b64_tr_b16 v[94:95], v12 offset:29184
    v_mfma_f32_16x16x32_bf16 v[224:227], v[176:179], v[80:83], v[224:227]
    ds_read_b128 v[152:155], v8 offset:14336
    s_waitcnt lgkmcnt(9)
    v_mfma_f32_16x16x32_bf16 v[228:231], v[180:183], v[80:83], v[228:231]
    ds_read_b128 v[156:159], v8 offset:15360
    v_mfma_f32_16x16x32_bf16 v[216:219], v[84:87], v[84:87], v[216:219]
    v_mfma_f32_16x16x32_bf16 v[220:223], v[16:19], v[84:87], v[220:223]
    s_barrier
    ds_read_b64_tr_b16 v[96:97], v12 offset:32768
    ds_read_b64_tr_b16 v[98:99], v12 offset:33280
    s_waitcnt lgkmcnt(10)
    v_mfma_f32_16x16x32_bf16 v[224:227], v[184:187], v[84:87], v[224:227]
    ds_read_b128 v[160:163], v8 offset:16384
    v_mfma_f32_16x16x32_bf16 v[228:231], v[188:191], v[84:87], v[228:231]
    ds_read_b128 v[164:167], v8 offset:17408
    s_waitcnt lgkmcnt(9)
    v_mfma_f32_16x16x32_bf16 v[216:219], v[88:91], v[88:91], v[216:219]
    v_mfma_f32_16x16x32_bf16 v[220:223], v[16:19], v[88:91], v[220:223]
    ds_read_b64_tr_b16 v[100:101], v12 offset:36864
    ds_read_b64_tr_b16 v[102:103], v12 offset:37376
    v_mfma_f32_16x16x32_bf16 v[224:227], v[144:147], v[88:91], v[224:227]
    ds_read_b128 v[168:171], v8 offset:18432
    s_waitcnt lgkmcnt(9)
    v_mfma_f32_16x16x32_bf16 v[228:231], v[148:151], v[88:91], v[228:231]
    ds_read_b128 v[172:175], v8 offset:19456
    v_mfma_f32_16x16x32_bf16 v[216:219], v[92:95], v[92:95], v[216:219]
    v_mfma_f32_16x16x32_bf16 v[220:223], v[16:19], v[92:95], v[220:223]
    ds_read_b64_tr_b16 v[104:105], v13 offset:0
    ds_read_b64_tr_b16 v[106:107], v13 offset:512
    s_waitcnt lgkmcnt(10)
    v_mfma_f32_16x16x32_bf16 v[224:227], v[152:155], v[92:95], v[224:227]
    ds_read_b128 v[176:179], v8 offset:20480
    v_mfma_f32_16x16x32_bf16 v[228:231], v[156:159], v[92:95], v[228:231]
    ds_read_b128 v[180:183], v8 offset:21504
    s_waitcnt lgkmcnt(9)
    v_mfma_f32_16x16x32_bf16 v[216:219], v[96:99], v[96:99], v[216:219]
    v_mfma_f32_16x16x32_bf16 v[220:223], v[16:19], v[96:99], v[220:223]
    ds_read_b64_tr_b16 v[108:109], v13 offset:4096
    ds_read_b64_tr_b16 v[110:111], v13 offset:4608
    v_mfma_f32_16x16x32_bf16 v[224:227], v[160:163], v[96:99], v[224:227]
    ds_read_b128 v[184:187], v8 offset:22528
    s_waitcnt lgkmcnt(9)
    v_mfma_f32_16x16x32_bf16 v[228:231], v[164:167], v[96:99], v[228:231]
    ds_read_b128 v[188:191], v8 offset:23552
    v_mfma_f32_16x16x32_bf16 v[216:219], v[100:103], v[100:103], v[216:219]
    v_mfma_f32_16x16x32_bf16 v[220:223], v[16:19], v[100:103], v[220:223]
    s_barrier
    ds_read_b64_tr_b16 v[112:113], v13 offset:8192
    ds_read_b64_tr_b16 v[114:115], v13 offset:8704
    s_waitcnt lgkmcnt(10)
    v_mfma_f32_16x16x32_bf16 v[224:227], v[168:171], v[100:103], v[224:227]
    ds_read_b128 v[144:147], v8 offset:24576
    v_mfma_f32_16x16x32_bf16 v[228:231], v[172:175], v[100:103], v[228:231]
    ds_read_b128 v[148:151], v8 offset:25600
    s_waitcnt lgkmcnt(9)
    v_mfma_f32_16x16x32_bf16 v[216:219], v[104:107], v[104:107], v[216:219]
    v_mfma_f32_16x16x32_bf16 v[220:223], v[16:19], v[104:107], v[220:223]
    ds_read_b64_tr_b16 v[116:117], v13 offset:12288
    ds_read_b64_tr_b16 v[118:119], v13 offset:12800
    v_mfma_f32_16x16x32_bf16 v[224:227], v[176:179], v[104:107], v[224:227]
    ds_read_b128 v[152:155], v8 offset:26624
    s_waitcnt lgkmcnt(9)
    v_mfma_f32_16x16x32_bf16 v[228:231], v[180:183], v[104:107], v[228:231]
    ds_read_b128 v[156:159], v8 offset:27648
    v_mfma_f32_16x16x32_bf16 v[216:219], v[108:111], v[108:111], v[216:219]
    v_mfma_f32_16x16x32_bf16 v[220:223], v[16:19], v[108:111], v[220:223]
    ds_read_b64_tr_b16 v[120:121], v13 offset:16384
    ds_read_b64_tr_b16 v[122:123], v13 offset:16896
    s_waitcnt lgkmcnt(10)
    v_mfma_f32_16x16x32_bf16 v[224:227], v[184:187], v[108:111], v[224:227]
    ds_read_b128 v[160:163], v8 offset:28672
    v_mfma_f32_16x16x32_bf16 v[228:231], v[188:191], v[108:111], v[228:231]
    ds_read_b128 v[164:167], v8 offset:29696
    s_waitcnt lgkmcnt(9)
    v_mfma_f32_16x16x32_bf16 v[216:219], v[112:115], v[112:115], v[216:219]
    v_mfma_f32_16x16x32_bf16 v[220:223], v[16:19], v[112:115], v[220:223]
    ds_read_b64_tr_b16 v[124:125], v13 offset:20480
    ds_read_b64_tr_b16 v[126:127], v13 offset:20992
    v_mfma_f32_16x16x32_bf16 v[224:227], v[144:147], v[112:115], v[224:227]
    ds_read_b128 v[168:171], v8 offset:30720
    s_waitcnt lgkmcnt(9)
    v_mfma_f32_16x16x32_bf16 v[228:231], v[148:151], v[112:115], v[228:231]
    ds_read_b128 v[172:175], v8 offset:31744
    v_mfma_f32_16x16x32_bf16 v[216:219], v[116:119], v[116:119], v[216:219]
    v_mfma_f32_16x16x32_bf16 v[220:223], v[16:19], v[116:119], v[220:223]
    s_barrier
    ds_read_b64_tr_b16 v[128:129], v13 offset:24576
    ds_read_b64_tr_b16 v[130:131], v13 offset:25088
    s_waitcnt lgkmcnt(10)
    v_mfma_f32_16x16x32_bf16 v[224:227], v[152:155], v[116:119], v[224:227]
    ds_read_b128 v[176:179], v8 offset:32768
    v_mfma_f32_16x16x32_bf16 v[228:231], v[156:159], v[116:119], v[228:231]
    ds_read_b128 v[180:183], v8 offset:33792
    s_waitcnt lgkmcnt(9)
    v_mfma_f32_16x16x32_bf16 v[216:219], v[120:123], v[120:123], v[216:219]
    v_mfma_f32_16x16x32_bf16 v[220:223], v[16:19], v[120:123], v[220:223]
    ds_read_b64_tr_b16 v[132:133], v13 offset:28672
    ds_read_b64_tr_b16 v[134:135], v13 offset:29184
    v_mfma_f32_16x16x32_bf16 v[224:227], v[160:163], v[120:123], v[224:227]
    ds_read_b128 v[184:187], v8 offset:34816
    s_waitcnt lgkmcnt(9)
    v_mfma_f32_16x16x32_bf16 v[228:231], v[164:167], v[120:123], v[228:231]
    ds_read_b128 v[188:191], v8 offset:35840
    v_mfma_f32_16x16x32_bf16 v[216:219], v[124:127], v[124:127], v[216:219]
    v_mfma_f32_16x16x32_bf16 v[220:223], v[16:19], v[124:127], v[220:223]
    ds_read_b64_tr_b16 v[136:137], v13 offset:32768
    ds_read_b64_tr_b16 v[138:139], v13 offset:33280
    s_waitcnt lgkmcnt(10)
    v_mfma_f32_16x16x32_bf16 v[224:227], v[168:171], v[124:127], v[224:227]
    ds_read_b128 v[144:147], v8 offset:36864
    v_mfma_f32_16x16x32_bf16 v[228:231], v[172:175], v[124:127], v[228:231]
    ds_read_b128 v[148:151], v8 offset:37888
    s_waitcnt lgkmcnt(9)
    v_mfma_f32_16x16x32_bf16 v[216:219], v[128:131], v[128:131], v[216:219]
    v_mfma_f32_16x16x32_bf16 v[220:223], v[16:19], v[128:131], v[220:223]
    ds_read_b64_tr_b16 v[140:141], v13 offset:36864
    ds_read_b64_tr_b16 v[142:143], v13 offset:37376
    v_mfma_f32_16x16x32_bf16 v[224:227], v[176:179], v[128:131], v[224:227]
    ds_read_b128 v[152:155], v8 offset:38912
    s_waitcnt lgkmcnt(9)
    v_mfma_f32_16x16x32_bf16 v[228:231], v[180:183], v[128:131], v[228:231]
    ds_read_b128 v[156:159], v8 offset:39936
    v_mfma_f32_16x16x32_bf16 v[216:219], v[132:135], v[132:135], v[216:219]
    v_mfma_f32_16x16x32_bf16 v[220:223], v[16:19], v[132:135], v[220:223]
    s_barrier
    ds_read_b128 v[160:163], v8 offset:40960
    s_waitcnt lgkmcnt(9)
    v_mfma_f32_16x16x32_bf16 v[224:227], v[184:187], v[132:135], v[224:227]
    ds_read_b128 v[164:167], v8 offset:41984
    v_mfma_f32_16x16x32_bf16 v[228:231], v[188:191], v[132:135], v[228:231]
    ds_read_b128 v[168:171], v8 offset:43008
    s_waitcnt lgkmcnt(8)
    v_mfma_f32_16x16x32_bf16 v[216:219], v[136:139], v[136:139], v[216:219]
    v_mfma_f32_16x16x32_bf16 v[220:223], v[16:19], v[136:139], v[220:223]
    ds_read_b128 v[172:175], v8 offset:44032
    v_mfma_f32_16x16x32_bf16 v[224:227], v[144:147], v[136:139], v[224:227]
    ds_read_b128 v[176:179], v8 offset:45056
    s_waitcnt lgkmcnt(7)
    v_mfma_f32_16x16x32_bf16 v[228:231], v[148:151], v[136:139], v[228:231]
    ds_read_b128 v[180:183], v8 offset:46080
    v_mfma_f32_16x16x32_bf16 v[216:219], v[140:143], v[140:143], v[216:219]
    v_mfma_f32_16x16x32_bf16 v[220:223], v[16:19], v[140:143], v[220:223]
    ds_read_b128 v[184:187], v8 offset:47104
    s_waitcnt lgkmcnt(7)
    v_mfma_f32_16x16x32_bf16 v[224:227], v[152:155], v[140:143], v[224:227]
    ds_read_b128 v[188:191], v8 offset:48128
    v_mfma_f32_16x16x32_bf16 v[228:231], v[156:159], v[140:143], v[228:231]
    ds_read_b128 v[144:147], v8 offset:49152
    s_waitcnt lgkmcnt(7)
    v_mfma_f32_16x16x32_bf16 v[232:235], v[160:163], v[64:67], 0
    ds_read_b128 v[148:151], v8 offset:50176
    v_mfma_f32_16x16x32_bf16 v[232:235], v[164:167], v[68:71], v[232:235]
    v_cndmask_b32 v20, v216, v217, s[80:81]
    v_cndmask_b32 v20, v20, v218, s[68:69]
    v_cndmask_b32 v20, v20, v219, s[70:71]
    ds_bpermute_b32 v22, v15, v20
    ds_read_b128 v[152:155], v8 offset:51200
    s_waitcnt lgkmcnt(8)
    v_mfma_f32_16x16x32_bf16 v[232:235], v[168:171], v[72:75], v[232:235]
    ds_read_b128 v[156:159], v8 offset:52224
    v_mfma_f32_16x16x32_bf16 v[232:235], v[172:175], v[76:79], v[232:235]
    ds_read_b128 v[160:163], v8 offset:53248
    s_waitcnt lgkmcnt(8)
    v_mfma_f32_16x16x32_bf16 v[232:235], v[176:179], v[80:83], v[232:235]
    ds_read_b128 v[164:167], v8 offset:54272
    v_mfma_f32_16x16x32_bf16 v[232:235], v[180:183], v[84:87], v[232:235]
    s_waitcnt lgkmcnt(4)
    v_mul_f32 v24, 0x3acccccd, v220
    v_mul_f32 v26, 0x3acccccd, v22
    v_fma_f32 v26, -v24, v24, v26
    v_max_f32 v26, 0, v26
    v_cvt_pk_bf16_f32 v26, v26, v26
    v_lshlrev_b32 v26, 16, v26
    v_add_f32 v26, 0x3727c5ac, v26
    v_cvt_pk_bf16_f32 v26, v26, v26
    v_lshlrev_b32 v26, 16, v26
    v_sqrt_f32 v26, v26
    v_cvt_pk_bf16_f32 v24, v24, v24
    v_lshlrev_b32 v24, 16, v24
    v_cvt_pk_bf16_f32 v26, v26, v26
    v_lshlrev_b32 v26, 16, v26
    v_rcp_f32 v25, v26
    s_nop 0
    v_mul_f32 v26, 1051011932, v25
    s_waitcnt vmcnt(0)
    v_fma_f32 v32, -v24, v192, v224
    v_fma_f32 v33, -v24, v193, v225
    v_fma_f32 v34, -v24, v194, v226
    v_fma_f32 v35, -v24, v195, v227
    v_mul_f32 v32, v26, v32
    v_mul_f32 v33, v26, v33
    v_mul_f32 v34, v26, v34
    v_mul_f32 v35, v26, v35
    v_cvt_pk_bf16_f32 v30, v32, v33
    v_cvt_pk_bf16_f32 v31, v34, v35
    buffer_store_dwordx2 v[30:31], v54, s[52:55], s78 offen sc0 sc1
    v_fma_f32 v32, -v24, v196, v228
    v_fma_f32 v33, -v24, v197, v229
    v_fma_f32 v34, -v24, v198, v230
    v_fma_f32 v35, -v24, v199, v231
    v_mul_f32 v32, v26, v32
    v_mul_f32 v33, v26, v33
    v_mul_f32 v34, v26, v34
    v_mul_f32 v35, v26, v35
    v_cvt_pk_bf16_f32 v30, v32, v33
    v_cvt_pk_bf16_f32 v31, v34, v35
    buffer_store_dwordx2 v[30:31], v55, s[52:55], s78 offen sc0 sc1
    ds_read_b128 v[168:171], v8 offset:55296
    v_mfma_f32_16x16x32_bf16 v[232:235], v[184:187], v[88:91], v[232:235]
    ds_read_b128 v[172:175], v8 offset:56320
    v_mfma_f32_16x16x32_bf16 v[232:235], v[188:191], v[92:95], v[232:235]
    ds_read_b128 v[176:179], v8 offset:57344
    v_mfma_f32_16x16x32_bf16 v[232:235], v[144:147], v[96:99], v[232:235]
    ds_read_b128 v[180:183], v8 offset:58368
    v_mfma_f32_16x16x32_bf16 v[232:235], v[148:151], v[100:103], v[232:235]
    ds_read_b128 v[184:187], v8 offset:59392
    s_waitcnt lgkmcnt(7)
    v_mfma_f32_16x16x32_bf16 v[232:235], v[152:155], v[104:107], v[232:235]
    ds_read_b128 v[188:191], v8 offset:60416
    v_mfma_f32_16x16x32_bf16 v[232:235], v[156:159], v[108:111], v[232:235]
    s_barrier
    ds_read_b128 v[144:147], v8 offset:61440
    s_waitcnt lgkmcnt(7)
    v_mfma_f32_16x16x32_bf16 v[232:235], v[160:163], v[112:115], v[232:235]
    ds_read_b128 v[148:151], v8 offset:62464
    v_mfma_f32_16x16x32_bf16 v[232:235], v[164:167], v[116:119], v[232:235]
    ds_read_b128 v[152:155], v8 offset:63488
    s_waitcnt lgkmcnt(7)
    v_mfma_f32_16x16x32_bf16 v[232:235], v[168:171], v[120:123], v[232:235]
    ds_read_b128 v[156:159], v8 offset:64512
    v_mfma_f32_16x16x32_bf16 v[232:235], v[172:175], v[124:127], v[232:235]
    ds_read_b128 v[160:163], v9 offset:0
    s_waitcnt lgkmcnt(7)
    v_mfma_f32_16x16x32_bf16 v[232:235], v[176:179], v[128:131], v[232:235]
    ds_read_b128 v[164:167], v9 offset:1024
    v_mfma_f32_16x16x32_bf16 v[232:235], v[180:183], v[132:135], v[232:235]
    ds_read_b128 v[168:171], v9 offset:2048
    s_waitcnt lgkmcnt(7)
    v_mfma_f32_16x16x32_bf16 v[232:235], v[184:187], v[136:139], v[232:235]
    ds_read_b128 v[172:175], v9 offset:3072
    v_mfma_f32_16x16x32_bf16 v[232:235], v[188:191], v[140:143], v[232:235]
    ds_read_b128 v[176:179], v9 offset:4096
    s_waitcnt lgkmcnt(7)
    v_mfma_f32_16x16x32_bf16 v[236:239], v[144:147], v[64:67], 0
    ds_read_b128 v[180:183], v9 offset:5120
    v_mfma_f32_16x16x32_bf16 v[236:239], v[148:151], v[68:71], v[236:239]
    ds_read_b128 v[184:187], v9 offset:6144
    s_waitcnt lgkmcnt(7)
    v_mfma_f32_16x16x32_bf16 v[236:239], v[152:155], v[72:75], v[236:239]
    ds_read_b128 v[188:191], v9 offset:7168
    v_mfma_f32_16x16x32_bf16 v[236:239], v[156:159], v[76:79], v[236:239]
    v_fma_f32 v32, -v24, v200, v232
    v_fma_f32 v33, -v24, v201, v233
    v_fma_f32 v34, -v24, v202, v234
    v_fma_f32 v35, -v24, v203, v235
    v_mul_f32 v32, v26, v32
    v_mul_f32 v33, v26, v33
    v_mul_f32 v34, v26, v34
    v_mul_f32 v35, v26, v35
    v_cvt_pk_bf16_f32 v30, v32, v33
    v_cvt_pk_bf16_f32 v31, v34, v35
    buffer_store_dwordx2 v[30:31], v56, s[52:55], s78 offen sc0 sc1
    ds_read_b128 v[144:147], v9 offset:8192
    s_waitcnt lgkmcnt(7)
    v_mfma_f32_16x16x32_bf16 v[236:239], v[160:163], v[80:83], v[236:239]
    ds_read_b128 v[148:151], v9 offset:9216
    v_mfma_f32_16x16x32_bf16 v[236:239], v[164:167], v[84:87], v[236:239]
    ds_read_b128 v[152:155], v9 offset:10240
    s_waitcnt lgkmcnt(7)
    v_mfma_f32_16x16x32_bf16 v[236:239], v[168:171], v[88:91], v[236:239]
    ds_read_b128 v[156:159], v9 offset:11264
    v_mfma_f32_16x16x32_bf16 v[236:239], v[172:175], v[92:95], v[236:239]
    ds_read_b128 v[160:163], v9 offset:12288
    s_waitcnt lgkmcnt(7)
    v_mfma_f32_16x16x32_bf16 v[236:239], v[176:179], v[96:99], v[236:239]
    ds_read_b128 v[164:167], v9 offset:13312
    v_mfma_f32_16x16x32_bf16 v[236:239], v[180:183], v[100:103], v[236:239]
    ds_read_b128 v[168:171], v9 offset:14336
    s_waitcnt lgkmcnt(7)
    v_mfma_f32_16x16x32_bf16 v[236:239], v[184:187], v[104:107], v[236:239]
    ds_read_b128 v[172:175], v9 offset:15360
    v_mfma_f32_16x16x32_bf16 v[236:239], v[188:191], v[108:111], v[236:239]
    s_barrier
    ds_read_b128 v[176:179], v7 offset:0
    s_waitcnt lgkmcnt(7)
    v_mfma_f32_16x16x32_bf16 v[236:239], v[144:147], v[112:115], v[236:239]
    ds_read_b128 v[180:183], v7 offset:1024
    v_mfma_f32_16x16x32_bf16 v[236:239], v[148:151], v[116:119], v[236:239]
    ds_read_b128 v[184:187], v7 offset:2048
    s_waitcnt lgkmcnt(7)
    v_mfma_f32_16x16x32_bf16 v[236:239], v[152:155], v[120:123], v[236:239]
    ds_read_b128 v[188:191], v7 offset:3072
    v_mfma_f32_16x16x32_bf16 v[236:239], v[156:159], v[124:127], v[236:239]
    ds_read_b128 v[144:147], v7 offset:4096
    s_waitcnt lgkmcnt(7)
    v_mfma_f32_16x16x32_bf16 v[236:239], v[160:163], v[128:131], v[236:239]
    ds_read_b128 v[148:151], v7 offset:5120
    v_mfma_f32_16x16x32_bf16 v[236:239], v[164:167], v[132:135], v[236:239]
    ds_read_b128 v[152:155], v7 offset:6144
    s_waitcnt lgkmcnt(7)
    v_mfma_f32_16x16x32_bf16 v[236:239], v[168:171], v[136:139], v[236:239]
    ds_read_b128 v[156:159], v7 offset:7168
    v_mfma_f32_16x16x32_bf16 v[236:239], v[172:175], v[140:143], v[236:239]
    ds_read_b128 v[160:163], v7 offset:8192
    s_waitcnt lgkmcnt(7)
    v_mfma_f32_16x16x32_bf16 v[240:243], v[176:179], v[64:67], 0
    ds_read_b128 v[164:167], v7 offset:9216
    v_mfma_f32_16x16x32_bf16 v[240:243], v[180:183], v[68:71], v[240:243]
    ds_read_b128 v[168:171], v7 offset:10240
    s_waitcnt lgkmcnt(7)
    v_mfma_f32_16x16x32_bf16 v[240:243], v[184:187], v[72:75], v[240:243]
    ds_read_b128 v[172:175], v7 offset:11264
    v_mfma_f32_16x16x32_bf16 v[240:243], v[188:191], v[76:79], v[240:243]
    v_fma_f32 v32, -v24, v204, v236
    v_fma_f32 v33, -v24, v205, v237
    v_fma_f32 v34, -v24, v206, v238
    v_fma_f32 v35, -v24, v207, v239
    v_mul_f32 v32, v25, v32
    v_mul_f32 v33, v25, v33
    v_mul_f32 v34, v25, v34
    v_mul_f32 v35, v25, v35
    v_cvt_pk_bf16_f32 v30, v32, v33
    v_cvt_pk_bf16_f32 v31, v34, v35
    buffer_store_dwordx2 v[30:31], v11, s[56:59], s79 offen
    v_lshlrev_b32 v32, 16, v30
    v_and_b32 v33, 0xffff0000, v30
    v_lshlrev_b32 v34, 16, v31
    v_and_b32 v35, 0xffff0000, v31
    v_mul_f32 v36, v32, v32
    v_fma_f32 v36, v33, v33, v36
    v_fma_f32 v36, v34, v34, v36
    v_fma_f32 v36, v35, v35, v36
    s_barrier
    ds_read_b128 v[176:179], v7 offset:12288
    s_waitcnt lgkmcnt(7)
    v_mfma_f32_16x16x32_bf16 v[240:243], v[144:147], v[80:83], v[240:243]
    ds_read_b128 v[180:183], v7 offset:13312
    v_mfma_f32_16x16x32_bf16 v[240:243], v[148:151], v[84:87], v[240:243]
    ds_read_b128 v[184:187], v7 offset:14336
    s_waitcnt lgkmcnt(7)
    v_mfma_f32_16x16x32_bf16 v[240:243], v[152:155], v[88:91], v[240:243]
    ds_read_b128 v[188:191], v7 offset:15360
    v_mfma_f32_16x16x32_bf16 v[240:243], v[156:159], v[92:95], v[240:243]
    ds_read_b128 v[144:147], v7 offset:16384
    s_waitcnt lgkmcnt(7)
    v_mfma_f32_16x16x32_bf16 v[240:243], v[160:163], v[96:99], v[240:243]
    ds_read_b128 v[148:151], v7 offset:17408
    v_mfma_f32_16x16x32_bf16 v[240:243], v[164:167], v[100:103], v[240:243]
    ds_read_b128 v[152:155], v7 offset:18432
    s_waitcnt lgkmcnt(7)
    v_mfma_f32_16x16x32_bf16 v[240:243], v[168:171], v[104:107], v[240:243]
    ds_read_b128 v[156:159], v7 offset:19456
    v_mfma_f32_16x16x32_bf16 v[240:243], v[172:175], v[108:111], v[240:243]
    s_waitcnt lgkmcnt(6)
    v_mfma_f32_16x16x32_bf16 v[240:243], v[176:179], v[112:115], v[240:243]
    v_mfma_f32_16x16x32_bf16 v[240:243], v[180:183], v[116:119], v[240:243]
    s_waitcnt lgkmcnt(4)
    v_mfma_f32_16x16x32_bf16 v[240:243], v[184:187], v[120:123], v[240:243]
    v_mfma_f32_16x16x32_bf16 v[240:243], v[188:191], v[124:127], v[240:243]
    s_waitcnt lgkmcnt(2)
    v_mfma_f32_16x16x32_bf16 v[240:243], v[144:147], v[128:131], v[240:243]
    v_mfma_f32_16x16x32_bf16 v[240:243], v[148:151], v[132:135], v[240:243]
    s_waitcnt lgkmcnt(0)
    v_mfma_f32_16x16x32_bf16 v[240:243], v[152:155], v[136:139], v[240:243]
    v_mfma_f32_16x16x32_bf16 v[240:243], v[156:159], v[140:143], v[240:243]
    s_nop 7
    v_fma_f32 v32, -v24, v208, v240
    v_fma_f32 v33, -v24, v209, v241
    v_fma_f32 v34, -v24, v210, v242
    v_fma_f32 v35, -v24, v211, v243
    v_mul_f32 v32, v25, v32
    v_mul_f32 v33, v25, v33
    v_mul_f32 v34, v25, v34
    v_mul_f32 v35, v25, v35
    v_cvt_pk_bf16_f32 v30, v32, v33
    v_cvt_pk_bf16_f32 v31, v34, v35
    s_mov_b64 exec, s[72:73]
    buffer_store_dwordx2 v[30:31], v23, s[56:59], s79 offen
    s_mov_b64 exec, -1
    v_lshlrev_b32 v32, 16, v30
    v_and_b32 v33, 0xffff0000, v30
    v_lshlrev_b32 v34, 16, v31
    v_and_b32 v35, 0xffff0000, v31
    v_fma_f32 v36, v32, v32, v36
    v_fma_f32 v36, v33, v33, v36
    v_fma_f32 v36, v34, v34, v36
    v_fma_f32 v36, v35, v35, v36
    v_mov_b32 v37, v36
    s_nop 1
    v_permlane16_swap_b32 v36, v37
    v_add_f32 v36, v36, v37
    v_mov_b32 v37, v36
    s_nop 1
    v_permlane32_swap_b32 v36, v37
    v_add_f32 v36, v36, v37
    s_nop 1
    v_max_f32_dpp v36, v36, v36 row_ror:1 row_mask:0xf bank_mask:0xf
    s_nop 1
    v_max_f32_dpp v36, v36, v36 row_ror:2 row_mask:0xf bank_mask:0xf
    s_nop 1
    v_max_f32_dpp v36, v36, v36 row_ror:4 row_mask:0xf bank_mask:0xf
    s_nop 1
    v_max_f32_dpp v36, v36, v36 row_ror:8 row_mask:0xf bank_mask:0xf
    s_mov_b64 exec, s[74:75]
    buffer_store_dword v36, v38, s[64:67], s19 offen
    s_endpgm
qkv_v:
    v_lshlrev_b32 v10, 2, v5
    buffer_load_dword v48, v10, s[64:67], s14 offen offset:192
    buffer_load_dword v49, v10, s[64:67], s14 offen offset:256
    v_lshlrev_b32 v23, 1, v6
    v_lshrrev_b32 v11, 1, v6
    v_or_b32 v23, v23, v11
    v_and_b32 v23, 3, v23
    v_lshlrev_b32 v23, 2, v23
    s_and_b32 s19, s15, 127
    v_add_u32 v23, s19, v23
    v_lshrrev_b32 v11, 3, v23
    v_xor_b32 v11, v11, v5
    v_lshlrev_b32 v11, 4, v11
    v_and_b32 v23, 4, v23
    v_lshl_add_u32 v11, v23, 1, v11
    v_lshl_add_u32 v11, v5, 8, v11
    v_add_u32 v11, 5120, v11
    v_add_u32 v23, 4096, v11
    v_cmp_gt_u32 s[72:73], 4, v5
    v_lshlrev_b32 v21, 4, v6
    s_barrier
    ds_read_b64_tr_b16 v[64:65], v12 offset:0
    ds_read_b64_tr_b16 v[66:67], v12 offset:512
    ds_read_b128 v[144:147], v8 offset:0
    ds_read_b128 v[148:151], v8 offset:1024
    ds_read_b64_tr_b16 v[68:69], v12 offset:4096
    ds_read_b64_tr_b16 v[70:71], v12 offset:4608
    ds_read_b128 v[152:155], v8 offset:2048
    ds_read_b128 v[156:159], v8 offset:3072
    s_barrier
    ds_read_b64_tr_b16 v[72:73], v12 offset:8192
    ds_read_b64_tr_b16 v[74:75], v12 offset:8704
    ds_read_b128 v[160:163], v8 offset:4096
    ds_read_b128 v[164:167], v8 offset:5120
    s_waitcnt lgkmcnt(9)
    v_mfma_f32_16x16x32_bf16 v[216:219], v[64:67], v[64:67], 0
    v_mfma_f32_16x16x32_bf16 v[220:223], v[16:19], v[64:67], 0
    ds_read_b64_tr_b16 v[76:77], v12 offset:12288
    ds_read_b64_tr_b16 v[78:79], v12 offset:12800
    v_mfma_f32_16x16x32_bf16 v[224:227], v[144:147], v[64:67], 0
    ds_read_b128 v[168:171], v8 offset:6144
    s_waitcnt lgkmcnt(9)
    v_mfma_f32_16x16x32_bf16 v[228:231], v[148:151], v[64:67], 0
    ds_read_b128 v[172:175], v8 offset:7168
    v_mfma_f32_16x16x32_bf16 v[216:219], v[68:71], v[68:71], v[216:219]
    v_mfma_f32_16x16x32_bf16 v[220:223], v[16:19], v[68:71], v[220:223]
    s_barrier
    ds_read_b64_tr_b16 v[80:81], v12 offset:16384
    ds_read_b64_tr_b16 v[82:83], v12 offset:16896
    s_waitcnt lgkmcnt(10)
    v_mfma_f32_16x16x32_bf16 v[224:227], v[152:155], v[68:71], v[224:227]
    ds_read_b128 v[176:179], v8 offset:8192
    v_mfma_f32_16x16x32_bf16 v[228:231], v[156:159], v[68:71], v[228:231]
    ds_read_b128 v[180:183], v8 offset:9216
    s_waitcnt lgkmcnt(9)
    v_mfma_f32_16x16x32_bf16 v[216:219], v[72:75], v[72:75], v[216:219]
    v_mfma_f32_16x16x32_bf16 v[220:223], v[16:19], v[72:75], v[220:223]
    ds_read_b64_tr_b16 v[84:85], v12 offset:20480
    ds_read_b64_tr_b16 v[86:87], v12 offset:20992
    v_mfma_f32_16x16x32_bf16 v[224:227], v[160:163], v[72:75], v[224:227]
    ds_read_b128 v[184:187], v8 offset:10240
    s_waitcnt lgkmcnt(9)
    v_mfma_f32_16x16x32_bf16 v[228:231], v[164:167], v[72:75], v[228:231]
    ds_read_b128 v[188:191], v8 offset:11264
    v_mfma_f32_16x16x32_bf16 v[216:219], v[76:79], v[76:79], v[216:219]
    v_mfma_f32_16x16x32_bf16 v[220:223], v[16:19], v[76:79], v[220:223]
    ds_read_b64_tr_b16 v[88:89], v12 offset:24576
    ds_read_b64_tr_b16 v[90:91], v12 offset:25088
    s_waitcnt lgkmcnt(10)
    v_mfma_f32_16x16x32_bf16 v[224:227], v[168:171], v[76:79], v[224:227]
    ds_read_b128 v[144:147], v8 offset:12288
    v_mfma_f32_16x16x32_bf16 v[228:231], v[172:175], v[76:79], v[228:231]
    ds_read_b128 v[148:151], v8 offset:13312
    s_waitcnt lgkmcnt(9)
    v_mfma_f32_16x16x32_bf16 v[216:219], v[80:83], v[80:83], v[216:219]
    v_mfma_f32_16x16x32_bf16 v[220:223], v[16:19], v[80:83], v[220:223]
    ds_read_b64_tr_b16 v[92:93], v12 offset:28672
    ds_read_b64_tr_b16 v[94:95], v12 offset:29184
    v_mfma_f32_16x16x32_bf16 v[224:227], v[176:179], v[80:83], v[224:227]
    ds_read_b128 v[152:155], v8 offset:14336
    s_waitcnt lgkmcnt(9)
    v_mfma_f32_16x16x32_bf16 v[228:231], v[180:183], v[80:83], v[228:231]
    ds_read_b128 v[156:159], v8 offset:15360
    v_mfma_f32_16x16x32_bf16 v[216:219], v[84:87], v[84:87], v[216:219]
    v_mfma_f32_16x16x32_bf16 v[220:223], v[16:19], v[84:87], v[220:223]
    s_barrier
    ds_read_b64_tr_b16 v[96:97], v12 offset:32768
    ds_read_b64_tr_b16 v[98:99], v12 offset:33280
    s_waitcnt lgkmcnt(10)
    v_mfma_f32_16x16x32_bf16 v[224:227], v[184:187], v[84:87], v[224:227]
    ds_read_b128 v[160:163], v8 offset:16384
    v_mfma_f32_16x16x32_bf16 v[228:231], v[188:191], v[84:87], v[228:231]
    ds_read_b128 v[164:167], v8 offset:17408
    s_waitcnt lgkmcnt(9)
    v_mfma_f32_16x16x32_bf16 v[216:219], v[88:91], v[88:91], v[216:219]
    v_mfma_f32_16x16x32_bf16 v[220:223], v[16:19], v[88:91], v[220:223]
    ds_read_b64_tr_b16 v[100:101], v12 offset:36864
    ds_read_b64_tr_b16 v[102:103], v12 offset:37376
    v_mfma_f32_16x16x32_bf16 v[224:227], v[144:147], v[88:91], v[224:227]
    ds_read_b128 v[168:171], v8 offset:18432
    s_waitcnt lgkmcnt(9)
    v_mfma_f32_16x16x32_bf16 v[228:231], v[148:151], v[88:91], v[228:231]
    ds_read_b128 v[172:175], v8 offset:19456
    v_mfma_f32_16x16x32_bf16 v[216:219], v[92:95], v[92:95], v[216:219]
    v_mfma_f32_16x16x32_bf16 v[220:223], v[16:19], v[92:95], v[220:223]
    ds_read_b64_tr_b16 v[104:105], v13 offset:0
    ds_read_b64_tr_b16 v[106:107], v13 offset:512
    s_waitcnt lgkmcnt(10)
    v_mfma_f32_16x16x32_bf16 v[224:227], v[152:155], v[92:95], v[224:227]
    ds_read_b128 v[176:179], v8 offset:20480
    v_mfma_f32_16x16x32_bf16 v[228:231], v[156:159], v[92:95], v[228:231]
    ds_read_b128 v[180:183], v8 offset:21504
    s_waitcnt lgkmcnt(9)
    v_mfma_f32_16x16x32_bf16 v[216:219], v[96:99], v[96:99], v[216:219]
    v_mfma_f32_16x16x32_bf16 v[220:223], v[16:19], v[96:99], v[220:223]
    ds_read_b64_tr_b16 v[108:109], v13 offset:4096
    ds_read_b64_tr_b16 v[110:111], v13 offset:4608
    v_mfma_f32_16x16x32_bf16 v[224:227], v[160:163], v[96:99], v[224:227]
    ds_read_b128 v[184:187], v8 offset:22528
    s_waitcnt lgkmcnt(9)
    v_mfma_f32_16x16x32_bf16 v[228:231], v[164:167], v[96:99], v[228:231]
    ds_read_b128 v[188:191], v8 offset:23552
    v_mfma_f32_16x16x32_bf16 v[216:219], v[100:103], v[100:103], v[216:219]
    v_mfma_f32_16x16x32_bf16 v[220:223], v[16:19], v[100:103], v[220:223]
    s_barrier
    ds_read_b64_tr_b16 v[112:113], v13 offset:8192
    ds_read_b64_tr_b16 v[114:115], v13 offset:8704
    s_waitcnt lgkmcnt(10)
    v_mfma_f32_16x16x32_bf16 v[224:227], v[168:171], v[100:103], v[224:227]
    ds_read_b128 v[144:147], v8 offset:24576
    v_mfma_f32_16x16x32_bf16 v[228:231], v[172:175], v[100:103], v[228:231]
    ds_read_b128 v[148:151], v8 offset:25600
    s_waitcnt lgkmcnt(9)
    v_mfma_f32_16x16x32_bf16 v[216:219], v[104:107], v[104:107], v[216:219]
    v_mfma_f32_16x16x32_bf16 v[220:223], v[16:19], v[104:107], v[220:223]
    ds_read_b64_tr_b16 v[116:117], v13 offset:12288
    ds_read_b64_tr_b16 v[118:119], v13 offset:12800
    v_mfma_f32_16x16x32_bf16 v[224:227], v[176:179], v[104:107], v[224:227]
    ds_read_b128 v[152:155], v8 offset:26624
    s_waitcnt lgkmcnt(9)
    v_mfma_f32_16x16x32_bf16 v[228:231], v[180:183], v[104:107], v[228:231]
    ds_read_b128 v[156:159], v8 offset:27648
    v_mfma_f32_16x16x32_bf16 v[216:219], v[108:111], v[108:111], v[216:219]
    v_mfma_f32_16x16x32_bf16 v[220:223], v[16:19], v[108:111], v[220:223]
    ds_read_b64_tr_b16 v[120:121], v13 offset:16384
    ds_read_b64_tr_b16 v[122:123], v13 offset:16896
    s_waitcnt lgkmcnt(10)
    v_mfma_f32_16x16x32_bf16 v[224:227], v[184:187], v[108:111], v[224:227]
    ds_read_b128 v[160:163], v8 offset:28672
    v_mfma_f32_16x16x32_bf16 v[228:231], v[188:191], v[108:111], v[228:231]
    ds_read_b128 v[164:167], v8 offset:29696
    s_waitcnt lgkmcnt(9)
    v_mfma_f32_16x16x32_bf16 v[216:219], v[112:115], v[112:115], v[216:219]
    v_mfma_f32_16x16x32_bf16 v[220:223], v[16:19], v[112:115], v[220:223]
    ds_read_b64_tr_b16 v[124:125], v13 offset:20480
    ds_read_b64_tr_b16 v[126:127], v13 offset:20992
    v_mfma_f32_16x16x32_bf16 v[224:227], v[144:147], v[112:115], v[224:227]
    ds_read_b128 v[168:171], v8 offset:30720
    s_waitcnt lgkmcnt(9)
    v_mfma_f32_16x16x32_bf16 v[228:231], v[148:151], v[112:115], v[228:231]
    ds_read_b128 v[172:175], v8 offset:31744
    v_mfma_f32_16x16x32_bf16 v[216:219], v[116:119], v[116:119], v[216:219]
    v_mfma_f32_16x16x32_bf16 v[220:223], v[16:19], v[116:119], v[220:223]
    s_barrier
    ds_read_b64_tr_b16 v[128:129], v13 offset:24576
    ds_read_b64_tr_b16 v[130:131], v13 offset:25088
    s_waitcnt lgkmcnt(10)
    v_mfma_f32_16x16x32_bf16 v[224:227], v[152:155], v[116:119], v[224:227]
    ds_read_b128 v[176:179], v8 offset:32768
    v_mfma_f32_16x16x32_bf16 v[228:231], v[156:159], v[116:119], v[228:231]
    ds_read_b128 v[180:183], v8 offset:33792
    s_waitcnt lgkmcnt(9)
    v_mfma_f32_16x16x32_bf16 v[216:219], v[120:123], v[120:123], v[216:219]
    v_mfma_f32_16x16x32_bf16 v[220:223], v[16:19], v[120:123], v[220:223]
    ds_read_b64_tr_b16 v[132:133], v13 offset:28672
    ds_read_b64_tr_b16 v[134:135], v13 offset:29184
    v_mfma_f32_16x16x32_bf16 v[224:227], v[160:163], v[120:123], v[224:227]
    ds_read_b128 v[184:187], v8 offset:34816
    s_waitcnt lgkmcnt(9)
    v_mfma_f32_16x16x32_bf16 v[228:231], v[164:167], v[120:123], v[228:231]
    ds_read_b128 v[188:191], v8 offset:35840
    v_mfma_f32_16x16x32_bf16 v[216:219], v[124:127], v[124:127], v[216:219]
    v_mfma_f32_16x16x32_bf16 v[220:223], v[16:19], v[124:127], v[220:223]
    ds_read_b64_tr_b16 v[136:137], v13 offset:32768
    ds_read_b64_tr_b16 v[138:139], v13 offset:33280
    s_waitcnt lgkmcnt(10)
    v_mfma_f32_16x16x32_bf16 v[224:227], v[168:171], v[124:127], v[224:227]
    ds_read_b128 v[144:147], v8 offset:36864
    v_mfma_f32_16x16x32_bf16 v[228:231], v[172:175], v[124:127], v[228:231]
    ds_read_b128 v[148:151], v8 offset:37888
    s_waitcnt lgkmcnt(9)
    v_mfma_f32_16x16x32_bf16 v[216:219], v[128:131], v[128:131], v[216:219]
    v_mfma_f32_16x16x32_bf16 v[220:223], v[16:19], v[128:131], v[220:223]
    ds_read_b64_tr_b16 v[140:141], v13 offset:36864
    ds_read_b64_tr_b16 v[142:143], v13 offset:37376
    v_mfma_f32_16x16x32_bf16 v[224:227], v[176:179], v[128:131], v[224:227]
    ds_read_b128 v[152:155], v8 offset:38912
    s_waitcnt lgkmcnt(9)
    v_mfma_f32_16x16x32_bf16 v[228:231], v[180:183], v[128:131], v[228:231]
    ds_read_b128 v[156:159], v8 offset:39936
    v_mfma_f32_16x16x32_bf16 v[216:219], v[132:135], v[132:135], v[216:219]
    v_mfma_f32_16x16x32_bf16 v[220:223], v[16:19], v[132:135], v[220:223]
    s_barrier
    ds_read_b128 v[160:163], v8 offset:40960
    s_waitcnt lgkmcnt(9)
    v_mfma_f32_16x16x32_bf16 v[224:227], v[184:187], v[132:135], v[224:227]
    ds_read_b128 v[164:167], v8 offset:41984
    v_mfma_f32_16x16x32_bf16 v[228:231], v[188:191], v[132:135], v[228:231]
    ds_read_b128 v[168:171], v8 offset:43008
    s_waitcnt lgkmcnt(8)
    v_mfma_f32_16x16x32_bf16 v[216:219], v[136:139], v[136:139], v[216:219]
    v_mfma_f32_16x16x32_bf16 v[220:223], v[16:19], v[136:139], v[220:223]
    ds_read_b128 v[172:175], v8 offset:44032
    v_mfma_f32_16x16x32_bf16 v[224:227], v[144:147], v[136:139], v[224:227]
    ds_read_b128 v[176:179], v8 offset:45056
    s_waitcnt lgkmcnt(7)
    v_mfma_f32_16x16x32_bf16 v[228:231], v[148:151], v[136:139], v[228:231]
    ds_read_b128 v[180:183], v8 offset:46080
    v_mfma_f32_16x16x32_bf16 v[216:219], v[140:143], v[140:143], v[216:219]
    v_mfma_f32_16x16x32_bf16 v[220:223], v[16:19], v[140:143], v[220:223]
    ds_read_b128 v[184:187], v8 offset:47104
    s_waitcnt lgkmcnt(7)
    v_mfma_f32_16x16x32_bf16 v[224:227], v[152:155], v[140:143], v[224:227]
    ds_read_b128 v[188:191], v8 offset:48128
    v_mfma_f32_16x16x32_bf16 v[228:231], v[156:159], v[140:143], v[228:231]
    ds_read_b128 v[144:147], v8 offset:49152
    s_waitcnt lgkmcnt(7)
    v_mfma_f32_16x16x32_bf16 v[232:235], v[160:163], v[64:67], 0
    ds_read_b128 v[148:151], v8 offset:50176
    v_mfma_f32_16x16x32_bf16 v[232:235], v[164:167], v[68:71], v[232:235]
    v_cndmask_b32 v20, v216, v217, s[80:81]
    v_cndmask_b32 v20, v20, v218, s[68:69]
    v_cndmask_b32 v20, v20, v219, s[70:71]
    ds_bpermute_b32 v22, v15, v20
    ds_read_b128 v[152:155], v8 offset:51200
    s_waitcnt lgkmcnt(8)
    v_mfma_f32_16x16x32_bf16 v[232:235], v[168:171], v[72:75], v[232:235]
    ds_read_b128 v[156:159], v8 offset:52224
    v_mfma_f32_16x16x32_bf16 v[232:235], v[172:175], v[76:79], v[232:235]
    ds_read_b128 v[160:163], v8 offset:53248
    s_waitcnt lgkmcnt(8)
    v_mfma_f32_16x16x32_bf16 v[232:235], v[176:179], v[80:83], v[232:235]
    ds_read_b128 v[164:167], v8 offset:54272
    v_mfma_f32_16x16x32_bf16 v[232:235], v[180:183], v[84:87], v[232:235]
    s_waitcnt lgkmcnt(4)
    v_mul_f32 v24, 0x3acccccd, v220
    v_mul_f32 v26, 0x3acccccd, v22
    v_fma_f32 v26, -v24, v24, v26
    v_max_f32 v26, 0, v26
    v_cvt_pk_bf16_f32 v26, v26, v26
    v_lshlrev_b32 v26, 16, v26
    v_add_f32 v26, 0x3727c5ac, v26
    v_cvt_pk_bf16_f32 v26, v26, v26
    v_lshlrev_b32 v26, 16, v26
    v_sqrt_f32 v26, v26
    v_cvt_pk_bf16_f32 v24, v24, v24
    v_lshlrev_b32 v24, 16, v24
    v_cvt_pk_bf16_f32 v26, v26, v26
    v_lshlrev_b32 v26, 16, v26
    v_rcp_f32 v25, v26
    s_nop 0
    v_mul_f32 v26, 1051011932, v25
    s_waitcnt vmcnt(0)
    ds_bpermute_b32 v40, v21, v24 offset:0
    ds_bpermute_b32 v44, v21, v25 offset:0
    ds_bpermute_b32 v41, v21, v24 offset:4
    ds_bpermute_b32 v45, v21, v25 offset:4
    ds_bpermute_b32 v42, v21, v24 offset:8
    ds_bpermute_b32 v46, v21, v25 offset:8
    ds_bpermute_b32 v43, v21, v24 offset:12
    ds_bpermute_b32 v47, v21, v25 offset:12
    v_fma_f32 v32, -v24, v192, v224
    v_fma_f32 v33, -v24, v193, v225
    v_fma_f32 v34, -v24, v194, v226
    v_fma_f32 v35, -v24, v195, v227
    v_mul_f32 v32, v26, v32
    v_mul_f32 v33, v26, v33
    v_mul_f32 v34, v26, v34
    v_mul_f32 v35, v26, v35
    v_cvt_pk_bf16_f32 v30, v32, v33
    v_cvt_pk_bf16_f32 v31, v34, v35
    buffer_store_dwordx2 v[30:31], v54, s[52:55], s78 offen sc0 sc1
    v_fma_f32 v32, -v24, v196, v228
    v_fma_f32 v33, -v24, v197, v229
    v_fma_f32 v34, -v24, v198, v230
    v_fma_f32 v35, -v24, v199, v231
    v_mul_f32 v32, v26, v32
    v_mul_f32 v33, v26, v33
    v_mul_f32 v34, v26, v34
    v_mul_f32 v35, v26, v35
    v_cvt_pk_bf16_f32 v30, v32, v33
    v_cvt_pk_bf16_f32 v31, v34, v35
    buffer_store_dwordx2 v[30:31], v55, s[52:55], s78 offen sc0 sc1
    ds_read_b128 v[168:171], v8 offset:55296
    v_mfma_f32_16x16x32_bf16 v[232:235], v[184:187], v[88:91], v[232:235]
    ds_read_b128 v[172:175], v8 offset:56320
    v_mfma_f32_16x16x32_bf16 v[232:235], v[188:191], v[92:95], v[232:235]
    ds_read_b128 v[176:179], v8 offset:57344
    v_mfma_f32_16x16x32_bf16 v[232:235], v[144:147], v[96:99], v[232:235]
    ds_read_b128 v[180:183], v8 offset:58368
    v_mfma_f32_16x16x32_bf16 v[232:235], v[148:151], v[100:103], v[232:235]
    ds_read_b128 v[184:187], v8 offset:59392
    s_waitcnt lgkmcnt(15)
    v_mfma_f32_16x16x32_bf16 v[232:235], v[152:155], v[104:107], v[232:235]
    ds_read_b128 v[188:191], v8 offset:60416
    v_mfma_f32_16x16x32_bf16 v[232:235], v[156:159], v[108:111], v[232:235]
    s_barrier
    ds_read_b128 v[144:147], v8 offset:61440
    s_waitcnt lgkmcnt(15)
    v_mfma_f32_16x16x32_bf16 v[232:235], v[160:163], v[112:115], v[232:235]
    ds_read_b128 v[148:151], v8 offset:62464
    v_mfma_f32_16x16x32_bf16 v[232:235], v[164:167], v[116:119], v[232:235]
    ds_read_b128 v[152:155], v8 offset:63488
    s_waitcnt lgkmcnt(7)
    v_mfma_f32_16x16x32_bf16 v[232:235], v[168:171], v[120:123], v[232:235]
    ds_read_b128 v[156:159], v8 offset:64512
    v_mfma_f32_16x16x32_bf16 v[232:235], v[172:175], v[124:127], v[232:235]
    ds_read_b128 v[160:163], v9 offset:0
    s_waitcnt lgkmcnt(7)
    v_mfma_f32_16x16x32_bf16 v[232:235], v[176:179], v[128:131], v[232:235]
    ds_read_b128 v[164:167], v9 offset:1024
    v_mfma_f32_16x16x32_bf16 v[232:235], v[180:183], v[132:135], v[232:235]
    ds_read_b128 v[168:171], v9 offset:2048
    s_waitcnt lgkmcnt(7)
    v_mfma_f32_16x16x32_bf16 v[232:235], v[184:187], v[136:139], v[232:235]
    ds_read_b128 v[172:175], v9 offset:3072
    v_mfma_f32_16x16x32_bf16 v[232:235], v[188:191], v[140:143], v[232:235]
    ds_read_b128 v[176:179], v9 offset:4096
    s_waitcnt lgkmcnt(7)
    v_mfma_f32_16x16x32_bf16 v[236:239], v[64:67], v[144:147], 0
    ds_read_b128 v[180:183], v9 offset:5120
    v_mfma_f32_16x16x32_bf16 v[236:239], v[68:71], v[148:151], v[236:239]
    ds_read_b128 v[184:187], v9 offset:6144
    s_waitcnt lgkmcnt(7)
    v_mfma_f32_16x16x32_bf16 v[236:239], v[72:75], v[152:155], v[236:239]
    ds_read_b128 v[188:191], v9 offset:7168
    v_mfma_f32_16x16x32_bf16 v[236:239], v[76:79], v[156:159], v[236:239]
    v_fma_f32 v32, -v24, v200, v232
    v_fma_f32 v33, -v24, v201, v233
    v_fma_f32 v34, -v24, v202, v234
    v_fma_f32 v35, -v24, v203, v235
    v_mul_f32 v32, v26, v32
    v_mul_f32 v33, v26, v33
    v_mul_f32 v34, v26, v34
    v_mul_f32 v35, v26, v35
    v_cvt_pk_bf16_f32 v30, v32, v33
    v_cvt_pk_bf16_f32 v31, v34, v35
    buffer_store_dwordx2 v[30:31], v56, s[52:55], s78 offen sc0 sc1
    ds_read_b128 v[144:147], v9 offset:8192
    s_waitcnt lgkmcnt(7)
    v_mfma_f32_16x16x32_bf16 v[236:239], v[80:83], v[160:163], v[236:239]
    ds_read_b128 v[148:151], v9 offset:9216
    v_mfma_f32_16x16x32_bf16 v[236:239], v[84:87], v[164:167], v[236:239]
    ds_read_b128 v[152:155], v9 offset:10240
    s_waitcnt lgkmcnt(7)
    v_mfma_f32_16x16x32_bf16 v[236:239], v[88:91], v[168:171], v[236:239]
    ds_read_b128 v[156:159], v9 offset:11264
    v_mfma_f32_16x16x32_bf16 v[236:239], v[92:95], v[172:175], v[236:239]
    ds_read_b128 v[160:163], v9 offset:12288
    s_waitcnt lgkmcnt(7)
    v_mfma_f32_16x16x32_bf16 v[236:239], v[96:99], v[176:179], v[236:239]
    ds_read_b128 v[164:167], v9 offset:13312
    v_mfma_f32_16x16x32_bf16 v[236:239], v[100:103], v[180:183], v[236:239]
    ds_read_b128 v[168:171], v9 offset:14336
    s_waitcnt lgkmcnt(7)
    v_mfma_f32_16x16x32_bf16 v[236:239], v[104:107], v[184:187], v[236:239]
    ds_read_b128 v[172:175], v9 offset:15360
    v_mfma_f32_16x16x32_bf16 v[236:239], v[108:111], v[188:191], v[236:239]
    s_barrier
    ds_read_b128 v[176:179], v7 offset:0
    s_waitcnt lgkmcnt(7)
    v_mfma_f32_16x16x32_bf16 v[236:239], v[112:115], v[144:147], v[236:239]
    ds_read_b128 v[180:183], v7 offset:1024
    v_mfma_f32_16x16x32_bf16 v[236:239], v[116:119], v[148:151], v[236:239]
    ds_read_b128 v[184:187], v7 offset:2048
    s_waitcnt lgkmcnt(7)
    v_mfma_f32_16x16x32_bf16 v[236:239], v[120:123], v[152:155], v[236:239]
    ds_read_b128 v[188:191], v7 offset:3072
    v_mfma_f32_16x16x32_bf16 v[236:239], v[124:127], v[156:159], v[236:239]
    ds_read_b128 v[144:147], v7 offset:4096
    s_waitcnt lgkmcnt(7)
    v_mfma_f32_16x16x32_bf16 v[236:239], v[128:131], v[160:163], v[236:239]
    ds_read_b128 v[148:151], v7 offset:5120
    v_mfma_f32_16x16x32_bf16 v[236:239], v[132:135], v[164:167], v[236:239]
    ds_read_b128 v[152:155], v7 offset:6144
    s_waitcnt lgkmcnt(7)
    v_mfma_f32_16x16x32_bf16 v[236:239], v[136:139], v[168:171], v[236:239]
    ds_read_b128 v[156:159], v7 offset:7168
    v_mfma_f32_16x16x32_bf16 v[236:239], v[140:143], v[172:175], v[236:239]
    ds_read_b128 v[160:163], v7 offset:8192
    s_waitcnt lgkmcnt(7)
    v_mfma_f32_16x16x32_bf16 v[240:243], v[64:67], v[176:179], 0
    ds_read_b128 v[164:167], v7 offset:9216
    v_mfma_f32_16x16x32_bf16 v[240:243], v[68:71], v[180:183], v[240:243]
    ds_read_b128 v[168:171], v7 offset:10240
    s_waitcnt lgkmcnt(7)
    v_mfma_f32_16x16x32_bf16 v[240:243], v[72:75], v[184:187], v[240:243]
    ds_read_b128 v[172:175], v7 offset:11264
    v_mfma_f32_16x16x32_bf16 v[240:243], v[76:79], v[188:191], v[240:243]
    v_fma_f32 v32, -v40, v48, v236
    v_fma_f32 v33, -v41, v48, v237
    v_fma_f32 v34, -v42, v48, v238
    v_fma_f32 v35, -v43, v48, v239
    v_mul_f32 v32, v44, v32
    v_mul_f32 v33, v45, v33
    v_mul_f32 v34, v46, v34
    v_mul_f32 v35, v47, v35
    v_cvt_pk_bf16_f32 v30, v32, v33
    v_cvt_pk_bf16_f32 v31, v34, v35
    buffer_store_dwordx2 v[30:31], v11, s[56:59], s79 offen
    s_barrier
    ds_read_b128 v[176:179], v7 offset:12288
    s_waitcnt lgkmcnt(7)
    v_mfma_f32_16x16x32_bf16 v[240:243], v[80:83], v[144:147], v[240:243]
    ds_read_b128 v[180:183], v7 offset:13312
    v_mfma_f32_16x16x32_bf16 v[240:243], v[84:87], v[148:151], v[240:243]
    ds_read_b128 v[184:187], v7 offset:14336
    s_waitcnt lgkmcnt(7)
    v_mfma_f32_16x16x32_bf16 v[240:243], v[88:91], v[152:155], v[240:243]
    ds_read_b128 v[188:191], v7 offset:15360
    v_mfma_f32_16x16x32_bf16 v[240:243], v[92:95], v[156:159], v[240:243]
    ds_read_b128 v[144:147], v7 offset:16384
    s_waitcnt lgkmcnt(7)
    v_mfma_f32_16x16x32_bf16 v[240:243], v[96:99], v[160:163], v[240:243]
    ds_read_b128 v[148:151], v7 offset:17408
    v_mfma_f32_16x16x32_bf16 v[240:243], v[100:103], v[164:167], v[240:243]
    ds_read_b128 v[152:155], v7 offset:18432
    s_waitcnt lgkmcnt(7)
    v_mfma_f32_16x16x32_bf16 v[240:243], v[104:107], v[168:171], v[240:243]
    ds_read_b128 v[156:159], v7 offset:19456
    v_mfma_f32_16x16x32_bf16 v[240:243], v[108:111], v[172:175], v[240:243]
    s_waitcnt lgkmcnt(6)
    v_mfma_f32_16x16x32_bf16 v[240:243], v[112:115], v[176:179], v[240:243]
    v_mfma_f32_16x16x32_bf16 v[240:243], v[116:119], v[180:183], v[240:243]
    s_waitcnt lgkmcnt(4)
    v_mfma_f32_16x16x32_bf16 v[240:243], v[120:123], v[184:187], v[240:243]
    v_mfma_f32_16x16x32_bf16 v[240:243], v[124:127], v[188:191], v[240:243]
    s_waitcnt lgkmcnt(2)
    v_mfma_f32_16x16x32_bf16 v[240:243], v[128:131], v[144:147], v[240:243]
    v_mfma_f32_16x16x32_bf16 v[240:243], v[132:135], v[148:151], v[240:243]
    s_waitcnt lgkmcnt(0)
    v_mfma_f32_16x16x32_bf16 v[240:243], v[136:139], v[152:155], v[240:243]
    v_mfma_f32_16x16x32_bf16 v[240:243], v[140:143], v[156:159], v[240:243]
    s_nop 7
    v_fma_f32 v32, -v40, v49, v240
    v_fma_f32 v33, -v41, v49, v241
    v_fma_f32 v34, -v42, v49, v242
    v_fma_f32 v35, -v43, v49, v243
    v_mul_f32 v32, v44, v32
    v_mul_f32 v33, v45, v33
    v_mul_f32 v34, v46, v34
    v_mul_f32 v35, v47, v35
    v_cvt_pk_bf16_f32 v30, v32, v33
    v_cvt_pk_bf16_f32 v31, v34, v35
    s_mov_b64 exec, s[72:73]
    buffer_store_dwordx2 v[30:31], v23, s[56:59], s79 offen
    s_endpgm
qkv_ld:
    v_lshrrev_b32 v10, 3, v1
    v_mul_u32_u24 v8, 128, v10
    v_bfe_u32 v10, v1, 1, 2
    v_bfe_u32 v11, v1, 4, 1
    v_xor_b32 v10, v10, v11
    v_and_b32 v11, 1, v1
    v_lshl_or_b32 v10, v10, 1, v11
    v_lshl_add_u32 v9, v10, 4, v8
    v_xor_b32 v9, 64, v9
    v_lshl_add_u32 v8, v10, 4, v8
    s_and_b32 s7, s3, 1
    s_lshl_b32 s7, s7, 6
    v_xor_b32 v8, s7, v8
    s_lshl_b32 s9, s3, 10
    s_mul_i32 s8, s6, 20480
    s_add_u32 s8, s8, s9
    s_mul_i32 s13, s4, 81920
    s_add_u32 s13, s13, s9
    s_waitcnt lgkmcnt(0)
    s_add_u32 s46, s83, 8388608
    s_add_u32 s44, s40, s46
    s_addc_u32 s45, s41, 0
    s_mov_b32 s46, 2621440
    s_mov_b32 s47, 0x00020000
    s_add_u32 s48, s40, 0
    s_addc_u32 s49, s41, 0
    s_mov_b32 s50, 901120
    s_mov_b32 s51, 0x00020000
    s_add_u32 s26, s9, 0
    s_add_u32 s27, s13, 0
    s_mov_b32 m0, s26
    s_nop 0
    buffer_load_dwordx4 v8, s[44:47], s27 offen lds
    s_add_u32 s26, s9, 81920
    s_add_u32 s27, s8, 0
    s_mov_b32 m0, s26
    s_nop 0
    buffer_load_dwordx4 v7, s[48:51], s27 offen lds
    s_add_u32 s26, s9, 4096
    s_add_u32 s27, s13, 4096
    s_mov_b32 m0, s26
    s_nop 0
    buffer_load_dwordx4 v8, s[44:47], s27 offen lds
    s_add_u32 s26, s9, 8192
    s_add_u32 s27, s13, 8192
    s_mov_b32 m0, s26
    s_nop 0
    buffer_load_dwordx4 v8, s[44:47], s27 offen lds
    s_add_u32 s26, s9, 86016
    s_add_u32 s27, s8, 4096
    s_mov_b32 m0, s26
    s_nop 0
    buffer_load_dwordx4 v7, s[48:51], s27 offen lds
    s_add_u32 s26, s9, 12288
    s_add_u32 s27, s13, 12288
    s_mov_b32 m0, s26
    s_nop 0
    buffer_load_dwordx4 v8, s[44:47], s27 offen lds
    s_add_u32 s26, s9, 16384
    s_add_u32 s27, s13, 16384
    s_mov_b32 m0, s26
    s_nop 0
    buffer_load_dwordx4 v8, s[44:47], s27 offen lds
    s_add_u32 s26, s9, 90112
    s_add_u32 s27, s8, 8192
    s_mov_b32 m0, s26
    s_nop 0
    buffer_load_dwordx4 v7, s[48:51], s27 offen lds
    s_add_u32 s26, s9, 20480
    s_add_u32 s27, s13, 20480
    s_mov_b32 m0, s26
    s_nop 0
    buffer_load_dwordx4 v8, s[44:47], s27 offen lds
    s_add_u32 s26, s9, 24576
    s_add_u32 s27, s13, 24576
    s_mov_b32 m0, s26
    s_nop 0
    buffer_load_dwordx4 v8, s[44:47], s27 offen lds
    s_add_u32 s26, s9, 94208
    s_add_u32 s27, s8, 12288
    s_mov_b32 m0, s26
    s_nop 0
    buffer_load_dwordx4 v7, s[48:51], s27 offen lds
    s_waitcnt vmcnt(8)
    s_barrier
    s_add_u32 s26, s9, 28672
    s_add_u32 s27, s13, 28672
    s_mov_b32 m0, s26
    s_nop 0
    buffer_load_dwordx4 v8, s[44:47], s27 offen lds
    s_add_u32 s26, s9, 32768
    s_add_u32 s27, s13, 32768
    s_mov_b32 m0, s26
    s_nop 0
    buffer_load_dwordx4 v8, s[44:47], s27 offen lds
    s_add_u32 s26, s9, 98304
    s_add_u32 s27, s8, 16384
    s_mov_b32 m0, s26
    s_nop 0
    buffer_load_dwordx4 v7, s[48:51], s27 offen lds
    s_add_u32 s26, s9, 36864
    s_add_u32 s27, s13, 36864
    s_mov_b32 m0, s26
    s_nop 0
    buffer_load_dwordx4 v8, s[44:47], s27 offen lds
    s_add_u32 s26, s9, 40960
    s_add_u32 s27, s13, 40960
    s_mov_b32 m0, s26
    s_nop 0
    buffer_load_dwordx4 v8, s[44:47], s27 offen lds
    s_add_u32 s26, s9, 102400
    s_add_u32 s27, s8, 20480
    s_mov_b32 m0, s26
    s_nop 0
    buffer_load_dwordx4 v7, s[48:51], s27 offen lds
    s_add_u32 s26, s9, 45056
    s_add_u32 s27, s13, 45056
    s_mov_b32 m0, s26
    s_nop 0
    buffer_load_dwordx4 v8, s[44:47], s27 offen lds
    s_waitcnt vmcnt(12)
    s_barrier
    s_add_u32 s26, s9, 49152
    s_add_u32 s27, s13, 49152
    s_mov_b32 m0, s26
    s_nop 0
    buffer_load_dwordx4 v8, s[44:47], s27 offen lds
    s_add_u32 s26, s9, 106496
    s_add_u32 s27, s8, 24576
    s_mov_b32 m0, s26
    s_nop 0
    buffer_load_dwordx4 v7, s[48:51], s27 offen lds
    s_add_u32 s26, s9, 53248
    s_add_u32 s27, s13, 53248
    s_mov_b32 m0, s26
    s_nop 0
    buffer_load_dwordx4 v8, s[44:47], s27 offen lds
    s_add_u32 s26, s9, 57344
    s_add_u32 s27, s13, 57344
    s_mov_b32 m0, s26
    s_nop 0
    buffer_load_dwordx4 v8, s[44:47], s27 offen lds
    s_add_u32 s26, s9, 110592
    s_add_u32 s27, s8, 28672
    s_mov_b32 m0, s26
    s_nop 0
    buffer_load_dwordx4 v7, s[48:51], s27 offen lds
    s_add_u32 s26, s9, 61440
    s_add_u32 s27, s13, 61440
    s_mov_b32 m0, s26
    s_nop 0
    buffer_load_dwordx4 v8, s[44:47], s27 offen lds
    s_waitcnt vmcnt(12)
    s_barrier
    s_add_u32 s26, s9, 65536
    s_add_u32 s27, s13, 65536
    s_mov_b32 m0, s26
    s_nop 0
    buffer_load_dwordx4 v8, s[44:47], s27 offen lds
    s_add_u32 s26, s9, 114688
    s_add_u32 s27, s8, 32768
    s_mov_b32 m0, s26
    s_nop 0
    buffer_load_dwordx4 v7, s[48:51], s27 offen lds
    s_add_u32 s26, s9, 69632
    s_add_u32 s27, s13, 69632
    s_mov_b32 m0, s26
    s_nop 0
    buffer_load_dwordx4 v8, s[44:47], s27 offen lds
    s_add_u32 s26, s9, 73728
    s_add_u32 s27, s13, 73728
    s_mov_b32 m0, s26
    s_nop 0
    buffer_load_dwordx4 v8, s[44:47], s27 offen lds
    s_add_u32 s26, s9, 118784
    s_add_u32 s27, s8, 36864
    s_mov_b32 m0, s26
    s_nop 0
    buffer_load_dwordx4 v7, s[48:51], s27 offen lds
    s_add_u32 s26, s9, 77824
    s_add_u32 s27, s13, 77824
    s_mov_b32 m0, s26
    s_nop 0
    buffer_load_dwordx4 v8, s[44:47], s27 offen lds
    s_waitcnt vmcnt(12)
    s_barrier
    s_add_u32 s26, s9, 122880
    s_add_u32 s27, s8, 40960
    s_mov_b32 m0, s26
    s_nop 0
    buffer_load_dwordx4 v7, s[48:51], s27 offen lds
    s_add_u32 s26, s9, 126976
    s_add_u32 s27, s8, 45056
    s_mov_b32 m0, s26
    s_nop 0
    buffer_load_dwordx4 v7, s[48:51], s27 offen lds
    s_add_u32 s26, s9, 131072
    s_add_u32 s27, s8, 49152
    s_mov_b32 m0, s26
    s_nop 0
    buffer_load_dwordx4 v7, s[48:51], s27 offen lds
    s_add_u32 s26, s9, 135168
    s_add_u32 s27, s8, 53248
    s_mov_b32 m0, s26
    s_nop 0
    buffer_load_dwordx4 v7, s[48:51], s27 offen lds
    s_add_u32 s26, s9, 139264
    s_add_u32 s27, s8, 57344
    s_mov_b32 m0, s26
    s_nop 0
    buffer_load_dwordx4 v7, s[48:51], s27 offen lds
    s_add_u32 s26, s9, 143360
    s_add_u32 s27, s8, 61440
    s_mov_b32 m0, s26
    s_nop 0
    buffer_load_dwordx4 v7, s[48:51], s27 offen lds
    s_waitcnt vmcnt(12)
    s_barrier
    s_cmp_ge_u32 s5, 4
    s_cbranch_scc1 qkv_ld5
    s_add_u32 s26, s9, 147456
    s_add_u32 s27, s8, 65536
    s_mov_b32 m0, s26
    s_nop 0
    buffer_load_dwordx4 v7, s[48:51], s27 offen lds
    s_add_u32 s26, s9, 151552
    s_add_u32 s27, s8, 69632
    s_mov_b32 m0, s26
    s_nop 0
    buffer_load_dwordx4 v7, s[48:51], s27 offen lds
    s_add_u32 s26, s9, 155648
    s_add_u32 s27, s8, 73728
    s_mov_b32 m0, s26
    s_nop 0
    buffer_load_dwordx4 v7, s[48:51], s27 offen lds
    s_add_u32 s26, s9, 159744
    s_add_u32 s27, s8, 77824
    s_mov_b32 m0, s26
    s_nop 0
    buffer_load_dwordx4 v7, s[48:51], s27 offen lds
    s_add_u32 s26, s9, 0
    s_add_u32 s27, s8, 81920
    s_mov_b32 m0, s26
    s_nop 0
    buffer_load_dwordx4 v7, s[48:51], s27 offen lds
    s_add_u32 s26, s9, 4096
    s_add_u32 s27, s8, 86016
    s_mov_b32 m0, s26
    s_nop 0
    buffer_load_dwordx4 v7, s[48:51], s27 offen lds
    s_waitcnt vmcnt(12)
    s_barrier
    s_add_u32 s26, s9, 8192
    s_add_u32 s27, s8, 90112
    s_mov_b32 m0, s26
    s_nop 0
    buffer_load_dwordx4 v7, s[48:51], s27 offen lds
    s_add_u32 s26, s9, 12288
    s_add_u32 s27, s8, 94208
    s_mov_b32 m0, s26
    s_nop 0
    buffer_load_dwordx4 v7, s[48:51], s27 offen lds
    s_add_u32 s26, s9, 16384
    s_add_u32 s27, s8, 98304
    s_mov_b32 m0, s26
    s_nop 0
    buffer_load_dwordx4 v7, s[48:51], s27 offen lds
    s_add_u32 s26, s9, 20480
    s_add_u32 s27, s8, 102400
    s_mov_b32 m0, s26
    s_nop 0
    buffer_load_dwordx4 v7, s[48:51], s27 offen lds
    s_add_u32 s26, s9, 24576
    s_add_u32 s27, s8, 106496
    s_mov_b32 m0, s26
    s_nop 0
    buffer_load_dwordx4 v7, s[48:51], s27 offen lds
    s_waitcnt vmcnt(12)
    s_barrier
    s_add_u32 s26, s9, 28672
    s_add_u32 s27, s8, 110592
    s_mov_b32 m0, s26
    s_nop 0
    buffer_load_dwordx4 v7, s[48:51], s27 offen lds
    s_add_u32 s26, s9, 32768
    s_add_u32 s27, s8, 114688
    s_mov_b32 m0, s26
    s_nop 0
    buffer_load_dwordx4 v7, s[48:51], s27 offen lds
    s_add_u32 s26, s9, 36864
    s_add_u32 s27, s8, 118784
    s_mov_b32 m0, s26
    s_nop 0
    buffer_load_dwordx4 v7, s[48:51], s27 offen lds
    s_waitcnt vmcnt(10)
    s_barrier
    s_waitcnt vmcnt(5)
    s_barrier
    s_waitcnt vmcnt(2)
    s_barrier
    s_waitcnt vmcnt(0)
    s_barrier
    s_endpgm
qkv_ld5:
    s_add_u32 s26, s9, 147456
    s_add_u32 s27, s8, 65536
    s_mov_b32 m0, s26
    s_nop 0
    buffer_load_dwordx4 v7, s[48:51], s27 offen lds
    s_add_u32 s26, s9, 151552
    s_add_u32 s27, s8, 69632
    s_mov_b32 m0, s26
    s_nop 0
    buffer_load_dwordx4 v7, s[48:51], s27 offen lds
    s_add_u32 s26, s9, 155648
    s_add_u32 s27, s8, 73728
    s_mov_b32 m0, s26
    s_nop 0
    buffer_load_dwordx4 v7, s[48:51], s27 offen lds
    s_add_u32 s26, s9, 159744
    s_add_u32 s27, s8, 77824
    s_mov_b32 m0, s26
    s_nop 0
    buffer_load_dwordx4 v7, s[48:51], s27 offen lds
    s_add_u32 s26, s9, 0
    s_add_u32 s27, s8, 81920
    s_mov_b32 m0, s26
    s_nop 0
    buffer_load_dwordx4 v7, s[48:51], s27 offen lds
    s_add_u32 s26, s9, 4096
    s_add_u32 s27, s8, 86016
    s_mov_b32 m0, s26
    s_nop 0
    buffer_load_dwordx4 v7, s[48:51], s27 offen lds
    s_waitcnt vmcnt(12)
    s_barrier
    s_add_u32 s26, s9, 8192
    s_add_u32 s27, s8, 90112
    s_mov_b32 m0, s26
    s_nop 0
    buffer_load_dwordx4 v7, s[48:51], s27 offen lds
    s_add_u32 s26, s9, 12288
    s_add_u32 s27, s8, 94208
    s_mov_b32 m0, s26
    s_nop 0
    buffer_load_dwordx4 v7, s[48:51], s27 offen lds
    s_add_u32 s26, s9, 16384
    s_add_u32 s27, s8, 98304
    s_mov_b32 m0, s26
    s_nop 0
    buffer_load_dwordx4 v7, s[48:51], s27 offen lds
    s_waitcnt vmcnt(10)
    s_barrier
    s_waitcnt vmcnt(5)
    s_barrier
    s_waitcnt vmcnt(2)
    s_barrier
    s_waitcnt vmcnt(0)
    s_barrier
qkv_end:
    s_endpgm
.section .rodata,"a"
.p2align 6
.amdhsa_kernel qkv_kernel
  .amdhsa_next_free_vgpr 248
  .amdhsa_next_free_sgpr 102
  .amdhsa_accum_offset 248
  .amdhsa_group_segment_fixed_size 0
  .amdhsa_kernarg_size 120
  .amdhsa_user_sgpr_count 2
  .amdhsa_user_sgpr_kernarg_segment_ptr 1
  .amdhsa_system_sgpr_workgroup_id_x 1
.end_amdhsa_kernel
.text
.section .rodata,"a"
.p2align 6
.amdhsa_kernel qkv2_kernel
  .amdhsa_next_free_vgpr 248
  .amdhsa_next_free_sgpr 102
  .amdhsa_accum_offset 248
  .amdhsa_group_segment_fixed_size 0
  .amdhsa_kernarg_size 120
  .amdhsa_user_sgpr_count 2
  .amdhsa_user_sgpr_kernarg_segment_ptr 1
  .amdhsa_system_sgpr_workgroup_id_x 1
.end_amdhsa_kernel
.text
.globl attn2_kernel
.p2align 8
.type attn2_kernel,@function
attn2_kernel:
    s_mov_b32 s79, 17825792
    s_branch attn_kernel_body
.globl attn_kernel
.p2align 8
.type attn_kernel,@function
attn_kernel:
    s_mov_b32 s79, 0
attn_kernel_body:
    s_cmp_ge_u32 s2, 256
    s_cbranch_scc1 attn_end
    s_load_dwordx16 s[16:31], s[0:1], 0
    s_load_dwordx8 s[32:39], s[0:1], 64
    s_load_dwordx2 s[40:41], s[0:1], 112
    s_load_dwordx2 s[42:43], s[0:1], 96
    v_lshrrev_b32 v2, 6, v0
    v_and_b32 v1, 63, v0
    v_and_b32 v3, 31, v0
    v_readfirstlane_b32 s3, v2
    v_bfe_u32 v4, v0, 5, 1
    v_lshlrev_b32 v5, 4, v1
    s_lshl_b32 s4, s2, 3
    s_add_u32 s4, s4, s3
    s_and_b32 s5, s4, 31
    s_lshr_b32 s6, s4, 5
    v_mov_b32 v15, 0
    v_mov_b32 v26, 0x3f80
    v_mov_b32 v30, 0x3f80
    v_mov_b32 v27, 0
    v_mov_b32 v31, 0
    v_mov_b32 v58, 0x3f803f80
    v_cmp_eq_u32 vcc, 20, v3
    s_nop 1
    v_cndmask_b32 v32, 0, v58, vcc
    v_cndmask_b32 v33, 0, v58, vcc
    v_cndmask_b32 v34, 0, v58, vcc
    v_cndmask_b32 v35, 0, v58, vcc
    v_cndmask_b32 v36, 0, v58, vcc
    v_cndmask_b32 v37, 0, v58, vcc
    v_cndmask_b32 v38, 0, v58, vcc
    v_cndmask_b32 v39, 0, v58, vcc
    v_cndmask_b32 v40, 0, v58, vcc
    v_cndmask_b32 v41, 0, v58, vcc
    v_cndmask_b32 v42, 0, v58, vcc
    v_cndmask_b32 v43, 0, v58, vcc
    v_cndmask_b32 v44, 0, v58, vcc
    v_cndmask_b32 v45, 0, v58, vcc
    v_cndmask_b32 v46, 0, v58, vcc
    v_cndmask_b32 v47, 0, v58, vcc
    v_lshlrev_b32 v128, 5, v3
    v_lshl_add_u32 v128, v4, 4, v128
    v_lshlrev_b32 v129, 3, v3
    v_add_u32 v129, 4096, v129
    v_and_b32 v61, 15, v3
    v_add_u32 v130, 0, v4
    v_xor_b32 v130, v130, v61
    v_lshlrev_b32 v130, 4, v130
    v_lshl_add_u32 v130, v3, 8, v130
    v_add_u32 v130, 5120, v130
    v_add_u32 v131, 2, v4
    v_xor_b32 v131, v131, v61
    v_lshlrev_b32 v131, 4, v131
    v_lshl_add_u32 v131, v3, 8, v131
    v_add_u32 v131, 5120, v131
    v_add_u32 v132, 4, v4
    v_xor_b32 v132, v132, v61
    v_lshlrev_b32 v132, 4, v132
    v_lshl_add_u32 v132, v3, 8, v132
    v_add_u32 v132, 5120, v132
    v_add_u32 v133, 6, v4
    v_xor_b32 v133, v133, v61
    v_lshlrev_b32 v133, 4, v133
    v_lshl_add_u32 v133, v3, 8, v133
    v_add_u32 v133, 5120, v133
    v_add_u32 v134, 8, v4
    v_xor_b32 v134, v134, v61
    v_lshlrev_b32 v134, 4, v134
    v_lshl_add_u32 v134, v3, 8, v134
    v_add_u32 v134, 5120, v134
    v_add_u32 v135, 10, v4
    v_xor_b32 v135, v135, v61
    v_lshlrev_b32 v135, 4, v135
    v_lshl_add_u32 v135, v3, 8, v135
    v_add_u32 v135, 5120, v135
    v_add_u32 v136, 12, v4
    v_xor_b32 v136, v136, v61
    v_lshlrev_b32 v136, 4, v136
    v_lshl_add_u32 v136, v3, 8, v136
    v_add_u32 v136, 5120, v136
    v_add_u32 v137, 14, v4
    v_xor_b32 v137, v137, v61
    v_lshlrev_b32 v137, 4, v137
    v_lshl_add_u32 v137, v3, 8, v137
    v_add_u32 v137, 5120, v137
    v_mov_b32 v96, 0
    v_mov_b32 v97, 0
    v_mov_b32 v98, 0
    v_mov_b32 v99, 0
    v_mov_b32 v100, 0
    v_mov_b32 v101, 0
    v_mov_b32 v102, 0
    v_mov_b32 v103, 0
    v_mov_b32 v104, 0
    v_mov_b32 v105, 0
    v_mov_b32 v106, 0
    v_mov_b32 v107, 0
    v_mov_b32 v108, 0
    v_mov_b32 v109, 0
    v_mov_b32 v110, 0
    v_mov_b32 v111, 0
    v_add_u32 v144, 61440, v128
    v_add_u32 v154, 122880, v128
    v_add_u32 v145, 61440, v129
    v_add_u32 v155, 122880, v129
    v_add_u32 v146, 61440, v130
    v_add_u32 v156, 122880, v130
    v_add_u32 v147, 61440, v131
    v_add_u32 v157, 122880, v131
    v_add_u32 v148, 61440, v132
    v_add_u32 v158, 122880, v132
    v_add_u32 v149, 61440, v133
    v_add_u32 v159, 122880, v133
    v_add_u32 v150, 61440, v134
    v_add_u32 v160, 122880, v134
    v_add_u32 v151, 61440, v135
    v_add_u32 v161, 122880, v135
    v_add_u32 v152, 61440, v136
    v_add_u32 v162, 122880, v136
    v_add_u32 v153, 61440, v137
    v_add_u32 v163, 122880, v137
    v_mov_b32 v48, 0
    v_mov_b32 v49, 0
    v_mov_b32 v50, 0
    v_mov_b32 v51, 0
    v_mov_b32 v52, 0
    v_mov_b32 v53, 0
    v_mov_b32 v54, 0
    v_mov_b32 v55, 0
    v_lshlrev_b32 v59, 3, v1
    s_mul_i32 s10, s4, 1280
    v_mov_b32 v58, 0x7fffffff
    v_cmp_eq_u32 vcc, 0, v4
    s_lshl_b32 s8, s6, 5
    v_add_u32 v6, s8, v3
    v_cndmask_b32 v57, v58, v59, vcc
    s_lshl_b32 s12, s3, 10
    s_and_b32 s13, s3, 3
    s_mul_i32 s13, s13, 3072
    s_add_u32 s13, s13, 151552
    v_lshlrev_b32 v60, 2, v1
    v_add_u32 v62, s13, v5
    v_add_u32 v63, s13, v59
    s_waitcnt lgkmcnt(0)
    s_add_u32 s48, s40, 15728640
    s_addc_u32 s49, s41, 0
    s_mov_b32 s50, 163840
    s_mov_b32 s51, 0x00020000
    s_cmp_ge_u32 s3, 4
    s_cbranch_scc1 attn_nd
    s_add_u32 s44, s40, 12582912
    s_addc_u32 s45, s41, 0
    s_mov_b32 s46, 2621440
    s_mov_b32 s47, 0x00020000
    buffer_load_dwordx4 v[8:11], v5, s[44:47], s10 offen
    buffer_load_dwordx2 v[12:13], v57, s[44:47], s10 offen offset:1024
    s_add_u32 s56, s40, 1016064
    s_addc_u32 s57, s41, 0
    s_mov_b32 s58, 512
    s_mov_b32 s59, 0x00020000
    buffer_load_dwordx2 v[142:143], v59, s[56:59], 0 offen
    s_add_u32 s10, s10, 5120
    s_mov_b32 m0, s13
    s_add_u32 s15, s13, 1024
    buffer_load_dwordx4 v5, s[44:47], s10 offen lds
    s_mov_b32 m0, s15
    s_add_u32 s10, s10, 1024
    s_add_u32 s15, s13, 2048
    buffer_load_dword v60, s[44:47], s10 offen lds
    s_mov_b32 m0, s15
    s_nop 0
    buffer_load_dwordx4 v5, s[56:59], 0 offen lds
    s_add_u32 s15, s12, 0
    s_mov_b32 m0, s15
    s_nop 0
    buffer_load_dwordx4 v5, s[48:51], s15 offen lds
    s_add_u32 s15, s12, 4096
    s_mov_b32 m0, s15
    s_nop 0
    buffer_load_dwordx4 v5, s[48:51], s15 offen lds
    s_add_u32 s15, s12, 8192
    s_mov_b32 m0, s15
    s_nop 0
    buffer_load_dwordx4 v5, s[48:51], s15 offen lds
    s_add_u32 s15, s12, 12288
    s_mov_b32 m0, s15
    s_nop 0
    buffer_load_dwordx4 v5, s[48:51], s15 offen lds
    s_add_u32 s15, s12, 16384
    s_mov_b32 m0, s15
    s_nop 0
    buffer_load_dwordx4 v5, s[48:51], s15 offen lds
    s_add_u32 s15, s12, 20480
    s_mov_b32 m0, s15
    s_nop 0
    buffer_load_dwordx4 v5, s[48:51], s15 offen lds
    s_add_u32 s15, s12, 24576
    s_mov_b32 m0, s15
    s_nop 0
    buffer_load_dwordx4 v5, s[48:51], s15 offen lds
    s_add_u32 s15, s12, 28672
    s_mov_b32 m0, s15
    s_nop 0
    buffer_load_dwordx4 v5, s[48:51], s15 offen lds
    s_add_u32 s15, s12, 32768
    s_mov_b32 m0, s15
    s_nop 0
    buffer_load_dwordx4 v5, s[48:51], s15 offen lds
    s_add_u32 s15, s12, 36864
    s_mov_b32 m0, s15
    s_nop 0
    buffer_load_dwordx4 v5, s[48:51], s15 offen lds
attn_nd:
    s_add_u32 s54, s79, 16777216
    s_add_u32 s52, s40, s54
    s_addc_u32 s53, s41, 0
    s_mov_b32 s54, 2621440
    s_mov_b32 s55, 0x00020000
    s_add_u32 s21, s12, 40960
    s_mov_b32 s16, 0x000fffff
    s_mov_b32 s17, 0x000fffff
    s_cmp_ge_u32 s3, 4
    s_cbranch_scc1 attn_nw
    s_waitcnt vmcnt(7)
attn_nw:
    s_barrier
    s_cbranch_scc0 attn_nw2
    v_cmp_eq_u32 vcc, 0, v4
    ds_read_b128 v[8:11], v62
    ds_read_b64 v[12:13], v63 offset:1024
    ds_read_b64 v[142:143], v63 offset:2048
    s_waitcnt lgkmcnt(0)
    v_cndmask_b32 v12, 0, v12, vcc
    v_cndmask_b32 v13, 0, v13, vcc
attn_nw2:
    v_max_f32 v60, v142, v143
    v_dot2_f32_bf16 v62, v8, v8, 0
    v_dot2_f32_bf16 v62, v9, v9, v62
    v_max_f32_dpp v60, v60, v60 row_ror:1 row_mask:0xf bank_mask:0xf
    s_nop 0
    v_dot2_f32_bf16 v62, v10, v10, v62
    v_max_f32_dpp v60, v60, v60 row_ror:2 row_mask:0xf bank_mask:0xf
    s_nop 0
    v_dot2_f32_bf16 v62, v11, v11, v62
    v_max_f32_dpp v60, v60, v60 row_ror:4 row_mask:0xf bank_mask:0xf
    s_nop 0
    v_dot2_f32_bf16 v62, v12, v12, v62
    v_max_f32_dpp v60, v60, v60 row_ror:8 row_mask:0xf bank_mask:0xf
    s_nop 0
    v_dot2_f32_bf16 v62, v13, v13, v62
    v_mov_b32 v61, v60
    v_mov_b32 v63, v62
    s_nop 0
    v_permlane16_swap_b32 v60, v61
    v_permlane32_swap_b32 v62, v63
    v_max_f32 v60, v60, v61
    v_add_f32 v62, v62, v63
    v_mov_b32 v61, v60
    s_nop 1
    v_permlane32_swap_b32 v60, v61
    v_max_f32 v60, v60, v61
    v_mul_f32 v62, v62, v60
    v_sqrt_f32 v62, v62
    v_cmp_eq_u32 vcc, 0, v4
    v_mul_f32 v62, 0x3f810000, v62
    v_add_u32 v62, 0xffff, v62
    v_lshrrev_b32 v62, 16, v62
    v_or_b32 v62, 0x8000, v62
    v_cndmask_b32 v14, 0, v62, vcc
    ds_read_b128 v[16:19], v128 offset:0
    ds_read_b64 v[24:25], v129 offset:0
    ds_read_b128 v[20:23], v128 offset:1024
    ds_read_b64 v[28:29], v129 offset:256
    s_waitcnt lgkmcnt(2)
    v_mfma_f32_32x32x16_bf16 v[64:79], v[16:19], v[8:11], 0
    v_mfma_f32_32x32x16_bf16 v[64:79], v[24:27], v[12:15], v[64:79]
    s_mov_b32 s11, 16
    s_nop 15
    s_setprio 3
    v_exp_f32 v64, v64
    v_exp_f32 v65, v65
    v_exp_f32 v66, v66
    v_exp_f32 v67, v67
    s_mov_b64 exec, s[16:17]
    ds_read_b128 v[32:35], v130 offset:0
    ds_read_b128 v[36:39], v131 offset:0
    s_mov_b64 exec, -1
    v_exp_f32 v68, v68
    v_exp_f32 v69, v69
    v_exp_f32 v70, v70
    v_exp_f32 v71, v71
    s_waitcnt lgkmcnt(2)
    v_mfma_f32_32x32x16_bf16 v[80:95], v[20:23], v[8:11], 0
    v_exp_f32 v72, v72
    v_exp_f32 v73, v73
    v_exp_f32 v74, v74
    v_exp_f32 v75, v75
    v_mfma_f32_32x32x16_bf16 v[80:95], v[28:31], v[12:15], v[80:95]
    ds_read_b128 v[16:19], v128 offset:2048
    ds_read_b64 v[24:25], v129 offset:512
    v_exp_f32 v76, v76
    v_exp_f32 v77, v77
    v_exp_f32 v78, v78
    v_exp_f32 v79, v79
    s_mov_b32 m0, s21
    s_nop 0
    buffer_load_dwordx4 v5, s[48:51], s21 offen lds
    s_add_u32 s21, s21, 8192
    v_cvt_pk_bf16_f32 v48, v64, v65
    v_cvt_pk_bf16_f32 v49, v66, v67
    v_cvt_pk_bf16_f32 v50, v68, v69
    v_cvt_pk_bf16_f32 v51, v70, v71
    v_cvt_pk_bf16_f32 v52, v72, v73
    v_cvt_pk_bf16_f32 v53, v74, v75
    v_cvt_pk_bf16_f32 v54, v76, v77
    v_cvt_pk_bf16_f32 v55, v78, v79
    s_waitcnt lgkmcnt(2)
    v_mfma_f32_32x32x16_bf16 v[96:111], v[32:35], v[48:51], v[96:111]
    v_exp_f32 v80, v80
    v_exp_f32 v81, v81
    v_exp_f32 v82, v82
    v_exp_f32 v83, v83
    v_mfma_f32_32x32x16_bf16 v[96:111], v[36:39], v[52:55], v[96:111]
    s_mov_b64 exec, s[16:17]
    ds_read_b128 v[40:43], v132 offset:0
    ds_read_b128 v[44:47], v133 offset:0
    s_mov_b64 exec, -1
    v_exp_f32 v84, v84
    v_exp_f32 v85, v85
    v_exp_f32 v86, v86
    v_exp_f32 v87, v87
    s_waitcnt lgkmcnt(2)
    v_mfma_f32_32x32x16_bf16 v[64:79], v[16:19], v[8:11], 0
    v_exp_f32 v88, v88
    v_exp_f32 v89, v89
    v_exp_f32 v90, v90
    v_exp_f32 v91, v91
    v_mfma_f32_32x32x16_bf16 v[64:79], v[24:27], v[12:15], v[64:79]
    ds_read_b128 v[20:23], v128 offset:3072
    ds_read_b64 v[28:29], v129 offset:768
    v_exp_f32 v92, v92
    v_exp_f32 v93, v93
    v_exp_f32 v94, v94
    v_exp_f32 v95, v95
    s_mov_b32 m0, s21
    s_nop 0
    buffer_load_dwordx4 v5, s[48:51], s21 offen lds
    s_add_u32 s21, s21, 8192
    v_cvt_pk_bf16_f32 v48, v80, v81
    v_cvt_pk_bf16_f32 v49, v82, v83
    v_cvt_pk_bf16_f32 v50, v84, v85
    v_cvt_pk_bf16_f32 v51, v86, v87
    v_cvt_pk_bf16_f32 v52, v88, v89
    v_cvt_pk_bf16_f32 v53, v90, v91
    v_cvt_pk_bf16_f32 v54, v92, v93
    v_cvt_pk_bf16_f32 v55, v94, v95
    s_waitcnt vmcnt(2)
    s_barrier
    s_waitcnt lgkmcnt(2)
    v_mfma_f32_32x32x16_bf16 v[96:111], v[40:43], v[48:51], v[96:111]
    v_exp_f32 v64, v64
    v_exp_f32 v65, v65
    v_exp_f32 v66, v66
    v_exp_f32 v67, v67
    v_mfma_f32_32x32x16_bf16 v[96:111], v[44:47], v[52:55], v[96:111]
    s_mov_b64 exec, s[16:17]
    ds_read_b128 v[32:35], v134 offset:0
    ds_read_b128 v[36:39], v135 offset:0
    s_mov_b64 exec, -1
    v_exp_f32 v68, v68
    v_exp_f32 v69, v69
    v_exp_f32 v70, v70
    v_exp_f32 v71, v71
    s_waitcnt lgkmcnt(2)
    v_mfma_f32_32x32x16_bf16 v[80:95], v[20:23], v[8:11], 0
    v_exp_f32 v72, v72
    v_exp_f32 v73, v73
    v_exp_f32 v74, v74
    v_exp_f32 v75, v75
    v_mfma_f32_32x32x16_bf16 v[80:95], v[28:31], v[12:15], v[80:95]
    ds_read_b128 v[16:19], v128 offset:10240
    ds_read_b64 v[24:25], v129 offset:10240
    v_exp_f32 v76, v76
    v_exp_f32 v77, v77
    v_exp_f32 v78, v78
    v_exp_f32 v79, v79
    s_mov_b32 m0, s21
    s_nop 0
    buffer_load_dwordx4 v5, s[48:51], s21 offen lds
    s_add_u32 s21, s21, 8192
    v_cvt_pk_bf16_f32 v48, v64, v65
    v_cvt_pk_bf16_f32 v49, v66, v67
    v_cvt_pk_bf16_f32 v50, v68, v69
    v_cvt_pk_bf16_f32 v51, v70, v71
    v_cvt_pk_bf16_f32 v52, v72, v73
    v_cvt_pk_bf16_f32 v53, v74, v75
    v_cvt_pk_bf16_f32 v54, v76, v77
    v_cvt_pk_bf16_f32 v55, v78, v79
    s_waitcnt lgkmcnt(2)
    v_mfma_f32_32x32x16_bf16 v[96:111], v[32:35], v[48:51], v[96:111]
    v_exp_f32 v80, v80
    v_exp_f32 v81, v81
    v_exp_f32 v82, v82
    v_exp_f32 v83, v83
    v_mfma_f32_32x32x16_bf16 v[96:111], v[36:39], v[52:55], v[96:111]
    s_mov_b64 exec, s[16:17]
    ds_read_b128 v[40:43], v136 offset:0
    ds_read_b128 v[44:47], v137 offset:0
    s_mov_b64 exec, -1
    v_exp_f32 v84, v84
    v_exp_f32 v85, v85
    v_exp_f32 v86, v86
    v_exp_f32 v87, v87
    s_waitcnt lgkmcnt(2)
    v_mfma_f32_32x32x16_bf16 v[64:79], v[16:19], v[8:11], 0
    v_exp_f32 v88, v88
    v_exp_f32 v89, v89
    v_exp_f32 v90, v90
    v_exp_f32 v91, v91
    v_mfma_f32_32x32x16_bf16 v[64:79], v[24:27], v[12:15], v[64:79]
    ds_read_b128 v[20:23], v128 offset:11264
    ds_read_b64 v[28:29], v129 offset:10496
    v_exp_f32 v92, v92
    v_exp_f32 v93, v93
    v_exp_f32 v94, v94
    v_exp_f32 v95, v95
    s_mov_b32 m0, s21
    s_nop 0
    buffer_load_dwordx4 v5, s[48:51], s21 offen lds
    s_add_u32 s21, s21, 8192
    v_cvt_pk_bf16_f32 v48, v80, v81
    v_cvt_pk_bf16_f32 v49, v82, v83
    v_cvt_pk_bf16_f32 v50, v84, v85
    v_cvt_pk_bf16_f32 v51, v86, v87
    v_cvt_pk_bf16_f32 v52, v88, v89
    v_cvt_pk_bf16_f32 v53, v90, v91
    v_cvt_pk_bf16_f32 v54, v92, v93
    v_cvt_pk_bf16_f32 v55, v94, v95
    s_waitcnt lgkmcnt(2)
    v_mfma_f32_32x32x16_bf16 v[96:111], v[40:43], v[48:51], v[96:111]
    v_exp_f32 v64, v64
    v_exp_f32 v65, v65
    v_exp_f32 v66, v66
    v_exp_f32 v67, v67
    v_mfma_f32_32x32x16_bf16 v[96:111], v[44:47], v[52:55], v[96:111]
    s_mov_b64 exec, s[16:17]
    ds_read_b128 v[32:35], v130 offset:10240
    ds_read_b128 v[36:39], v131 offset:10240
    s_mov_b64 exec, -1
    v_exp_f32 v68, v68
    v_exp_f32 v69, v69
    v_exp_f32 v70, v70
    v_exp_f32 v71, v71
    s_waitcnt lgkmcnt(2)
    v_mfma_f32_32x32x16_bf16 v[80:95], v[20:23], v[8:11], 0
    v_exp_f32 v72, v72
    v_exp_f32 v73, v73
    v_exp_f32 v74, v74
    v_exp_f32 v75, v75
    v_mfma_f32_32x32x16_bf16 v[80:95], v[28:31], v[12:15], v[80:95]
    ds_read_b128 v[16:19], v128 offset:12288
    ds_read_b64 v[24:25], v129 offset:10752
    v_exp_f32 v76, v76
    v_exp_f32 v77, v77
    v_exp_f32 v78, v78
    v_exp_f32 v79, v79
    s_mov_b32 m0, s21
    s_nop 0
    buffer_load_dwordx4 v5, s[48:51], s21 offen lds
    s_add_u32 s21, s21, 8192
    v_cvt_pk_bf16_f32 v48, v64, v65
    v_cvt_pk_bf16_f32 v49, v66, v67
    v_cvt_pk_bf16_f32 v50, v68, v69
    v_cvt_pk_bf16_f32 v51, v70, v71
    v_cvt_pk_bf16_f32 v52, v72, v73
    v_cvt_pk_bf16_f32 v53, v74, v75
    v_cvt_pk_bf16_f32 v54, v76, v77
    v_cvt_pk_bf16_f32 v55, v78, v79
    s_waitcnt lgkmcnt(2)
    v_mfma_f32_32x32x16_bf16 v[96:111], v[32:35], v[48:51], v[96:111]
    v_exp_f32 v80, v80
    v_exp_f32 v81, v81
    v_exp_f32 v82, v82
    v_exp_f32 v83, v83
    v_mfma_f32_32x32x16_bf16 v[96:111], v[36:39], v[52:55], v[96:111]
    s_mov_b64 exec, s[16:17]
    ds_read_b128 v[40:43], v132 offset:10240
    ds_read_b128 v[44:47], v133 offset:10240
    s_mov_b64 exec, -1
    v_exp_f32 v84, v84
    v_exp_f32 v85, v85
    v_exp_f32 v86, v86
    v_exp_f32 v87, v87
    s_waitcnt lgkmcnt(2)
    v_mfma_f32_32x32x16_bf16 v[64:79], v[16:19], v[8:11], 0
    v_exp_f32 v88, v88
    v_exp_f32 v89, v89
    v_exp_f32 v90, v90
    v_exp_f32 v91, v91
    v_mfma_f32_32x32x16_bf16 v[64:79], v[24:27], v[12:15], v[64:79]
    ds_read_b128 v[20:23], v128 offset:13312
    ds_read_b64 v[28:29], v129 offset:11008
    v_exp_f32 v92, v92
    v_exp_f32 v93, v93
    v_exp_f32 v94, v94
    v_exp_f32 v95, v95
    s_mov_b32 m0, s21
    s_nop 0
    buffer_load_dwordx4 v5, s[48:51], s21 offen lds
    s_add_u32 s21, s21, 8192
    v_cvt_pk_bf16_f32 v48, v80, v81
    v_cvt_pk_bf16_f32 v49, v82, v83
    v_cvt_pk_bf16_f32 v50, v84, v85
    v_cvt_pk_bf16_f32 v51, v86, v87
    v_cvt_pk_bf16_f32 v52, v88, v89
    v_cvt_pk_bf16_f32 v53, v90, v91
    v_cvt_pk_bf16_f32 v54, v92, v93
    v_cvt_pk_bf16_f32 v55, v94, v95
    s_setprio 2
    s_waitcnt lgkmcnt(2)
    v_mfma_f32_32x32x16_bf16 v[96:111], v[40:43], v[48:51], v[96:111]
    v_exp_f32 v64, v64
    v_exp_f32 v65, v65
    v_exp_f32 v66, v66
    v_exp_f32 v67, v67
    v_mfma_f32_32x32x16_bf16 v[96:111], v[44:47], v[52:55], v[96:111]
    s_mov_b64 exec, s[16:17]
    ds_read_b128 v[32:35], v134 offset:10240
    ds_read_b128 v[36:39], v135 offset:10240
    s_mov_b64 exec, -1
    v_exp_f32 v68, v68
    v_exp_f32 v69, v69
    v_exp_f32 v70, v70
    v_exp_f32 v71, v71
    s_waitcnt lgkmcnt(2)
    v_mfma_f32_32x32x16_bf16 v[80:95], v[20:23], v[8:11], 0
    v_exp_f32 v72, v72
    v_exp_f32 v73, v73
    v_exp_f32 v74, v74
    v_exp_f32 v75, v75
    v_mfma_f32_32x32x16_bf16 v[80:95], v[28:31], v[12:15], v[80:95]
    ds_read_b128 v[16:19], v128 offset:20480
    ds_read_b64 v[24:25], v129 offset:20480
    v_exp_f32 v76, v76
    v_exp_f32 v77, v77
    v_exp_f32 v78, v78
    v_exp_f32 v79, v79
    s_mov_b32 m0, s21
    s_nop 0
    buffer_load_dwordx4 v5, s[48:51], s21 offen lds
    s_add_u32 s21, s21, 8192
    v_cvt_pk_bf16_f32 v48, v64, v65
    v_cvt_pk_bf16_f32 v49, v66, v67
    v_cvt_pk_bf16_f32 v50, v68, v69
    v_cvt_pk_bf16_f32 v51, v70, v71
    v_cvt_pk_bf16_f32 v52, v72, v73
    v_cvt_pk_bf16_f32 v53, v74, v75
    v_cvt_pk_bf16_f32 v54, v76, v77
    v_cvt_pk_bf16_f32 v55, v78, v79
    s_waitcnt lgkmcnt(2)
    v_mfma_f32_32x32x16_bf16 v[96:111], v[32:35], v[48:51], v[96:111]
    v_exp_f32 v80, v80
    v_exp_f32 v81, v81
    v_exp_f32 v82, v82
    v_exp_f32 v83, v83
    v_mfma_f32_32x32x16_bf16 v[96:111], v[36:39], v[52:55], v[96:111]
    s_mov_b64 exec, s[16:17]
    ds_read_b128 v[40:43], v136 offset:10240
    ds_read_b128 v[44:47], v137 offset:10240
    s_mov_b64 exec, -1
    v_exp_f32 v84, v84
    v_exp_f32 v85, v85
    v_exp_f32 v86, v86
    v_exp_f32 v87, v87
    s_waitcnt lgkmcnt(2)
    v_mfma_f32_32x32x16_bf16 v[64:79], v[16:19], v[8:11], 0
    v_exp_f32 v88, v88
    v_exp_f32 v89, v89
    v_exp_f32 v90, v90
    v_exp_f32 v91, v91
    v_mfma_f32_32x32x16_bf16 v[64:79], v[24:27], v[12:15], v[64:79]
    ds_read_b128 v[20:23], v128 offset:21504
    ds_read_b64 v[28:29], v129 offset:20736
    v_exp_f32 v92, v92
    v_exp_f32 v93, v93
    v_exp_f32 v94, v94
    v_exp_f32 v95, v95
    s_mov_b32 m0, s21
    s_nop 0
    buffer_load_dwordx4 v5, s[48:51], s21 offen lds
    s_add_u32 s21, s21, 8192
    v_cvt_pk_bf16_f32 v48, v80, v81
    v_cvt_pk_bf16_f32 v49, v82, v83
    v_cvt_pk_bf16_f32 v50, v84, v85
    v_cvt_pk_bf16_f32 v51, v86, v87
    v_cvt_pk_bf16_f32 v52, v88, v89
    v_cvt_pk_bf16_f32 v53, v90, v91
    v_cvt_pk_bf16_f32 v54, v92, v93
    v_cvt_pk_bf16_f32 v55, v94, v95
    s_waitcnt lgkmcnt(2)
    v_mfma_f32_32x32x16_bf16 v[96:111], v[40:43], v[48:51], v[96:111]
    v_exp_f32 v64, v64
    v_exp_f32 v65, v65
    v_exp_f32 v66, v66
    v_exp_f32 v67, v67
    v_mfma_f32_32x32x16_bf16 v[96:111], v[44:47], v[52:55], v[96:111]
    s_mov_b64 exec, s[16:17]
    ds_read_b128 v[32:35], v130 offset:20480
    ds_read_b128 v[36:39], v131 offset:20480
    s_mov_b64 exec, -1
    v_exp_f32 v68, v68
    v_exp_f32 v69, v69
    v_exp_f32 v70, v70
    v_exp_f32 v71, v71
    s_waitcnt lgkmcnt(2)
    v_mfma_f32_32x32x16_bf16 v[80:95], v[20:23], v[8:11], 0
    v_exp_f32 v72, v72
    v_exp_f32 v73, v73
    v_exp_f32 v74, v74
    v_exp_f32 v75, v75
    v_mfma_f32_32x32x16_bf16 v[80:95], v[28:31], v[12:15], v[80:95]
    ds_read_b128 v[16:19], v128 offset:22528
    ds_read_b64 v[24:25], v129 offset:20992
    v_exp_f32 v76, v76
    v_exp_f32 v77, v77
    v_exp_f32 v78, v78
    v_exp_f32 v79, v79
    s_mov_b32 m0, s21
    s_nop 0
    buffer_load_dwordx4 v5, s[48:51], s21 offen lds
    s_add_u32 s21, s21, 8192
    v_cvt_pk_bf16_f32 v48, v64, v65
    v_cvt_pk_bf16_f32 v49, v66, v67
    v_cvt_pk_bf16_f32 v50, v68, v69
    v_cvt_pk_bf16_f32 v51, v70, v71
    v_cvt_pk_bf16_f32 v52, v72, v73
    v_cvt_pk_bf16_f32 v53, v74, v75
    v_cvt_pk_bf16_f32 v54, v76, v77
    v_cvt_pk_bf16_f32 v55, v78, v79
    s_waitcnt lgkmcnt(2)
    v_mfma_f32_32x32x16_bf16 v[96:111], v[32:35], v[48:51], v[96:111]
    v_exp_f32 v80, v80
    v_exp_f32 v81, v81
    v_exp_f32 v82, v82
    v_exp_f32 v83, v83
    v_mfma_f32_32x32x16_bf16 v[96:111], v[36:39], v[52:55], v[96:111]
    s_mov_b64 exec, s[16:17]
    ds_read_b128 v[40:43], v132 offset:20480
    ds_read_b128 v[44:47], v133 offset:20480
    s_mov_b64 exec, -1
    v_exp_f32 v84, v84
    v_exp_f32 v85, v85
    v_exp_f32 v86, v86
    v_exp_f32 v87, v87
    s_waitcnt lgkmcnt(2)
    v_mfma_f32_32x32x16_bf16 v[64:79], v[16:19], v[8:11], 0
    v_exp_f32 v88, v88
    v_exp_f32 v89, v89
    v_exp_f32 v90, v90
    v_exp_f32 v91, v91
    v_mfma_f32_32x32x16_bf16 v[64:79], v[24:27], v[12:15], v[64:79]
    ds_read_b128 v[20:23], v128 offset:23552
    ds_read_b64 v[28:29], v129 offset:21248
    v_exp_f32 v92, v92
    v_exp_f32 v93, v93
    v_exp_f32 v94, v94
    v_exp_f32 v95, v95
    s_mov_b32 m0, s21
    s_nop 0
    buffer_load_dwordx4 v5, s[48:51], s21 offen lds
    s_add_u32 s21, s21, 8192
    v_cvt_pk_bf16_f32 v48, v80, v81
    v_cvt_pk_bf16_f32 v49, v82, v83
    v_cvt_pk_bf16_f32 v50, v84, v85
    v_cvt_pk_bf16_f32 v51, v86, v87
    v_cvt_pk_bf16_f32 v52, v88, v89
    v_cvt_pk_bf16_f32 v53, v90, v91
    v_cvt_pk_bf16_f32 v54, v92, v93
    v_cvt_pk_bf16_f32 v55, v94, v95
    s_setprio 1
    s_waitcnt lgkmcnt(2)
    v_mfma_f32_32x32x16_bf16 v[96:111], v[40:43], v[48:51], v[96:111]
    v_exp_f32 v64, v64
    v_exp_f32 v65, v65
    v_exp_f32 v66, v66
    v_exp_f32 v67, v67
    v_mfma_f32_32x32x16_bf16 v[96:111], v[44:47], v[52:55], v[96:111]
    s_mov_b64 exec, s[16:17]
    ds_read_b128 v[32:35], v134 offset:20480
    ds_read_b128 v[36:39], v135 offset:20480
    s_mov_b64 exec, -1
    v_exp_f32 v68, v68
    v_exp_f32 v69, v69
    v_exp_f32 v70, v70
    v_exp_f32 v71, v71
    s_waitcnt lgkmcnt(2)
    v_mfma_f32_32x32x16_bf16 v[80:95], v[20:23], v[8:11], 0
    v_exp_f32 v72, v72
    v_exp_f32 v73, v73
    v_exp_f32 v74, v74
    v_exp_f32 v75, v75
    v_mfma_f32_32x32x16_bf16 v[80:95], v[28:31], v[12:15], v[80:95]
    ds_read_b128 v[16:19], v128 offset:30720
    ds_read_b64 v[24:25], v129 offset:30720
    v_exp_f32 v76, v76
    v_exp_f32 v77, v77
    v_exp_f32 v78, v78
    v_exp_f32 v79, v79
    s_mov_b32 m0, s21
    s_nop 0
    buffer_load_dwordx4 v5, s[48:51], s21 offen lds
    s_add_u32 s21, s21, 8192
    v_cvt_pk_bf16_f32 v48, v64, v65
    v_cvt_pk_bf16_f32 v49, v66, v67
    v_cvt_pk_bf16_f32 v50, v68, v69
    v_cvt_pk_bf16_f32 v51, v70, v71
    v_cvt_pk_bf16_f32 v52, v72, v73
    v_cvt_pk_bf16_f32 v53, v74, v75
    v_cvt_pk_bf16_f32 v54, v76, v77
    v_cvt_pk_bf16_f32 v55, v78, v79
    s_waitcnt lgkmcnt(2)
    v_mfma_f32_32x32x16_bf16 v[96:111], v[32:35], v[48:51], v[96:111]
    v_exp_f32 v80, v80
    v_exp_f32 v81, v81
    v_exp_f32 v82, v82
    v_exp_f32 v83, v83
    v_mfma_f32_32x32x16_bf16 v[96:111], v[36:39], v[52:55], v[96:111]
    s_mov_b64 exec, s[16:17]
    ds_read_b128 v[40:43], v136 offset:20480
    ds_read_b128 v[44:47], v137 offset:20480
    s_mov_b64 exec, -1
    v_exp_f32 v84, v84
    v_exp_f32 v85, v85
    v_exp_f32 v86, v86
    v_exp_f32 v87, v87
    s_waitcnt lgkmcnt(2)
    v_mfma_f32_32x32x16_bf16 v[64:79], v[16:19], v[8:11], 0
    v_exp_f32 v88, v88
    v_exp_f32 v89, v89
    v_exp_f32 v90, v90
    v_exp_f32 v91, v91
    v_mfma_f32_32x32x16_bf16 v[64:79], v[24:27], v[12:15], v[64:79]
    ds_read_b128 v[20:23], v128 offset:31744
    ds_read_b64 v[28:29], v129 offset:30976
    v_exp_f32 v92, v92
    v_exp_f32 v93, v93
    v_exp_f32 v94, v94
    v_exp_f32 v95, v95
    s_mov_b32 m0, s21
    s_nop 0
    buffer_load_dwordx4 v5, s[48:51], s21 offen lds
    s_add_u32 s21, s21, 8192
    v_cvt_pk_bf16_f32 v48, v80, v81
    v_cvt_pk_bf16_f32 v49, v82, v83
    v_cvt_pk_bf16_f32 v50, v84, v85
    v_cvt_pk_bf16_f32 v51, v86, v87
    v_cvt_pk_bf16_f32 v52, v88, v89
    v_cvt_pk_bf16_f32 v53, v90, v91
    v_cvt_pk_bf16_f32 v54, v92, v93
    v_cvt_pk_bf16_f32 v55, v94, v95
    s_setprio 0
    s_waitcnt lgkmcnt(2)
    v_mfma_f32_32x32x16_bf16 v[96:111], v[40:43], v[48:51], v[96:111]
    v_exp_f32 v64, v64
    v_exp_f32 v65, v65
    v_exp_f32 v66, v66
    v_exp_f32 v67, v67
    v_mfma_f32_32x32x16_bf16 v[96:111], v[44:47], v[52:55], v[96:111]
    s_mov_b64 exec, s[16:17]
    ds_read_b128 v[32:35], v130 offset:30720
    ds_read_b128 v[36:39], v131 offset:30720
    s_mov_b64 exec, -1
    v_exp_f32 v68, v68
    v_exp_f32 v69, v69
    v_exp_f32 v70, v70
    v_exp_f32 v71, v71
    s_waitcnt lgkmcnt(2)
    v_mfma_f32_32x32x16_bf16 v[80:95], v[20:23], v[8:11], 0
    v_exp_f32 v72, v72
    v_exp_f32 v73, v73
    v_exp_f32 v74, v74
    v_exp_f32 v75, v75
    v_mfma_f32_32x32x16_bf16 v[80:95], v[28:31], v[12:15], v[80:95]
    ds_read_b128 v[16:19], v128 offset:32768
    ds_read_b64 v[24:25], v129 offset:31232
    v_exp_f32 v76, v76
    v_exp_f32 v77, v77
    v_exp_f32 v78, v78
    v_exp_f32 v79, v79
    s_mov_b32 m0, s21
    s_nop 0
    buffer_load_dwordx4 v5, s[48:51], s21 offen lds
    s_add_u32 s21, s21, 8192
    v_cvt_pk_bf16_f32 v48, v64, v65
    v_cvt_pk_bf16_f32 v49, v66, v67
    v_cvt_pk_bf16_f32 v50, v68, v69
    v_cvt_pk_bf16_f32 v51, v70, v71
    v_cvt_pk_bf16_f32 v52, v72, v73
    v_cvt_pk_bf16_f32 v53, v74, v75
    v_cvt_pk_bf16_f32 v54, v76, v77
    v_cvt_pk_bf16_f32 v55, v78, v79
    s_waitcnt lgkmcnt(2)
    v_mfma_f32_32x32x16_bf16 v[96:111], v[32:35], v[48:51], v[96:111]
    v_exp_f32 v80, v80
    v_exp_f32 v81, v81
    v_exp_f32 v82, v82
    v_exp_f32 v83, v83
    v_mfma_f32_32x32x16_bf16 v[96:111], v[36:39], v[52:55], v[96:111]
    s_mov_b64 exec, s[16:17]
    ds_read_b128 v[40:43], v132 offset:30720
    ds_read_b128 v[44:47], v133 offset:30720
    s_mov_b64 exec, -1
    v_exp_f32 v84, v84
    v_exp_f32 v85, v85
    v_exp_f32 v86, v86
    v_exp_f32 v87, v87
    s_waitcnt lgkmcnt(2)
    v_mfma_f32_32x32x16_bf16 v[64:79], v[16:19], v[8:11], 0
    v_exp_f32 v88, v88
    v_exp_f32 v89, v89
    v_exp_f32 v90, v90
    v_exp_f32 v91, v91
    v_mfma_f32_32x32x16_bf16 v[64:79], v[24:27], v[12:15], v[64:79]
    ds_read_b128 v[20:23], v128 offset:33792
    ds_read_b64 v[28:29], v129 offset:31488
    v_exp_f32 v92, v92
    v_exp_f32 v93, v93
    v_exp_f32 v94, v94
    v_exp_f32 v95, v95
    s_mov_b32 m0, s21
    s_nop 0
    buffer_load_dwordx4 v5, s[48:51], s21 offen lds
    s_add_u32 s21, s21, 8192
    v_cvt_pk_bf16_f32 v48, v80, v81
    v_cvt_pk_bf16_f32 v49, v82, v83
    v_cvt_pk_bf16_f32 v50, v84, v85
    v_cvt_pk_bf16_f32 v51, v86, v87
    v_cvt_pk_bf16_f32 v52, v88, v89
    v_cvt_pk_bf16_f32 v53, v90, v91
    v_cvt_pk_bf16_f32 v54, v92, v93
    v_cvt_pk_bf16_f32 v55, v94, v95
    s_waitcnt vmcnt(9)
    s_barrier
    s_setprio 3
    s_waitcnt lgkmcnt(2)
    v_mfma_f32_32x32x16_bf16 v[96:111], v[40:43], v[48:51], v[96:111]
    v_exp_f32 v64, v64
    v_exp_f32 v65, v65
    v_exp_f32 v66, v66
    v_exp_f32 v67, v67
    v_mfma_f32_32x32x16_bf16 v[96:111], v[44:47], v[52:55], v[96:111]
    s_mov_b64 exec, s[16:17]
    ds_read_b128 v[32:35], v134 offset:30720
    ds_read_b128 v[36:39], v135 offset:30720
    s_mov_b64 exec, -1
    v_exp_f32 v68, v68
    v_exp_f32 v69, v69
    v_exp_f32 v70, v70
    v_exp_f32 v71, v71
    s_waitcnt lgkmcnt(2)
    v_mfma_f32_32x32x16_bf16 v[80:95], v[20:23], v[8:11], 0
    v_exp_f32 v72, v72
    v_exp_f32 v73, v73
    v_exp_f32 v74, v74
    v_exp_f32 v75, v75
    v_mfma_f32_32x32x16_bf16 v[80:95], v[28:31], v[12:15], v[80:95]
    ds_read_b128 v[16:19], v128 offset:40960
    ds_read_b64 v[24:25], v129 offset:40960
    v_exp_f32 v76, v76
    v_exp_f32 v77, v77
    v_exp_f32 v78, v78
    v_exp_f32 v79, v79
    s_mov_b32 m0, s21
    s_nop 0
    buffer_load_dwordx4 v5, s[48:51], s21 offen lds
    s_add_u32 s21, s21, 8192
    v_cvt_pk_bf16_f32 v48, v64, v65
    v_cvt_pk_bf16_f32 v49, v66, v67
    v_cvt_pk_bf16_f32 v50, v68, v69
    v_cvt_pk_bf16_f32 v51, v70, v71
    v_cvt_pk_bf16_f32 v52, v72, v73
    v_cvt_pk_bf16_f32 v53, v74, v75
    v_cvt_pk_bf16_f32 v54, v76, v77
    v_cvt_pk_bf16_f32 v55, v78, v79
    s_waitcnt lgkmcnt(2)
    v_mfma_f32_32x32x16_bf16 v[96:111], v[32:35], v[48:51], v[96:111]
    v_exp_f32 v80, v80
    v_exp_f32 v81, v81
    v_exp_f32 v82, v82
    v_exp_f32 v83, v83
    v_mfma_f32_32x32x16_bf16 v[96:111], v[36:39], v[52:55], v[96:111]
    s_mov_b64 exec, s[16:17]
    ds_read_b128 v[40:43], v136 offset:30720
    ds_read_b128 v[44:47], v137 offset:30720
    s_mov_b64 exec, -1
    v_exp_f32 v84, v84
    v_exp_f32 v85, v85
    v_exp_f32 v86, v86
    v_exp_f32 v87, v87
    s_waitcnt lgkmcnt(2)
    v_mfma_f32_32x32x16_bf16 v[64:79], v[16:19], v[8:11], 0
    v_exp_f32 v88, v88
    v_exp_f32 v89, v89
    v_exp_f32 v90, v90
    v_exp_f32 v91, v91
    v_mfma_f32_32x32x16_bf16 v[64:79], v[24:27], v[12:15], v[64:79]
    ds_read_b128 v[20:23], v128 offset:41984
    ds_read_b64 v[28:29], v129 offset:41216
    v_exp_f32 v92, v92
    v_exp_f32 v93, v93
    v_exp_f32 v94, v94
    v_exp_f32 v95, v95
    s_nop 0
    v_cvt_pk_bf16_f32 v48, v80, v81
    v_cvt_pk_bf16_f32 v49, v82, v83
    v_cvt_pk_bf16_f32 v50, v84, v85
    v_cvt_pk_bf16_f32 v51, v86, v87
    v_cvt_pk_bf16_f32 v52, v88, v89
    v_cvt_pk_bf16_f32 v53, v90, v91
    v_cvt_pk_bf16_f32 v54, v92, v93
    v_cvt_pk_bf16_f32 v55, v94, v95
    s_waitcnt lgkmcnt(2)
    v_mfma_f32_32x32x16_bf16 v[96:111], v[40:43], v[48:51], v[96:111]
    v_exp_f32 v64, v64
    v_exp_f32 v65, v65
    v_exp_f32 v66, v66
    v_exp_f32 v67, v67
    v_mfma_f32_32x32x16_bf16 v[96:111], v[44:47], v[52:55], v[96:111]
    s_mov_b64 exec, s[16:17]
    ds_read_b128 v[32:35], v130 offset:40960
    ds_read_b128 v[36:39], v131 offset:40960
    s_mov_b64 exec, -1
    v_exp_f32 v68, v68
    v_exp_f32 v69, v69
    v_exp_f32 v70, v70
    v_exp_f32 v71, v71
    s_waitcnt lgkmcnt(2)
    v_mfma_f32_32x32x16_bf16 v[80:95], v[20:23], v[8:11], 0
    v_exp_f32 v72, v72
    v_exp_f32 v73, v73
    v_exp_f32 v74, v74
    v_exp_f32 v75, v75
    v_mfma_f32_32x32x16_bf16 v[80:95], v[28:31], v[12:15], v[80:95]
    ds_read_b128 v[16:19], v128 offset:43008
    ds_read_b64 v[24:25], v129 offset:41472
    v_exp_f32 v76, v76
    v_exp_f32 v77, v77
    v_exp_f32 v78, v78
    v_exp_f32 v79, v79
    s_nop 0
    v_cvt_pk_bf16_f32 v48, v64, v65
    v_cvt_pk_bf16_f32 v49, v66, v67
    v_cvt_pk_bf16_f32 v50, v68, v69
    v_cvt_pk_bf16_f32 v51, v70, v71
    v_cvt_pk_bf16_f32 v52, v72, v73
    v_cvt_pk_bf16_f32 v53, v74, v75
    v_cvt_pk_bf16_f32 v54, v76, v77
    v_cvt_pk_bf16_f32 v55, v78, v79
    s_waitcnt lgkmcnt(2)
    v_mfma_f32_32x32x16_bf16 v[96:111], v[32:35], v[48:51], v[96:111]
    v_exp_f32 v80, v80
    v_exp_f32 v81, v81
    v_exp_f32 v82, v82
    v_exp_f32 v83, v83
    v_mfma_f32_32x32x16_bf16 v[96:111], v[36:39], v[52:55], v[96:111]
    s_mov_b64 exec, s[16:17]
    ds_read_b128 v[40:43], v132 offset:40960
    ds_read_b128 v[44:47], v133 offset:40960
    s_mov_b64 exec, -1
    v_exp_f32 v84, v84
    v_exp_f32 v85, v85
    v_exp_f32 v86, v86
    v_exp_f32 v87, v87
    s_waitcnt lgkmcnt(2)
    v_mfma_f32_32x32x16_bf16 v[64:79], v[16:19], v[8:11], 0
    v_exp_f32 v88, v88
    v_exp_f32 v89, v89
    v_exp_f32 v90, v90
    v_exp_f32 v91, v91
    v_mfma_f32_32x32x16_bf16 v[64:79], v[24:27], v[12:15], v[64:79]
    ds_read_b128 v[20:23], v128 offset:44032
    ds_read_b64 v[28:29], v129 offset:41728
    v_exp_f32 v92, v92
    v_exp_f32 v93, v93
    v_exp_f32 v94, v94
    v_exp_f32 v95, v95
    s_nop 0
    v_cvt_pk_bf16_f32 v48, v80, v81
    v_cvt_pk_bf16_f32 v49, v82, v83
    v_cvt_pk_bf16_f32 v50, v84, v85
    v_cvt_pk_bf16_f32 v51, v86, v87
    v_cvt_pk_bf16_f32 v52, v88, v89
    v_cvt_pk_bf16_f32 v53, v90, v91
    v_cvt_pk_bf16_f32 v54, v92, v93
    v_cvt_pk_bf16_f32 v55, v94, v95
    s_waitcnt lgkmcnt(2)
    v_mfma_f32_32x32x16_bf16 v[96:111], v[40:43], v[48:51], v[96:111]
    v_exp_f32 v64, v64
    v_exp_f32 v65, v65
    v_exp_f32 v66, v66
    v_exp_f32 v67, v67
    v_mfma_f32_32x32x16_bf16 v[96:111], v[44:47], v[52:55], v[96:111]
    s_mov_b64 exec, s[16:17]
    ds_read_b128 v[32:35], v134 offset:40960
    ds_read_b128 v[36:39], v135 offset:40960
    s_mov_b64 exec, -1
    v_exp_f32 v68, v68
    v_exp_f32 v69, v69
    v_exp_f32 v70, v70
    v_exp_f32 v71, v71
    s_waitcnt lgkmcnt(2)
    v_mfma_f32_32x32x16_bf16 v[80:95], v[20:23], v[8:11], 0
    v_exp_f32 v72, v72
    v_exp_f32 v73, v73
    v_exp_f32 v74, v74
    v_exp_f32 v75, v75
    v_mfma_f32_32x32x16_bf16 v[80:95], v[28:31], v[12:15], v[80:95]
    ds_read_b128 v[16:19], v128 offset:51200
    ds_read_b64 v[24:25], v129 offset:51200
    v_exp_f32 v76, v76
    v_exp_f32 v77, v77
    v_exp_f32 v78, v78
    v_exp_f32 v79, v79
    s_nop 0
    v_cvt_pk_bf16_f32 v48, v64, v65
    v_cvt_pk_bf16_f32 v49, v66, v67
    v_cvt_pk_bf16_f32 v50, v68, v69
    v_cvt_pk_bf16_f32 v51, v70, v71
    v_cvt_pk_bf16_f32 v52, v72, v73
    v_cvt_pk_bf16_f32 v53, v74, v75
    v_cvt_pk_bf16_f32 v54, v76, v77
    v_cvt_pk_bf16_f32 v55, v78, v79
    s_waitcnt lgkmcnt(2)
    v_mfma_f32_32x32x16_bf16 v[96:111], v[32:35], v[48:51], v[96:111]
    v_exp_f32 v80, v80
    v_exp_f32 v81, v81
    v_exp_f32 v82, v82
    v_exp_f32 v83, v83
    v_mfma_f32_32x32x16_bf16 v[96:111], v[36:39], v[52:55], v[96:111]
    s_mov_b64 exec, s[16:17]
    ds_read_b128 v[40:43], v136 offset:40960
    ds_read_b128 v[44:47], v137 offset:40960
    s_mov_b64 exec, -1
    v_exp_f32 v84, v84
    v_exp_f32 v85, v85
    v_exp_f32 v86, v86
    v_exp_f32 v87, v87
    s_waitcnt lgkmcnt(2)
    v_mfma_f32_32x32x16_bf16 v[64:79], v[16:19], v[8:11], 0
    v_exp_f32 v88, v88
    v_exp_f32 v89, v89
    v_exp_f32 v90, v90
    v_exp_f32 v91, v91
    v_mfma_f32_32x32x16_bf16 v[64:79], v[24:27], v[12:15], v[64:79]
    ds_read_b128 v[20:23], v128 offset:52224
    ds_read_b64 v[28:29], v129 offset:51456
    v_exp_f32 v92, v92
    v_exp_f32 v93, v93
    v_exp_f32 v94, v94
    v_exp_f32 v95, v95
    s_nop 0
    v_cvt_pk_bf16_f32 v48, v80, v81
    v_cvt_pk_bf16_f32 v49, v82, v83
    v_cvt_pk_bf16_f32 v50, v84, v85
    v_cvt_pk_bf16_f32 v51, v86, v87
    v_cvt_pk_bf16_f32 v52, v88, v89
    v_cvt_pk_bf16_f32 v53, v90, v91
    v_cvt_pk_bf16_f32 v54, v92, v93
    v_cvt_pk_bf16_f32 v55, v94, v95
    s_waitcnt lgkmcnt(2)
    v_mfma_f32_32x32x16_bf16 v[96:111], v[40:43], v[48:51], v[96:111]
    v_exp_f32 v64, v64
    v_exp_f32 v65, v65
    v_exp_f32 v66, v66
    v_exp_f32 v67, v67
    v_mfma_f32_32x32x16_bf16 v[96:111], v[44:47], v[52:55], v[96:111]
    s_mov_b64 exec, s[16:17]
    ds_read_b128 v[32:35], v130 offset:51200
    ds_read_b128 v[36:39], v131 offset:51200
    s_mov_b64 exec, -1
    v_exp_f32 v68, v68
    v_exp_f32 v69, v69
    v_exp_f32 v70, v70
    v_exp_f32 v71, v71
    s_waitcnt lgkmcnt(2)
    v_mfma_f32_32x32x16_bf16 v[80:95], v[20:23], v[8:11], 0
    v_exp_f32 v72, v72
    v_exp_f32 v73, v73
    v_exp_f32 v74, v74
    v_exp_f32 v75, v75
    v_mfma_f32_32x32x16_bf16 v[80:95], v[28:31], v[12:15], v[80:95]
    ds_read_b128 v[16:19], v128 offset:53248
    ds_read_b64 v[24:25], v129 offset:51712
    v_exp_f32 v76, v76
    v_exp_f32 v77, v77
    v_exp_f32 v78, v78
    v_exp_f32 v79, v79
    s_nop 0
    v_cvt_pk_bf16_f32 v48, v64, v65
    v_cvt_pk_bf16_f32 v49, v66, v67
    v_cvt_pk_bf16_f32 v50, v68, v69
    v_cvt_pk_bf16_f32 v51, v70, v71
    v_cvt_pk_bf16_f32 v52, v72, v73
    v_cvt_pk_bf16_f32 v53, v74, v75
    v_cvt_pk_bf16_f32 v54, v76, v77
    v_cvt_pk_bf16_f32 v55, v78, v79
    s_waitcnt lgkmcnt(2)
    v_mfma_f32_32x32x16_bf16 v[96:111], v[32:35], v[48:51], v[96:111]
    v_exp_f32 v80, v80
    v_exp_f32 v81, v81
    v_exp_f32 v82, v82
    v_exp_f32 v83, v83
    v_mfma_f32_32x32x16_bf16 v[96:111], v[36:39], v[52:55], v[96:111]
    s_mov_b64 exec, s[16:17]
    ds_read_b128 v[40:43], v132 offset:51200
    ds_read_b128 v[44:47], v133 offset:51200
    s_mov_b64 exec, -1
    v_exp_f32 v84, v84
    v_exp_f32 v85, v85
    v_exp_f32 v86, v86
    v_exp_f32 v87, v87
    s_waitcnt lgkmcnt(2)
    v_mfma_f32_32x32x16_bf16 v[64:79], v[16:19], v[8:11], 0
    v_exp_f32 v88, v88
    v_exp_f32 v89, v89
    v_exp_f32 v90, v90
    v_exp_f32 v91, v91
    v_mfma_f32_32x32x16_bf16 v[64:79], v[24:27], v[12:15], v[64:79]
    ds_read_b128 v[20:23], v128 offset:54272
    ds_read_b64 v[28:29], v129 offset:51968
    v_exp_f32 v92, v92
    v_exp_f32 v93, v93
    v_exp_f32 v94, v94
    v_exp_f32 v95, v95
    s_nop 0
    v_cvt_pk_bf16_f32 v48, v80, v81
    v_cvt_pk_bf16_f32 v49, v82, v83
    v_cvt_pk_bf16_f32 v50, v84, v85
    v_cvt_pk_bf16_f32 v51, v86, v87
    v_cvt_pk_bf16_f32 v52, v88, v89
    v_cvt_pk_bf16_f32 v53, v90, v91
    v_cvt_pk_bf16_f32 v54, v92, v93
    v_cvt_pk_bf16_f32 v55, v94, v95
    s_setprio 2
    s_waitcnt lgkmcnt(2)
    v_mfma_f32_32x32x16_bf16 v[96:111], v[40:43], v[48:51], v[96:111]
    v_exp_f32 v64, v64
    v_exp_f32 v65, v65
    v_exp_f32 v66, v66
    v_exp_f32 v67, v67
    v_mfma_f32_32x32x16_bf16 v[96:111], v[44:47], v[52:55], v[96:111]
    s_mov_b64 exec, s[16:17]
    ds_read_b128 v[32:35], v134 offset:51200
    ds_read_b128 v[36:39], v135 offset:51200
    s_mov_b64 exec, -1
    v_exp_f32 v68, v68
    v_exp_f32 v69, v69
    v_exp_f32 v70, v70
    v_exp_f32 v71, v71
    s_waitcnt lgkmcnt(2)
    v_mfma_f32_32x32x16_bf16 v[80:95], v[20:23], v[8:11], 0
    v_exp_f32 v72, v72
    v_exp_f32 v73, v73
    v_exp_f32 v74, v74
    v_exp_f32 v75, v75
    v_mfma_f32_32x32x16_bf16 v[80:95], v[28:31], v[12:15], v[80:95]
    ds_read_b128 v[16:19], v144 offset:0
    ds_read_b64 v[24:25], v145 offset:0
    v_exp_f32 v76, v76
    v_exp_f32 v77, v77
    v_exp_f32 v78, v78
    v_exp_f32 v79, v79
    s_nop 0
    v_cvt_pk_bf16_f32 v48, v64, v65
    v_cvt_pk_bf16_f32 v49, v66, v67
    v_cvt_pk_bf16_f32 v50, v68, v69
    v_cvt_pk_bf16_f32 v51, v70, v71
    v_cvt_pk_bf16_f32 v52, v72, v73
    v_cvt_pk_bf16_f32 v53, v74, v75
    v_cvt_pk_bf16_f32 v54, v76, v77
    v_cvt_pk_bf16_f32 v55, v78, v79
    s_waitcnt lgkmcnt(2)
    v_mfma_f32_32x32x16_bf16 v[96:111], v[32:35], v[48:51], v[96:111]
    v_exp_f32 v80, v80
    v_exp_f32 v81, v81
    v_exp_f32 v82, v82
    v_exp_f32 v83, v83
    v_mfma_f32_32x32x16_bf16 v[96:111], v[36:39], v[52:55], v[96:111]
    s_mov_b64 exec, s[16:17]
    ds_read_b128 v[40:43], v136 offset:51200
    ds_read_b128 v[44:47], v137 offset:51200
    s_mov_b64 exec, -1
    v_exp_f32 v84, v84
    v_exp_f32 v85, v85
    v_exp_f32 v86, v86
    v_exp_f32 v87, v87
    s_waitcnt lgkmcnt(2)
    v_mfma_f32_32x32x16_bf16 v[64:79], v[16:19], v[8:11], 0
    v_exp_f32 v88, v88
    v_exp_f32 v89, v89
    v_exp_f32 v90, v90
    v_exp_f32 v91, v91
    v_mfma_f32_32x32x16_bf16 v[64:79], v[24:27], v[12:15], v[64:79]
    ds_read_b128 v[20:23], v144 offset:1024
    ds_read_b64 v[28:29], v145 offset:256
    v_exp_f32 v92, v92
    v_exp_f32 v93, v93
    v_exp_f32 v94, v94
    v_exp_f32 v95, v95
    s_nop 0
    v_cvt_pk_bf16_f32 v48, v80, v81
    v_cvt_pk_bf16_f32 v49, v82, v83
    v_cvt_pk_bf16_f32 v50, v84, v85
    v_cvt_pk_bf16_f32 v51, v86, v87
    v_cvt_pk_bf16_f32 v52, v88, v89
    v_cvt_pk_bf16_f32 v53, v90, v91
    v_cvt_pk_bf16_f32 v54, v92, v93
    v_cvt_pk_bf16_f32 v55, v94, v95
    s_waitcnt lgkmcnt(2)
    v_mfma_f32_32x32x16_bf16 v[96:111], v[40:43], v[48:51], v[96:111]
    v_exp_f32 v64, v64
    v_exp_f32 v65, v65
    v_exp_f32 v66, v66
    v_exp_f32 v67, v67
    v_mfma_f32_32x32x16_bf16 v[96:111], v[44:47], v[52:55], v[96:111]
    s_mov_b64 exec, s[16:17]
    ds_read_b128 v[32:35], v146 offset:0
    ds_read_b128 v[36:39], v147 offset:0
    s_mov_b64 exec, -1
    v_exp_f32 v68, v68
    v_exp_f32 v69, v69
    v_exp_f32 v70, v70
    v_exp_f32 v71, v71
    s_waitcnt lgkmcnt(2)
    v_mfma_f32_32x32x16_bf16 v[80:95], v[20:23], v[8:11], 0
    v_exp_f32 v72, v72
    v_exp_f32 v73, v73
    v_exp_f32 v74, v74
    v_exp_f32 v75, v75
    v_mfma_f32_32x32x16_bf16 v[80:95], v[28:31], v[12:15], v[80:95]
    ds_read_b128 v[16:19], v144 offset:2048
    ds_read_b64 v[24:25], v145 offset:512
    v_exp_f32 v76, v76
    v_exp_f32 v77, v77
    v_exp_f32 v78, v78
    v_exp_f32 v79, v79
    s_nop 0
    v_cvt_pk_bf16_f32 v48, v64, v65
    v_cvt_pk_bf16_f32 v49, v66, v67
    v_cvt_pk_bf16_f32 v50, v68, v69
    v_cvt_pk_bf16_f32 v51, v70, v71
    v_cvt_pk_bf16_f32 v52, v72, v73
    v_cvt_pk_bf16_f32 v53, v74, v75
    v_cvt_pk_bf16_f32 v54, v76, v77
    v_cvt_pk_bf16_f32 v55, v78, v79
    s_waitcnt lgkmcnt(2)
    v_mfma_f32_32x32x16_bf16 v[96:111], v[32:35], v[48:51], v[96:111]
    v_exp_f32 v80, v80
    v_exp_f32 v81, v81
    v_exp_f32 v82, v82
    v_exp_f32 v83, v83
    v_mfma_f32_32x32x16_bf16 v[96:111], v[36:39], v[52:55], v[96:111]
    s_mov_b64 exec, s[16:17]
    ds_read_b128 v[40:43], v148 offset:0
    ds_read_b128 v[44:47], v149 offset:0
    s_mov_b64 exec, -1
    v_exp_f32 v84, v84
    v_exp_f32 v85, v85
    v_exp_f32 v86, v86
    v_exp_f32 v87, v87
    s_waitcnt lgkmcnt(2)
    v_mfma_f32_32x32x16_bf16 v[64:79], v[16:19], v[8:11], 0
    v_exp_f32 v88, v88
    v_exp_f32 v89, v89
    v_exp_f32 v90, v90
    v_exp_f32 v91, v91
    v_mfma_f32_32x32x16_bf16 v[64:79], v[24:27], v[12:15], v[64:79]
    ds_read_b128 v[20:23], v144 offset:3072
    ds_read_b64 v[28:29], v145 offset:768
    v_exp_f32 v92, v92
    v_exp_f32 v93, v93
    v_exp_f32 v94, v94
    v_exp_f32 v95, v95
    s_nop 0
    v_cvt_pk_bf16_f32 v48, v80, v81
    v_cvt_pk_bf16_f32 v49, v82, v83
    v_cvt_pk_bf16_f32 v50, v84, v85
    v_cvt_pk_bf16_f32 v51, v86, v87
    v_cvt_pk_bf16_f32 v52, v88, v89
    v_cvt_pk_bf16_f32 v53, v90, v91
    v_cvt_pk_bf16_f32 v54, v92, v93
    v_cvt_pk_bf16_f32 v55, v94, v95
    s_setprio 1
    s_waitcnt lgkmcnt(2)
    v_mfma_f32_32x32x16_bf16 v[96:111], v[40:43], v[48:51], v[96:111]
    v_exp_f32 v64, v64
    v_exp_f32 v65, v65
    v_exp_f32 v66, v66
    v_exp_f32 v67, v67
    v_mfma_f32_32x32x16_bf16 v[96:111], v[44:47], v[52:55], v[96:111]
    s_mov_b64 exec, s[16:17]
    ds_read_b128 v[32:35], v150 offset:0
    ds_read_b128 v[36:39], v151 offset:0
    s_mov_b64 exec, -1
    v_exp_f32 v68, v68
    v_exp_f32 v69, v69
    v_exp_f32 v70, v70
    v_exp_f32 v71, v71
    s_waitcnt lgkmcnt(2)
    v_mfma_f32_32x32x16_bf16 v[80:95], v[20:23], v[8:11], 0
    v_exp_f32 v72, v72
    v_exp_f32 v73, v73
    v_exp_f32 v74, v74
    v_exp_f32 v75, v75
    v_mfma_f32_32x32x16_bf16 v[80:95], v[28:31], v[12:15], v[80:95]
    ds_read_b128 v[16:19], v144 offset:10240
    ds_read_b64 v[24:25], v145 offset:10240
    v_exp_f32 v76, v76
    v_exp_f32 v77, v77
    v_exp_f32 v78, v78
    v_exp_f32 v79, v79
    s_nop 0
    v_cvt_pk_bf16_f32 v48, v64, v65
    v_cvt_pk_bf16_f32 v49, v66, v67
    v_cvt_pk_bf16_f32 v50, v68, v69
    v_cvt_pk_bf16_f32 v51, v70, v71
    v_cvt_pk_bf16_f32 v52, v72, v73
    v_cvt_pk_bf16_f32 v53, v74, v75
    v_cvt_pk_bf16_f32 v54, v76, v77
    v_cvt_pk_bf16_f32 v55, v78, v79
    s_waitcnt lgkmcnt(2)
    v_mfma_f32_32x32x16_bf16 v[96:111], v[32:35], v[48:51], v[96:111]
    v_exp_f32 v80, v80
    v_exp_f32 v81, v81
    v_exp_f32 v82, v82
    v_exp_f32 v83, v83
    v_mfma_f32_32x32x16_bf16 v[96:111], v[36:39], v[52:55], v[96:111]
    s_mov_b64 exec, s[16:17]
    ds_read_b128 v[40:43], v152 offset:0
    ds_read_b128 v[44:47], v153 offset:0
    s_mov_b64 exec, -1
    v_exp_f32 v84, v84
    v_exp_f32 v85, v85
    v_exp_f32 v86, v86
    v_exp_f32 v87, v87
    s_waitcnt lgkmcnt(2)
    v_mfma_f32_32x32x16_bf16 v[64:79], v[16:19], v[8:11], 0
    v_exp_f32 v88, v88
    v_exp_f32 v89, v89
    v_exp_f32 v90, v90
    v_exp_f32 v91, v91
    v_mfma_f32_32x32x16_bf16 v[64:79], v[24:27], v[12:15], v[64:79]
    ds_read_b128 v[20:23], v144 offset:11264
    ds_read_b64 v[28:29], v145 offset:10496
    v_exp_f32 v92, v92
    v_exp_f32 v93, v93
    v_exp_f32 v94, v94
    v_exp_f32 v95, v95
    s_nop 0
    v_cvt_pk_bf16_f32 v48, v80, v81
    v_cvt_pk_bf16_f32 v49, v82, v83
    v_cvt_pk_bf16_f32 v50, v84, v85
    v_cvt_pk_bf16_f32 v51, v86, v87
    v_cvt_pk_bf16_f32 v52, v88, v89
    v_cvt_pk_bf16_f32 v53, v90, v91
    v_cvt_pk_bf16_f32 v54, v92, v93
    v_cvt_pk_bf16_f32 v55, v94, v95
    s_setprio 0
    s_waitcnt lgkmcnt(2)
    v_mfma_f32_32x32x16_bf16 v[96:111], v[40:43], v[48:51], v[96:111]
    v_exp_f32 v64, v64
    v_exp_f32 v65, v65
    v_exp_f32 v66, v66
    v_exp_f32 v67, v67
    v_mfma_f32_32x32x16_bf16 v[96:111], v[44:47], v[52:55], v[96:111]
    s_mov_b64 exec, s[16:17]
    ds_read_b128 v[32:35], v146 offset:10240
    ds_read_b128 v[36:39], v147 offset:10240
    s_mov_b64 exec, -1
    v_exp_f32 v68, v68
    v_exp_f32 v69, v69
    v_exp_f32 v70, v70
    v_exp_f32 v71, v71
    s_waitcnt lgkmcnt(2)
    v_mfma_f32_32x32x16_bf16 v[80:95], v[20:23], v[8:11], 0
    v_exp_f32 v72, v72
    v_exp_f32 v73, v73
    v_exp_f32 v74, v74
    v_exp_f32 v75, v75
    v_mfma_f32_32x32x16_bf16 v[80:95], v[28:31], v[12:15], v[80:95]
    ds_read_b128 v[16:19], v144 offset:12288
    ds_read_b64 v[24:25], v145 offset:10752
    v_exp_f32 v76, v76
    v_exp_f32 v77, v77
    v_exp_f32 v78, v78
    v_exp_f32 v79, v79
    s_nop 0
    v_cvt_pk_bf16_f32 v48, v64, v65
    v_cvt_pk_bf16_f32 v49, v66, v67
    v_cvt_pk_bf16_f32 v50, v68, v69
    v_cvt_pk_bf16_f32 v51, v70, v71
    v_cvt_pk_bf16_f32 v52, v72, v73
    v_cvt_pk_bf16_f32 v53, v74, v75
    v_cvt_pk_bf16_f32 v54, v76, v77
    v_cvt_pk_bf16_f32 v55, v78, v79
    s_waitcnt lgkmcnt(2)
    v_mfma_f32_32x32x16_bf16 v[96:111], v[32:35], v[48:51], v[96:111]
    v_exp_f32 v80, v80
    v_exp_f32 v81, v81
    v_exp_f32 v82, v82
    v_exp_f32 v83, v83
    v_mfma_f32_32x32x16_bf16 v[96:111], v[36:39], v[52:55], v[96:111]
    s_mov_b64 exec, s[16:17]
    ds_read_b128 v[40:43], v148 offset:10240
    ds_read_b128 v[44:47], v149 offset:10240
    s_mov_b64 exec, -1
    v_exp_f32 v84, v84
    v_exp_f32 v85, v85
    v_exp_f32 v86, v86
    v_exp_f32 v87, v87
    s_waitcnt lgkmcnt(2)
    v_mfma_f32_32x32x16_bf16 v[64:79], v[16:19], v[8:11], 0
    v_exp_f32 v88, v88
    v_exp_f32 v89, v89
    v_exp_f32 v90, v90
    v_exp_f32 v91, v91
    v_mfma_f32_32x32x16_bf16 v[64:79], v[24:27], v[12:15], v[64:79]
    ds_read_b128 v[20:23], v144 offset:13312
    ds_read_b64 v[28:29], v145 offset:11008
    v_exp_f32 v92, v92
    v_exp_f32 v93, v93
    v_exp_f32 v94, v94
    v_exp_f32 v95, v95
    s_nop 0
    v_cvt_pk_bf16_f32 v48, v80, v81
    v_cvt_pk_bf16_f32 v49, v82, v83
    v_cvt_pk_bf16_f32 v50, v84, v85
    v_cvt_pk_bf16_f32 v51, v86, v87
    v_cvt_pk_bf16_f32 v52, v88, v89
    v_cvt_pk_bf16_f32 v53, v90, v91
    v_cvt_pk_bf16_f32 v54, v92, v93
    v_cvt_pk_bf16_f32 v55, v94, v95
    s_waitcnt vmcnt(0)
    s_barrier
    s_setprio 3
    s_waitcnt lgkmcnt(2)
    v_mfma_f32_32x32x16_bf16 v[96:111], v[40:43], v[48:51], v[96:111]
    v_exp_f32 v64, v64
    v_exp_f32 v65, v65
    v_exp_f32 v66, v66
    v_exp_f32 v67, v67
    v_mfma_f32_32x32x16_bf16 v[96:111], v[44:47], v[52:55], v[96:111]
    s_mov_b64 exec, s[16:17]
    ds_read_b128 v[32:35], v150 offset:10240
    ds_read_b128 v[36:39], v151 offset:10240
    s_mov_b64 exec, -1
    v_exp_f32 v68, v68
    v_exp_f32 v69, v69
    v_exp_f32 v70, v70
    v_exp_f32 v71, v71
    s_waitcnt lgkmcnt(2)
    v_mfma_f32_32x32x16_bf16 v[80:95], v[20:23], v[8:11], 0
    v_exp_f32 v72, v72
    v_exp_f32 v73, v73
    v_exp_f32 v74, v74
    v_exp_f32 v75, v75
    v_mfma_f32_32x32x16_bf16 v[80:95], v[28:31], v[12:15], v[80:95]
    ds_read_b128 v[16:19], v144 offset:20480
    ds_read_b64 v[24:25], v145 offset:20480
    v_exp_f32 v76, v76
    v_exp_f32 v77, v77
    v_exp_f32 v78, v78
    v_exp_f32 v79, v79
    s_nop 0
    v_cvt_pk_bf16_f32 v48, v64, v65
    v_cvt_pk_bf16_f32 v49, v66, v67
    v_cvt_pk_bf16_f32 v50, v68, v69
    v_cvt_pk_bf16_f32 v51, v70, v71
    v_cvt_pk_bf16_f32 v52, v72, v73
    v_cvt_pk_bf16_f32 v53, v74, v75
    v_cvt_pk_bf16_f32 v54, v76, v77
    v_cvt_pk_bf16_f32 v55, v78, v79
    s_waitcnt lgkmcnt(2)
    v_mfma_f32_32x32x16_bf16 v[96:111], v[32:35], v[48:51], v[96:111]
    v_exp_f32 v80, v80
    v_exp_f32 v81, v81
    v_exp_f32 v82, v82
    v_exp_f32 v83, v83
    v_mfma_f32_32x32x16_bf16 v[96:111], v[36:39], v[52:55], v[96:111]
    s_mov_b64 exec, s[16:17]
    ds_read_b128 v[40:43], v152 offset:10240
    ds_read_b128 v[44:47], v153 offset:10240
    s_mov_b64 exec, -1
    v_exp_f32 v84, v84
    v_exp_f32 v85, v85
    v_exp_f32 v86, v86
    v_exp_f32 v87, v87
    s_waitcnt lgkmcnt(2)
    v_mfma_f32_32x32x16_bf16 v[64:79], v[16:19], v[8:11], 0
    v_exp_f32 v88, v88
    v_exp_f32 v89, v89
    v_exp_f32 v90, v90
    v_exp_f32 v91, v91
    v_mfma_f32_32x32x16_bf16 v[64:79], v[24:27], v[12:15], v[64:79]
    ds_read_b128 v[20:23], v144 offset:21504
    ds_read_b64 v[28:29], v145 offset:20736
    v_exp_f32 v92, v92
    v_exp_f32 v93, v93
    v_exp_f32 v94, v94
    v_exp_f32 v95, v95
    s_nop 0
    v_cvt_pk_bf16_f32 v48, v80, v81
    v_cvt_pk_bf16_f32 v49, v82, v83
    v_cvt_pk_bf16_f32 v50, v84, v85
    v_cvt_pk_bf16_f32 v51, v86, v87
    v_cvt_pk_bf16_f32 v52, v88, v89
    v_cvt_pk_bf16_f32 v53, v90, v91
    v_cvt_pk_bf16_f32 v54, v92, v93
    v_cvt_pk_bf16_f32 v55, v94, v95
    s_waitcnt lgkmcnt(2)
    v_mfma_f32_32x32x16_bf16 v[96:111], v[40:43], v[48:51], v[96:111]
    v_exp_f32 v64, v64
    v_exp_f32 v65, v65
    v_exp_f32 v66, v66
    v_exp_f32 v67, v67
    v_mfma_f32_32x32x16_bf16 v[96:111], v[44:47], v[52:55], v[96:111]
    s_mov_b64 exec, s[16:17]
    ds_read_b128 v[32:35], v146 offset:20480
    ds_read_b128 v[36:39], v147 offset:20480
    s_mov_b64 exec, -1
    v_exp_f32 v68, v68
    v_exp_f32 v69, v69
    v_exp_f32 v70, v70
    v_exp_f32 v71, v71
    s_waitcnt lgkmcnt(2)
    v_mfma_f32_32x32x16_bf16 v[80:95], v[20:23], v[8:11], 0
    v_exp_f32 v72, v72
    v_exp_f32 v73, v73
    v_exp_f32 v74, v74
    v_exp_f32 v75, v75
    v_mfma_f32_32x32x16_bf16 v[80:95], v[28:31], v[12:15], v[80:95]
    ds_read_b128 v[16:19], v144 offset:22528
    ds_read_b64 v[24:25], v145 offset:20992
    v_exp_f32 v76, v76
    v_exp_f32 v77, v77
    v_exp_f32 v78, v78
    v_exp_f32 v79, v79
    s_nop 0
    v_cvt_pk_bf16_f32 v48, v64, v65
    v_cvt_pk_bf16_f32 v49, v66, v67
    v_cvt_pk_bf16_f32 v50, v68, v69
    v_cvt_pk_bf16_f32 v51, v70, v71
    v_cvt_pk_bf16_f32 v52, v72, v73
    v_cvt_pk_bf16_f32 v53, v74, v75
    v_cvt_pk_bf16_f32 v54, v76, v77
    v_cvt_pk_bf16_f32 v55, v78, v79
    s_waitcnt lgkmcnt(2)
    v_mfma_f32_32x32x16_bf16 v[96:111], v[32:35], v[48:51], v[96:111]
    v_exp_f32 v80, v80
    v_exp_f32 v81, v81
    v_exp_f32 v82, v82
    v_exp_f32 v83, v83
    v_mfma_f32_32x32x16_bf16 v[96:111], v[36:39], v[52:55], v[96:111]
    s_mov_b64 exec, s[16:17]
    ds_read_b128 v[40:43], v148 offset:20480
    ds_read_b128 v[44:47], v149 offset:20480
    s_mov_b64 exec, -1
    v_exp_f32 v84, v84
    v_exp_f32 v85, v85
    v_exp_f32 v86, v86
    v_exp_f32 v87, v87
    s_waitcnt lgkmcnt(2)
    v_mfma_f32_32x32x16_bf16 v[64:79], v[16:19], v[8:11], 0
    v_exp_f32 v88, v88
    v_exp_f32 v89, v89
    v_exp_f32 v90, v90
    v_exp_f32 v91, v91
    v_mfma_f32_32x32x16_bf16 v[64:79], v[24:27], v[12:15], v[64:79]
    ds_read_b128 v[20:23], v144 offset:23552
    ds_read_b64 v[28:29], v145 offset:21248
    v_exp_f32 v92, v92
    v_exp_f32 v93, v93
    v_exp_f32 v94, v94
    v_exp_f32 v95, v95
    s_nop 0
    v_cvt_pk_bf16_f32 v48, v80, v81
    v_cvt_pk_bf16_f32 v49, v82, v83
    v_cvt_pk_bf16_f32 v50, v84, v85
    v_cvt_pk_bf16_f32 v51, v86, v87
    v_cvt_pk_bf16_f32 v52, v88, v89
    v_cvt_pk_bf16_f32 v53, v90, v91
    v_cvt_pk_bf16_f32 v54, v92, v93
    v_cvt_pk_bf16_f32 v55, v94, v95
    s_waitcnt lgkmcnt(2)
    v_mfma_f32_32x32x16_bf16 v[96:111], v[40:43], v[48:51], v[96:111]
    v_exp_f32 v64, v64
    v_exp_f32 v65, v65
    v_exp_f32 v66, v66
    v_exp_f32 v67, v67
    v_mfma_f32_32x32x16_bf16 v[96:111], v[44:47], v[52:55], v[96:111]
    s_mov_b64 exec, s[16:17]
    ds_read_b128 v[32:35], v150 offset:20480
    ds_read_b128 v[36:39], v151 offset:20480
    s_mov_b64 exec, -1
    v_exp_f32 v68, v68
    v_exp_f32 v69, v69
    v_exp_f32 v70, v70
    v_exp_f32 v71, v71
    s_waitcnt lgkmcnt(2)
    v_mfma_f32_32x32x16_bf16 v[80:95], v[20:23], v[8:11], 0
    v_exp_f32 v72, v72
    v_exp_f32 v73, v73
    v_exp_f32 v74, v74
    v_exp_f32 v75, v75
    v_mfma_f32_32x32x16_bf16 v[80:95], v[28:31], v[12:15], v[80:95]
    ds_read_b128 v[16:19], v144 offset:30720
    ds_read_b64 v[24:25], v145 offset:30720
    v_exp_f32 v76, v76
    v_exp_f32 v77, v77
    v_exp_f32 v78, v78
    v_exp_f32 v79, v79
    s_nop 0
    v_cvt_pk_bf16_f32 v48, v64, v65
    v_cvt_pk_bf16_f32 v49, v66, v67
    v_cvt_pk_bf16_f32 v50, v68, v69
    v_cvt_pk_bf16_f32 v51, v70, v71
    v_cvt_pk_bf16_f32 v52, v72, v73
    v_cvt_pk_bf16_f32 v53, v74, v75
    v_cvt_pk_bf16_f32 v54, v76, v77
    v_cvt_pk_bf16_f32 v55, v78, v79
    s_waitcnt lgkmcnt(2)
    v_mfma_f32_32x32x16_bf16 v[96:111], v[32:35], v[48:51], v[96:111]
    v_exp_f32 v80, v80
    v_exp_f32 v81, v81
    v_exp_f32 v82, v82
    v_exp_f32 v83, v83
    v_mfma_f32_32x32x16_bf16 v[96:111], v[36:39], v[52:55], v[96:111]
    s_mov_b64 exec, s[16:17]
    ds_read_b128 v[40:43], v152 offset:20480
    ds_read_b128 v[44:47], v153 offset:20480
    s_mov_b64 exec, -1
    v_exp_f32 v84, v84
    v_exp_f32 v85, v85
    v_exp_f32 v86, v86
    v_exp_f32 v87, v87
    s_waitcnt lgkmcnt(2)
    v_mfma_f32_32x32x16_bf16 v[64:79], v[16:19], v[8:11], 0
    v_exp_f32 v88, v88
    v_exp_f32 v89, v89
    v_exp_f32 v90, v90
    v_exp_f32 v91, v91
    v_mfma_f32_32x32x16_bf16 v[64:79], v[24:27], v[12:15], v[64:79]
    ds_read_b128 v[20:23], v144 offset:31744
    ds_read_b64 v[28:29], v145 offset:30976
    v_exp_f32 v92, v92
    v_exp_f32 v93, v93
    v_exp_f32 v94, v94
    v_exp_f32 v95, v95
    s_nop 0
    v_cvt_pk_bf16_f32 v48, v80, v81
    v_cvt_pk_bf16_f32 v49, v82, v83
    v_cvt_pk_bf16_f32 v50, v84, v85
    v_cvt_pk_bf16_f32 v51, v86, v87
    v_cvt_pk_bf16_f32 v52, v88, v89
    v_cvt_pk_bf16_f32 v53, v90, v91
    v_cvt_pk_bf16_f32 v54, v92, v93
    v_cvt_pk_bf16_f32 v55, v94, v95
    s_waitcnt lgkmcnt(2)
    v_mfma_f32_32x32x16_bf16 v[96:111], v[40:43], v[48:51], v[96:111]
    v_exp_f32 v64, v64
    v_exp_f32 v65, v65
    v_exp_f32 v66, v66
    v_exp_f32 v67, v67
    v_mfma_f32_32x32x16_bf16 v[96:111], v[44:47], v[52:55], v[96:111]
    s_mov_b64 exec, s[16:17]
    ds_read_b128 v[32:35], v146 offset:30720
    ds_read_b128 v[36:39], v147 offset:30720
    s_mov_b64 exec, -1
    v_exp_f32 v68, v68
    v_exp_f32 v69, v69
    v_exp_f32 v70, v70
    v_exp_f32 v71, v71
    s_waitcnt lgkmcnt(2)
    v_mfma_f32_32x32x16_bf16 v[80:95], v[20:23], v[8:11], 0
    v_exp_f32 v72, v72
    v_exp_f32 v73, v73
    v_exp_f32 v74, v74
    v_exp_f32 v75, v75
    v_mfma_f32_32x32x16_bf16 v[80:95], v[28:31], v[12:15], v[80:95]
    ds_read_b128 v[16:19], v144 offset:32768
    ds_read_b64 v[24:25], v145 offset:31232
    v_exp_f32 v76, v76
    v_exp_f32 v77, v77
    v_exp_f32 v78, v78
    v_exp_f32 v79, v79
    s_nop 0
    v_cvt_pk_bf16_f32 v48, v64, v65
    v_cvt_pk_bf16_f32 v49, v66, v67
    v_cvt_pk_bf16_f32 v50, v68, v69
    v_cvt_pk_bf16_f32 v51, v70, v71
    v_cvt_pk_bf16_f32 v52, v72, v73
    v_cvt_pk_bf16_f32 v53, v74, v75
    v_cvt_pk_bf16_f32 v54, v76, v77
    v_cvt_pk_bf16_f32 v55, v78, v79
    s_waitcnt lgkmcnt(2)
    v_mfma_f32_32x32x16_bf16 v[96:111], v[32:35], v[48:51], v[96:111]
    v_exp_f32 v80, v80
    v_exp_f32 v81, v81
    v_exp_f32 v82, v82
    v_exp_f32 v83, v83
    v_mfma_f32_32x32x16_bf16 v[96:111], v[36:39], v[52:55], v[96:111]
    s_mov_b64 exec, s[16:17]
    ds_read_b128 v[40:43], v148 offset:30720
    ds_read_b128 v[44:47], v149 offset:30720
    s_mov_b64 exec, -1
    v_exp_f32 v84, v84
    v_exp_f32 v85, v85
    v_exp_f32 v86, v86
    v_exp_f32 v87, v87
    s_waitcnt lgkmcnt(2)
    v_mfma_f32_32x32x16_bf16 v[64:79], v[16:19], v[8:11], 0
    v_exp_f32 v88, v88
    v_exp_f32 v89, v89
    v_exp_f32 v90, v90
    v_exp_f32 v91, v91
    v_mfma_f32_32x32x16_bf16 v[64:79], v[24:27], v[12:15], v[64:79]
    ds_read_b128 v[20:23], v144 offset:33792
    ds_read_b64 v[28:29], v145 offset:31488
    v_exp_f32 v92, v92
    v_exp_f32 v93, v93
    v_exp_f32 v94, v94
    v_exp_f32 v95, v95
    s_nop 0
    v_cvt_pk_bf16_f32 v48, v80, v81
    v_cvt_pk_bf16_f32 v49, v82, v83
    v_cvt_pk_bf16_f32 v50, v84, v85
    v_cvt_pk_bf16_f32 v51, v86, v87
    v_cvt_pk_bf16_f32 v52, v88, v89
    v_cvt_pk_bf16_f32 v53, v90, v91
    v_cvt_pk_bf16_f32 v54, v92, v93
    v_cvt_pk_bf16_f32 v55, v94, v95
    s_waitcnt lgkmcnt(2)
    v_mfma_f32_32x32x16_bf16 v[96:111], v[40:43], v[48:51], v[96:111]
    v_exp_f32 v64, v64
    v_exp_f32 v65, v65
    v_exp_f32 v66, v66
    v_exp_f32 v67, v67
    v_mfma_f32_32x32x16_bf16 v[96:111], v[44:47], v[52:55], v[96:111]
    s_mov_b64 exec, s[16:17]
    ds_read_b128 v[32:35], v150 offset:30720
    ds_read_b128 v[36:39], v151 offset:30720
    s_mov_b64 exec, -1
    v_exp_f32 v68, v68
    v_exp_f32 v69, v69
    v_exp_f32 v70, v70
    v_exp_f32 v71, v71
    s_waitcnt lgkmcnt(2)
    v_mfma_f32_32x32x16_bf16 v[80:95], v[20:23], v[8:11], 0
    v_exp_f32 v72, v72
    v_exp_f32 v73, v73
    v_exp_f32 v74, v74
    v_exp_f32 v75, v75
    v_mfma_f32_32x32x16_bf16 v[80:95], v[28:31], v[12:15], v[80:95]
    ds_read_b128 v[16:19], v144 offset:40960
    ds_read_b64 v[24:25], v145 offset:40960
    v_exp_f32 v76, v76
    v_exp_f32 v77, v77
    v_exp_f32 v78, v78
    v_exp_f32 v79, v79
    s_nop 0
    v_cvt_pk_bf16_f32 v48, v64, v65
    v_cvt_pk_bf16_f32 v49, v66, v67
    v_cvt_pk_bf16_f32 v50, v68, v69
    v_cvt_pk_bf16_f32 v51, v70, v71
    v_cvt_pk_bf16_f32 v52, v72, v73
    v_cvt_pk_bf16_f32 v53, v74, v75
    v_cvt_pk_bf16_f32 v54, v76, v77
    v_cvt_pk_bf16_f32 v55, v78, v79
    s_waitcnt lgkmcnt(2)
    v_mfma_f32_32x32x16_bf16 v[96:111], v[32:35], v[48:51], v[96:111]
    v_exp_f32 v80, v80
    v_exp_f32 v81, v81
    v_exp_f32 v82, v82
    v_exp_f32 v83, v83
    v_mfma_f32_32x32x16_bf16 v[96:111], v[36:39], v[52:55], v[96:111]
    s_mov_b64 exec, s[16:17]
    ds_read_b128 v[40:43], v152 offset:30720
    ds_read_b128 v[44:47], v153 offset:30720
    s_mov_b64 exec, -1
    v_exp_f32 v84, v84
    v_exp_f32 v85, v85
    v_exp_f32 v86, v86
    v_exp_f32 v87, v87
    s_waitcnt lgkmcnt(2)
    v_mfma_f32_32x32x16_bf16 v[64:79], v[16:19], v[8:11], 0
    v_exp_f32 v88, v88
    v_exp_f32 v89, v89
    v_exp_f32 v90, v90
    v_exp_f32 v91, v91
    v_mfma_f32_32x32x16_bf16 v[64:79], v[24:27], v[12:15], v[64:79]
    ds_read_b128 v[20:23], v144 offset:41984
    ds_read_b64 v[28:29], v145 offset:41216
    v_exp_f32 v92, v92
    v_exp_f32 v93, v93
    v_exp_f32 v94, v94
    v_exp_f32 v95, v95
    s_nop 0
    v_cvt_pk_bf16_f32 v48, v80, v81
    v_cvt_pk_bf16_f32 v49, v82, v83
    v_cvt_pk_bf16_f32 v50, v84, v85
    v_cvt_pk_bf16_f32 v51, v86, v87
    v_cvt_pk_bf16_f32 v52, v88, v89
    v_cvt_pk_bf16_f32 v53, v90, v91
    v_cvt_pk_bf16_f32 v54, v92, v93
    v_cvt_pk_bf16_f32 v55, v94, v95
    s_waitcnt lgkmcnt(2)
    v_mfma_f32_32x32x16_bf16 v[96:111], v[40:43], v[48:51], v[96:111]
    v_exp_f32 v64, v64
    v_exp_f32 v65, v65
    v_exp_f32 v66, v66
    v_exp_f32 v67, v67
    v_mfma_f32_32x32x16_bf16 v[96:111], v[44:47], v[52:55], v[96:111]
    s_mov_b64 exec, s[16:17]
    ds_read_b128 v[32:35], v146 offset:40960
    ds_read_b128 v[36:39], v147 offset:40960
    s_mov_b64 exec, -1
    v_exp_f32 v68, v68
    v_exp_f32 v69, v69
    v_exp_f32 v70, v70
    v_exp_f32 v71, v71
    s_waitcnt lgkmcnt(2)
    v_mfma_f32_32x32x16_bf16 v[80:95], v[20:23], v[8:11], 0
    v_exp_f32 v72, v72
    v_exp_f32 v73, v73
    v_exp_f32 v74, v74
    v_exp_f32 v75, v75
    v_mfma_f32_32x32x16_bf16 v[80:95], v[28:31], v[12:15], v[80:95]
    ds_read_b128 v[16:19], v144 offset:43008
    ds_read_b64 v[24:25], v145 offset:41472
    v_exp_f32 v76, v76
    v_exp_f32 v77, v77
    v_exp_f32 v78, v78
    v_exp_f32 v79, v79
    s_nop 0
    v_cvt_pk_bf16_f32 v48, v64, v65
    v_cvt_pk_bf16_f32 v49, v66, v67
    v_cvt_pk_bf16_f32 v50, v68, v69
    v_cvt_pk_bf16_f32 v51, v70, v71
    v_cvt_pk_bf16_f32 v52, v72, v73
    v_cvt_pk_bf16_f32 v53, v74, v75
    v_cvt_pk_bf16_f32 v54, v76, v77
    v_cvt_pk_bf16_f32 v55, v78, v79
    s_waitcnt lgkmcnt(2)
    v_mfma_f32_32x32x16_bf16 v[96:111], v[32:35], v[48:51], v[96:111]
    v_exp_f32 v80, v80
    v_exp_f32 v81, v81
    v_exp_f32 v82, v82
    v_exp_f32 v83, v83
    v_mfma_f32_32x32x16_bf16 v[96:111], v[36:39], v[52:55], v[96:111]
    s_mov_b64 exec, s[16:17]
    ds_read_b128 v[40:43], v148 offset:40960
    ds_read_b128 v[44:47], v149 offset:40960
    s_mov_b64 exec, -1
    v_exp_f32 v84, v84
    v_exp_f32 v85, v85
    v_exp_f32 v86, v86
    v_exp_f32 v87, v87
    s_waitcnt lgkmcnt(2)
    v_mfma_f32_32x32x16_bf16 v[64:79], v[16:19], v[8:11], 0
    v_exp_f32 v88, v88
    v_exp_f32 v89, v89
    v_exp_f32 v90, v90
    v_exp_f32 v91, v91
    v_mfma_f32_32x32x16_bf16 v[64:79], v[24:27], v[12:15], v[64:79]
    ds_read_b128 v[20:23], v144 offset:44032
    ds_read_b64 v[28:29], v145 offset:41728
    v_exp_f32 v92, v92
    v_exp_f32 v93, v93
    v_exp_f32 v94, v94
    v_exp_f32 v95, v95
    s_nop 0
    v_cvt_pk_bf16_f32 v48, v80, v81
    v_cvt_pk_bf16_f32 v49, v82, v83
    v_cvt_pk_bf16_f32 v50, v84, v85
    v_cvt_pk_bf16_f32 v51, v86, v87
    v_cvt_pk_bf16_f32 v52, v88, v89
    v_cvt_pk_bf16_f32 v53, v90, v91
    v_cvt_pk_bf16_f32 v54, v92, v93
    v_cvt_pk_bf16_f32 v55, v94, v95
    s_waitcnt lgkmcnt(2)
    v_mfma_f32_32x32x16_bf16 v[96:111], v[40:43], v[48:51], v[96:111]
    v_exp_f32 v64, v64
    v_exp_f32 v65, v65
    v_exp_f32 v66, v66
    v_exp_f32 v67, v67
    v_mfma_f32_32x32x16_bf16 v[96:111], v[44:47], v[52:55], v[96:111]
    s_mov_b64 exec, s[16:17]
    ds_read_b128 v[32:35], v150 offset:40960
    ds_read_b128 v[36:39], v151 offset:40960
    s_mov_b64 exec, -1
    v_exp_f32 v68, v68
    v_exp_f32 v69, v69
    v_exp_f32 v70, v70
    v_exp_f32 v71, v71
    s_waitcnt lgkmcnt(2)
    v_mfma_f32_32x32x16_bf16 v[80:95], v[20:23], v[8:11], 0
    v_exp_f32 v72, v72
    v_exp_f32 v73, v73
    v_exp_f32 v74, v74
    v_exp_f32 v75, v75
    v_mfma_f32_32x32x16_bf16 v[80:95], v[28:31], v[12:15], v[80:95]
    ds_read_b128 v[16:19], v144 offset:51200
    ds_read_b64 v[24:25], v145 offset:51200
    v_exp_f32 v76, v76
    v_exp_f32 v77, v77
    v_exp_f32 v78, v78
    v_exp_f32 v79, v79
    s_nop 0
    v_cvt_pk_bf16_f32 v48, v64, v65
    v_cvt_pk_bf16_f32 v49, v66, v67
    v_cvt_pk_bf16_f32 v50, v68, v69
    v_cvt_pk_bf16_f32 v51, v70, v71
    v_cvt_pk_bf16_f32 v52, v72, v73
    v_cvt_pk_bf16_f32 v53, v74, v75
    v_cvt_pk_bf16_f32 v54, v76, v77
    v_cvt_pk_bf16_f32 v55, v78, v79
    s_waitcnt lgkmcnt(2)
    v_mfma_f32_32x32x16_bf16 v[96:111], v[32:35], v[48:51], v[96:111]
    v_exp_f32 v80, v80
    v_exp_f32 v81, v81
    v_exp_f32 v82, v82
    v_exp_f32 v83, v83
    v_mfma_f32_32x32x16_bf16 v[96:111], v[36:39], v[52:55], v[96:111]
    s_mov_b64 exec, s[16:17]
    ds_read_b128 v[40:43], v152 offset:40960
    ds_read_b128 v[44:47], v153 offset:40960
    s_mov_b64 exec, -1
    v_exp_f32 v84, v84
    v_exp_f32 v85, v85
    v_exp_f32 v86, v86
    v_exp_f32 v87, v87
    s_waitcnt lgkmcnt(2)
    v_mfma_f32_32x32x16_bf16 v[64:79], v[16:19], v[8:11], 0
    v_exp_f32 v88, v88
    v_exp_f32 v89, v89
    v_exp_f32 v90, v90
    v_exp_f32 v91, v91
    v_mfma_f32_32x32x16_bf16 v[64:79], v[24:27], v[12:15], v[64:79]
    ds_read_b128 v[20:23], v144 offset:52224
    ds_read_b64 v[28:29], v145 offset:51456
    v_exp_f32 v92, v92
    v_exp_f32 v93, v93
    v_exp_f32 v94, v94
    v_exp_f32 v95, v95
    s_nop 0
    v_cvt_pk_bf16_f32 v48, v80, v81
    v_cvt_pk_bf16_f32 v49, v82, v83
    v_cvt_pk_bf16_f32 v50, v84, v85
    v_cvt_pk_bf16_f32 v51, v86, v87
    v_cvt_pk_bf16_f32 v52, v88, v89
    v_cvt_pk_bf16_f32 v53, v90, v91
    v_cvt_pk_bf16_f32 v54, v92, v93
    v_cvt_pk_bf16_f32 v55, v94, v95
    s_waitcnt lgkmcnt(2)
    v_mfma_f32_32x32x16_bf16 v[96:111], v[40:43], v[48:51], v[96:111]
    v_exp_f32 v64, v64
    v_exp_f32 v65, v65
    v_exp_f32 v66, v66
    v_exp_f32 v67, v67
    v_mfma_f32_32x32x16_bf16 v[96:111], v[44:47], v[52:55], v[96:111]
    s_mov_b64 exec, s[16:17]
    ds_read_b128 v[32:35], v146 offset:51200
    ds_read_b128 v[36:39], v147 offset:51200
    s_mov_b64 exec, -1
    v_exp_f32 v68, v68
    v_exp_f32 v69, v69
    v_exp_f32 v70, v70
    v_exp_f32 v71, v71
    s_waitcnt lgkmcnt(2)
    v_mfma_f32_32x32x16_bf16 v[80:95], v[20:23], v[8:11], 0
    v_exp_f32 v72, v72
    v_exp_f32 v73, v73
    v_exp_f32 v74, v74
    v_exp_f32 v75, v75
    v_mfma_f32_32x32x16_bf16 v[80:95], v[28:31], v[12:15], v[80:95]
    ds_read_b128 v[16:19], v144 offset:53248
    ds_read_b64 v[24:25], v145 offset:51712
    v_exp_f32 v76, v76
    v_exp_f32 v77, v77
    v_exp_f32 v78, v78
    v_exp_f32 v79, v79
    s_nop 0
    v_cvt_pk_bf16_f32 v48, v64, v65
    v_cvt_pk_bf16_f32 v49, v66, v67
    v_cvt_pk_bf16_f32 v50, v68, v69
    v_cvt_pk_bf16_f32 v51, v70, v71
    v_cvt_pk_bf16_f32 v52, v72, v73
    v_cvt_pk_bf16_f32 v53, v74, v75
    v_cvt_pk_bf16_f32 v54, v76, v77
    v_cvt_pk_bf16_f32 v55, v78, v79
    s_waitcnt lgkmcnt(2)
    v_mfma_f32_32x32x16_bf16 v[96:111], v[32:35], v[48:51], v[96:111]
    v_exp_f32 v80, v80
    v_exp_f32 v81, v81
    v_exp_f32 v82, v82
    v_exp_f32 v83, v83
    v_mfma_f32_32x32x16_bf16 v[96:111], v[36:39], v[52:55], v[96:111]
    s_mov_b64 exec, s[16:17]
    ds_read_b128 v[40:43], v148 offset:51200
    ds_read_b128 v[44:47], v149 offset:51200
    s_mov_b64 exec, -1
    v_exp_f32 v84, v84
    v_exp_f32 v85, v85
    v_exp_f32 v86, v86
    v_exp_f32 v87, v87
    s_waitcnt lgkmcnt(2)
    v_mfma_f32_32x32x16_bf16 v[64:79], v[16:19], v[8:11], 0
    v_exp_f32 v88, v88
    v_exp_f32 v89, v89
    v_exp_f32 v90, v90
    v_exp_f32 v91, v91
    v_mfma_f32_32x32x16_bf16 v[64:79], v[24:27], v[12:15], v[64:79]
    ds_read_b128 v[20:23], v144 offset:54272
    ds_read_b64 v[28:29], v145 offset:51968
    v_exp_f32 v92, v92
    v_exp_f32 v93, v93
    v_exp_f32 v94, v94
    v_exp_f32 v95, v95
    s_nop 0
    v_cvt_pk_bf16_f32 v48, v80, v81
    v_cvt_pk_bf16_f32 v49, v82, v83
    v_cvt_pk_bf16_f32 v50, v84, v85
    v_cvt_pk_bf16_f32 v51, v86, v87
    v_cvt_pk_bf16_f32 v52, v88, v89
    v_cvt_pk_bf16_f32 v53, v90, v91
    v_cvt_pk_bf16_f32 v54, v92, v93
    v_cvt_pk_bf16_f32 v55, v94, v95
    s_setprio 2
    s_waitcnt lgkmcnt(2)
    v_mfma_f32_32x32x16_bf16 v[96:111], v[40:43], v[48:51], v[96:111]
    v_exp_f32 v64, v64
    v_exp_f32 v65, v65
    v_exp_f32 v66, v66
    v_exp_f32 v67, v67
    v_mfma_f32_32x32x16_bf16 v[96:111], v[44:47], v[52:55], v[96:111]
    s_mov_b64 exec, s[16:17]
    ds_read_b128 v[32:35], v150 offset:51200
    ds_read_b128 v[36:39], v151 offset:51200
    s_mov_b64 exec, -1
    v_exp_f32 v68, v68
    v_exp_f32 v69, v69
    v_exp_f32 v70, v70
    v_exp_f32 v71, v71
    s_waitcnt lgkmcnt(2)
    v_mfma_f32_32x32x16_bf16 v[80:95], v[20:23], v[8:11], 0
    v_exp_f32 v72, v72
    v_exp_f32 v73, v73
    v_exp_f32 v74, v74
    v_exp_f32 v75, v75
    v_mfma_f32_32x32x16_bf16 v[80:95], v[28:31], v[12:15], v[80:95]
    ds_read_b128 v[16:19], v154 offset:0
    ds_read_b64 v[24:25], v155 offset:0
    v_exp_f32 v76, v76
    v_exp_f32 v77, v77
    v_exp_f32 v78, v78
    v_exp_f32 v79, v79
    s_nop 0
    v_cvt_pk_bf16_f32 v48, v64, v65
    v_cvt_pk_bf16_f32 v49, v66, v67
    v_cvt_pk_bf16_f32 v50, v68, v69
    v_cvt_pk_bf16_f32 v51, v70, v71
    v_cvt_pk_bf16_f32 v52, v72, v73
    v_cvt_pk_bf16_f32 v53, v74, v75
    v_cvt_pk_bf16_f32 v54, v76, v77
    v_cvt_pk_bf16_f32 v55, v78, v79
    s_waitcnt lgkmcnt(2)
    v_mfma_f32_32x32x16_bf16 v[96:111], v[32:35], v[48:51], v[96:111]
    v_exp_f32 v80, v80
    v_exp_f32 v81, v81
    v_exp_f32 v82, v82
    v_exp_f32 v83, v83
    v_mfma_f32_32x32x16_bf16 v[96:111], v[36:39], v[52:55], v[96:111]
    s_mov_b64 exec, s[16:17]
    ds_read_b128 v[40:43], v152 offset:51200
    ds_read_b128 v[44:47], v153 offset:51200
    s_mov_b64 exec, -1
    v_exp_f32 v84, v84
    v_exp_f32 v85, v85
    v_exp_f32 v86, v86
    v_exp_f32 v87, v87
    s_waitcnt lgkmcnt(2)
    v_mfma_f32_32x32x16_bf16 v[64:79], v[16:19], v[8:11], 0
    v_exp_f32 v88, v88
    v_exp_f32 v89, v89
    v_exp_f32 v90, v90
    v_exp_f32 v91, v91
    v_mfma_f32_32x32x16_bf16 v[64:79], v[24:27], v[12:15], v[64:79]
    ds_read_b128 v[20:23], v154 offset:1024
    ds_read_b64 v[28:29], v155 offset:256
    v_exp_f32 v92, v92
    v_exp_f32 v93, v93
    v_exp_f32 v94, v94
    v_exp_f32 v95, v95
    s_nop 0
    v_cvt_pk_bf16_f32 v48, v80, v81
    v_cvt_pk_bf16_f32 v49, v82, v83
    v_cvt_pk_bf16_f32 v50, v84, v85
    v_cvt_pk_bf16_f32 v51, v86, v87
    v_cvt_pk_bf16_f32 v52, v88, v89
    v_cvt_pk_bf16_f32 v53, v90, v91
    v_cvt_pk_bf16_f32 v54, v92, v93
    v_cvt_pk_bf16_f32 v55, v94, v95
    s_waitcnt lgkmcnt(2)
    v_mfma_f32_32x32x16_bf16 v[96:111], v[40:43], v[48:51], v[96:111]
    v_exp_f32 v64, v64
    v_exp_f32 v65, v65
    v_exp_f32 v66, v66
    v_exp_f32 v67, v67
    v_mfma_f32_32x32x16_bf16 v[96:111], v[44:47], v[52:55], v[96:111]
    s_mov_b64 exec, s[16:17]
    ds_read_b128 v[32:35], v156 offset:0
    ds_read_b128 v[36:39], v157 offset:0
    s_mov_b64 exec, -1
    v_exp_f32 v68, v68
    v_exp_f32 v69, v69
    v_exp_f32 v70, v70
    v_exp_f32 v71, v71
    s_waitcnt lgkmcnt(2)
    v_mfma_f32_32x32x16_bf16 v[80:95], v[20:23], v[8:11], 0
    v_exp_f32 v72, v72
    v_exp_f32 v73, v73
    v_exp_f32 v74, v74
    v_exp_f32 v75, v75
    v_mfma_f32_32x32x16_bf16 v[80:95], v[28:31], v[12:15], v[80:95]
    ds_read_b128 v[16:19], v154 offset:2048
    ds_read_b64 v[24:25], v155 offset:512
    v_exp_f32 v76, v76
    v_exp_f32 v77, v77
    v_exp_f32 v78, v78
    v_exp_f32 v79, v79
    s_nop 0
    v_cvt_pk_bf16_f32 v48, v64, v65
    v_cvt_pk_bf16_f32 v49, v66, v67
    v_cvt_pk_bf16_f32 v50, v68, v69
    v_cvt_pk_bf16_f32 v51, v70, v71
    v_cvt_pk_bf16_f32 v52, v72, v73
    v_cvt_pk_bf16_f32 v53, v74, v75
    v_cvt_pk_bf16_f32 v54, v76, v77
    v_cvt_pk_bf16_f32 v55, v78, v79
    s_waitcnt lgkmcnt(2)
    v_mfma_f32_32x32x16_bf16 v[96:111], v[32:35], v[48:51], v[96:111]
    v_exp_f32 v80, v80
    v_exp_f32 v81, v81
    v_exp_f32 v82, v82
    v_exp_f32 v83, v83
    v_mfma_f32_32x32x16_bf16 v[96:111], v[36:39], v[52:55], v[96:111]
    s_mov_b64 exec, s[16:17]
    ds_read_b128 v[40:43], v158 offset:0
    ds_read_b128 v[44:47], v159 offset:0
    s_mov_b64 exec, -1
    v_exp_f32 v84, v84
    v_exp_f32 v85, v85
    v_exp_f32 v86, v86
    v_exp_f32 v87, v87
    s_waitcnt lgkmcnt(2)
    v_mfma_f32_32x32x16_bf16 v[64:79], v[16:19], v[8:11], 0
    v_exp_f32 v88, v88
    v_exp_f32 v89, v89
    v_exp_f32 v90, v90
    v_exp_f32 v91, v91
    v_mfma_f32_32x32x16_bf16 v[64:79], v[24:27], v[12:15], v[64:79]
    ds_read_b128 v[20:23], v154 offset:3072
    ds_read_b64 v[28:29], v155 offset:768
    v_exp_f32 v92, v92
    v_exp_f32 v93, v93
    v_exp_f32 v94, v94
    v_exp_f32 v95, v95
    s_nop 0
    v_cvt_pk_bf16_f32 v48, v80, v81
    v_cvt_pk_bf16_f32 v49, v82, v83
    v_cvt_pk_bf16_f32 v50, v84, v85
    v_cvt_pk_bf16_f32 v51, v86, v87
    v_cvt_pk_bf16_f32 v52, v88, v89
    v_cvt_pk_bf16_f32 v53, v90, v91
    v_cvt_pk_bf16_f32 v54, v92, v93
    v_cvt_pk_bf16_f32 v55, v94, v95
    s_waitcnt lgkmcnt(2)
    v_mfma_f32_32x32x16_bf16 v[96:111], v[40:43], v[48:51], v[96:111]
    v_exp_f32 v64, v64
    v_exp_f32 v65, v65
    v_exp_f32 v66, v66
    v_exp_f32 v67, v67
    v_mfma_f32_32x32x16_bf16 v[96:111], v[44:47], v[52:55], v[96:111]
    s_mov_b64 exec, s[16:17]
    ds_read_b128 v[32:35], v160 offset:0
    ds_read_b128 v[36:39], v161 offset:0
    s_mov_b64 exec, -1
    v_exp_f32 v68, v68
    v_exp_f32 v69, v69
    v_exp_f32 v70, v70
    v_exp_f32 v71, v71
    s_waitcnt lgkmcnt(2)
    v_mfma_f32_32x32x16_bf16 v[80:95], v[20:23], v[8:11], 0
    v_exp_f32 v72, v72
    v_exp_f32 v73, v73
    v_exp_f32 v74, v74
    v_exp_f32 v75, v75
    v_mfma_f32_32x32x16_bf16 v[80:95], v[28:31], v[12:15], v[80:95]
    ds_read_b128 v[16:19], v154 offset:10240
    ds_read_b64 v[24:25], v155 offset:10240
    v_exp_f32 v76, v76
    v_exp_f32 v77, v77
    v_exp_f32 v78, v78
    v_exp_f32 v79, v79
    s_nop 0
    v_cvt_pk_bf16_f32 v48, v64, v65
    v_cvt_pk_bf16_f32 v49, v66, v67
    v_cvt_pk_bf16_f32 v50, v68, v69
    v_cvt_pk_bf16_f32 v51, v70, v71
    v_cvt_pk_bf16_f32 v52, v72, v73
    v_cvt_pk_bf16_f32 v53, v74, v75
    v_cvt_pk_bf16_f32 v54, v76, v77
    v_cvt_pk_bf16_f32 v55, v78, v79
    s_waitcnt lgkmcnt(2)
    v_mfma_f32_32x32x16_bf16 v[96:111], v[32:35], v[48:51], v[96:111]
    v_exp_f32 v80, v80
    v_exp_f32 v81, v81
    v_exp_f32 v82, v82
    v_exp_f32 v83, v83
    v_mfma_f32_32x32x16_bf16 v[96:111], v[36:39], v[52:55], v[96:111]
    s_mov_b64 exec, s[16:17]
    ds_read_b128 v[40:43], v162 offset:0
    ds_read_b128 v[44:47], v163 offset:0
    s_mov_b64 exec, -1
    v_exp_f32 v84, v84
    v_exp_f32 v85, v85
    v_exp_f32 v86, v86
    v_exp_f32 v87, v87
    s_waitcnt lgkmcnt(2)
    v_mfma_f32_32x32x16_bf16 v[64:79], v[16:19], v[8:11], 0
    v_exp_f32 v88, v88
    v_exp_f32 v89, v89
    v_exp_f32 v90, v90
    v_exp_f32 v91, v91
    v_mfma_f32_32x32x16_bf16 v[64:79], v[24:27], v[12:15], v[64:79]
    ds_read_b128 v[20:23], v154 offset:11264
    ds_read_b64 v[28:29], v155 offset:10496
    v_exp_f32 v92, v92
    v_exp_f32 v93, v93
    v_exp_f32 v94, v94
    v_exp_f32 v95, v95
    s_nop 0
    v_cvt_pk_bf16_f32 v48, v80, v81
    v_cvt_pk_bf16_f32 v49, v82, v83
    v_cvt_pk_bf16_f32 v50, v84, v85
    v_cvt_pk_bf16_f32 v51, v86, v87
    v_cvt_pk_bf16_f32 v52, v88, v89
    v_cvt_pk_bf16_f32 v53, v90, v91
    v_cvt_pk_bf16_f32 v54, v92, v93
    v_cvt_pk_bf16_f32 v55, v94, v95
    s_waitcnt lgkmcnt(2)
    v_mfma_f32_32x32x16_bf16 v[96:111], v[40:43], v[48:51], v[96:111]
    v_exp_f32 v64, v64
    v_exp_f32 v65, v65
    v_exp_f32 v66, v66
    v_exp_f32 v67, v67
    v_mfma_f32_32x32x16_bf16 v[96:111], v[44:47], v[52:55], v[96:111]
    s_mov_b64 exec, s[16:17]
    ds_read_b128 v[32:35], v156 offset:10240
    ds_read_b128 v[36:39], v157 offset:10240
    s_mov_b64 exec, -1
    v_exp_f32 v68, v68
    v_exp_f32 v69, v69
    v_exp_f32 v70, v70
    v_exp_f32 v71, v71
    s_waitcnt lgkmcnt(2)
    v_mfma_f32_32x32x16_bf16 v[80:95], v[20:23], v[8:11], 0
    v_exp_f32 v72, v72
    v_exp_f32 v73, v73
    v_exp_f32 v74, v74
    v_exp_f32 v75, v75
    v_mfma_f32_32x32x16_bf16 v[80:95], v[28:31], v[12:15], v[80:95]
    ds_read_b128 v[16:19], v154 offset:12288
    ds_read_b64 v[24:25], v155 offset:10752
    v_exp_f32 v76, v76
    v_exp_f32 v77, v77
    v_exp_f32 v78, v78
    v_exp_f32 v79, v79
    s_nop 0
    v_cvt_pk_bf16_f32 v48, v64, v65
    v_cvt_pk_bf16_f32 v49, v66, v67
    v_cvt_pk_bf16_f32 v50, v68, v69
    v_cvt_pk_bf16_f32 v51, v70, v71
    v_cvt_pk_bf16_f32 v52, v72, v73
    v_cvt_pk_bf16_f32 v53, v74, v75
    v_cvt_pk_bf16_f32 v54, v76, v77
    v_cvt_pk_bf16_f32 v55, v78, v79
    s_waitcnt lgkmcnt(2)
    v_mfma_f32_32x32x16_bf16 v[96:111], v[32:35], v[48:51], v[96:111]
    v_exp_f32 v80, v80
    v_exp_f32 v81, v81
    v_exp_f32 v82, v82
    v_exp_f32 v83, v83
    v_mfma_f32_32x32x16_bf16 v[96:111], v[36:39], v[52:55], v[96:111]
    s_mov_b64 exec, s[16:17]
    ds_read_b128 v[40:43], v158 offset:10240
    ds_read_b128 v[44:47], v159 offset:10240
    s_mov_b64 exec, -1
    v_exp_f32 v84, v84
    v_exp_f32 v85, v85
    v_exp_f32 v86, v86
    v_exp_f32 v87, v87
    s_waitcnt lgkmcnt(2)
    v_mfma_f32_32x32x16_bf16 v[64:79], v[16:19], v[8:11], 0
    v_exp_f32 v88, v88
    v_exp_f32 v89, v89
    v_exp_f32 v90, v90
    v_exp_f32 v91, v91
    v_mfma_f32_32x32x16_bf16 v[64:79], v[24:27], v[12:15], v[64:79]
    ds_read_b128 v[20:23], v154 offset:13312
    ds_read_b64 v[28:29], v155 offset:11008
    v_exp_f32 v92, v92
    v_exp_f32 v93, v93
    v_exp_f32 v94, v94
    v_exp_f32 v95, v95
    s_nop 0
    v_cvt_pk_bf16_f32 v48, v80, v81
    v_cvt_pk_bf16_f32 v49, v82, v83
    v_cvt_pk_bf16_f32 v50, v84, v85
    v_cvt_pk_bf16_f32 v51, v86, v87
    v_cvt_pk_bf16_f32 v52, v88, v89
    v_cvt_pk_bf16_f32 v53, v90, v91
    v_cvt_pk_bf16_f32 v54, v92, v93
    v_cvt_pk_bf16_f32 v55, v94, v95
    s_waitcnt lgkmcnt(2)
    v_mfma_f32_32x32x16_bf16 v[96:111], v[40:43], v[48:51], v[96:111]
    v_exp_f32 v64, v64
    v_exp_f32 v65, v65
    v_exp_f32 v66, v66
    v_exp_f32 v67, v67
    v_mfma_f32_32x32x16_bf16 v[96:111], v[44:47], v[52:55], v[96:111]
    s_mov_b64 exec, s[16:17]
    ds_read_b128 v[32:35], v160 offset:10240
    ds_read_b128 v[36:39], v161 offset:10240
    s_mov_b64 exec, -1
    v_exp_f32 v68, v68
    v_exp_f32 v69, v69
    v_exp_f32 v70, v70
    v_exp_f32 v71, v71
    s_waitcnt lgkmcnt(2)
    v_mfma_f32_32x32x16_bf16 v[80:95], v[20:23], v[8:11], 0
    v_exp_f32 v72, v72
    v_exp_f32 v73, v73
    v_exp_f32 v74, v74
    v_exp_f32 v75, v75
    v_mfma_f32_32x32x16_bf16 v[80:95], v[28:31], v[12:15], v[80:95]
    ds_read_b128 v[16:19], v154 offset:20480
    ds_read_b64 v[24:25], v155 offset:20480
    v_exp_f32 v76, v76
    v_exp_f32 v77, v77
    v_exp_f32 v78, v78
    v_exp_f32 v79, v79
    s_nop 0
    v_cvt_pk_bf16_f32 v48, v64, v65
    v_cvt_pk_bf16_f32 v49, v66, v67
    v_cvt_pk_bf16_f32 v50, v68, v69
    v_cvt_pk_bf16_f32 v51, v70, v71
    v_cvt_pk_bf16_f32 v52, v72, v73
    v_cvt_pk_bf16_f32 v53, v74, v75
    v_cvt_pk_bf16_f32 v54, v76, v77
    v_cvt_pk_bf16_f32 v55, v78, v79
    s_waitcnt lgkmcnt(2)
    v_mfma_f32_32x32x16_bf16 v[96:111], v[32:35], v[48:51], v[96:111]
    v_exp_f32 v80, v80
    v_exp_f32 v81, v81
    v_exp_f32 v82, v82
    v_exp_f32 v83, v83
    v_mfma_f32_32x32x16_bf16 v[96:111], v[36:39], v[52:55], v[96:111]
    s_mov_b64 exec, s[16:17]
    ds_read_b128 v[40:43], v162 offset:10240
    ds_read_b128 v[44:47], v163 offset:10240
    s_mov_b64 exec, -1
    v_exp_f32 v84, v84
    v_exp_f32 v85, v85
    v_exp_f32 v86, v86
    v_exp_f32 v87, v87
    s_waitcnt lgkmcnt(2)
    v_mfma_f32_32x32x16_bf16 v[64:79], v[16:19], v[8:11], 0
    v_exp_f32 v88, v88
    v_exp_f32 v89, v89
    v_exp_f32 v90, v90
    v_exp_f32 v91, v91
    v_mfma_f32_32x32x16_bf16 v[64:79], v[24:27], v[12:15], v[64:79]
    ds_read_b128 v[20:23], v154 offset:21504
    ds_read_b64 v[28:29], v155 offset:20736
    v_exp_f32 v92, v92
    v_exp_f32 v93, v93
    v_exp_f32 v94, v94
    v_exp_f32 v95, v95
    s_nop 0
    v_cvt_pk_bf16_f32 v48, v80, v81
    v_cvt_pk_bf16_f32 v49, v82, v83
    v_cvt_pk_bf16_f32 v50, v84, v85
    v_cvt_pk_bf16_f32 v51, v86, v87
    v_cvt_pk_bf16_f32 v52, v88, v89
    v_cvt_pk_bf16_f32 v53, v90, v91
    v_cvt_pk_bf16_f32 v54, v92, v93
    v_cvt_pk_bf16_f32 v55, v94, v95
    s_setprio 1
    s_waitcnt lgkmcnt(2)
    v_mfma_f32_32x32x16_bf16 v[96:111], v[40:43], v[48:51], v[96:111]
    v_exp_f32 v64, v64
    v_exp_f32 v65, v65
    v_exp_f32 v66, v66
    v_exp_f32 v67, v67
    v_mfma_f32_32x32x16_bf16 v[96:111], v[44:47], v[52:55], v[96:111]
    s_mov_b64 exec, s[16:17]
    ds_read_b128 v[32:35], v156 offset:20480
    ds_read_b128 v[36:39], v157 offset:20480
    s_mov_b64 exec, -1
    v_exp_f32 v68, v68
    v_exp_f32 v69, v69
    v_exp_f32 v70, v70
    v_exp_f32 v71, v71
    s_waitcnt lgkmcnt(2)
    v_mfma_f32_32x32x16_bf16 v[80:95], v[20:23], v[8:11], 0
    v_exp_f32 v72, v72
    v_exp_f32 v73, v73
    v_exp_f32 v74, v74
    v_exp_f32 v75, v75
    v_mfma_f32_32x32x16_bf16 v[80:95], v[28:31], v[12:15], v[80:95]
    ds_read_b128 v[16:19], v154 offset:22528
    ds_read_b64 v[24:25], v155 offset:20992
    v_exp_f32 v76, v76
    v_exp_f32 v77, v77
    v_exp_f32 v78, v78
    v_exp_f32 v79, v79
    s_nop 0
    v_cvt_pk_bf16_f32 v48, v64, v65
    v_cvt_pk_bf16_f32 v49, v66, v67
    v_cvt_pk_bf16_f32 v50, v68, v69
    v_cvt_pk_bf16_f32 v51, v70, v71
    v_cvt_pk_bf16_f32 v52, v72, v73
    v_cvt_pk_bf16_f32 v53, v74, v75
    v_cvt_pk_bf16_f32 v54, v76, v77
    v_cvt_pk_bf16_f32 v55, v78, v79
    s_waitcnt lgkmcnt(2)
    v_mfma_f32_32x32x16_bf16 v[96:111], v[32:35], v[48:51], v[96:111]
    v_exp_f32 v80, v80
    v_exp_f32 v81, v81
    v_exp_f32 v82, v82
    v_exp_f32 v83, v83
    v_mfma_f32_32x32x16_bf16 v[96:111], v[36:39], v[52:55], v[96:111]
    s_mov_b64 exec, s[16:17]
    ds_read_b128 v[40:43], v158 offset:20480
    ds_read_b128 v[44:47], v159 offset:20480
    s_mov_b64 exec, -1
    v_exp_f32 v84, v84
    v_exp_f32 v85, v85
    v_exp_f32 v86, v86
    v_exp_f32 v87, v87
    s_waitcnt lgkmcnt(2)
    v_mfma_f32_32x32x16_bf16 v[64:79], v[16:19], v[8:11], 0
    v_exp_f32 v88, v88
    v_exp_f32 v89, v89
    v_exp_f32 v90, v90
    v_exp_f32 v91, v91
    v_mfma_f32_32x32x16_bf16 v[64:79], v[24:27], v[12:15], v[64:79]
    ds_read_b128 v[20:23], v154 offset:23552
    ds_read_b64 v[28:29], v155 offset:21248
    v_exp_f32 v92, v92
    v_exp_f32 v93, v93
    v_exp_f32 v94, v94
    v_exp_f32 v95, v95
    s_nop 0
    v_cvt_pk_bf16_f32 v48, v80, v81
    v_cvt_pk_bf16_f32 v49, v82, v83
    v_cvt_pk_bf16_f32 v50, v84, v85
    v_cvt_pk_bf16_f32 v51, v86, v87
    v_cvt_pk_bf16_f32 v52, v88, v89
    v_cvt_pk_bf16_f32 v53, v90, v91
    v_cvt_pk_bf16_f32 v54, v92, v93
    v_cvt_pk_bf16_f32 v55, v94, v95
    s_waitcnt lgkmcnt(2)
    v_mfma_f32_32x32x16_bf16 v[96:111], v[40:43], v[48:51], v[96:111]
    v_exp_f32 v64, v64
    v_exp_f32 v65, v65
    v_exp_f32 v66, v66
    v_exp_f32 v67, v67
    v_mfma_f32_32x32x16_bf16 v[96:111], v[44:47], v[52:55], v[96:111]
    s_mov_b64 exec, s[16:17]
    ds_read_b128 v[32:35], v160 offset:20480
    ds_read_b128 v[36:39], v161 offset:20480
    s_mov_b64 exec, -1
    v_exp_f32 v68, v68
    v_exp_f32 v69, v69
    v_exp_f32 v70, v70
    v_exp_f32 v71, v71
    s_waitcnt lgkmcnt(2)
    v_mfma_f32_32x32x16_bf16 v[80:95], v[20:23], v[8:11], 0
    v_exp_f32 v72, v72
    v_exp_f32 v73, v73
    v_exp_f32 v74, v74
    v_exp_f32 v75, v75
    v_mfma_f32_32x32x16_bf16 v[80:95], v[28:31], v[12:15], v[80:95]
    ds_read_b128 v[16:19], v154 offset:30720
    ds_read_b64 v[24:25], v155 offset:30720
    v_exp_f32 v76, v76
    v_exp_f32 v77, v77
    v_exp_f32 v78, v78
    v_exp_f32 v79, v79
    s_nop 0
    v_cvt_pk_bf16_f32 v48, v64, v65
    v_cvt_pk_bf16_f32 v49, v66, v67
    v_cvt_pk_bf16_f32 v50, v68, v69
    v_cvt_pk_bf16_f32 v51, v70, v71
    v_cvt_pk_bf16_f32 v52, v72, v73
    v_cvt_pk_bf16_f32 v53, v74, v75
    v_cvt_pk_bf16_f32 v54, v76, v77
    v_cvt_pk_bf16_f32 v55, v78, v79
    s_waitcnt lgkmcnt(2)
    v_mfma_f32_32x32x16_bf16 v[96:111], v[32:35], v[48:51], v[96:111]
    v_exp_f32 v80, v80
    v_exp_f32 v81, v81
    v_exp_f32 v82, v82
    v_exp_f32 v83, v83
    v_mfma_f32_32x32x16_bf16 v[96:111], v[36:39], v[52:55], v[96:111]
    s_mov_b64 exec, s[16:17]
    ds_read_b128 v[40:43], v162 offset:20480
    ds_read_b128 v[44:47], v163 offset:20480
    s_mov_b64 exec, -1
    v_exp_f32 v84, v84
    v_exp_f32 v85, v85
    v_exp_f32 v86, v86
    v_exp_f32 v87, v87
    s_waitcnt lgkmcnt(2)
    v_mfma_f32_32x32x16_bf16 v[64:79], v[16:19], v[8:11], 0
    v_exp_f32 v88, v88
    v_exp_f32 v89, v89
    v_exp_f32 v90, v90
    v_exp_f32 v91, v91
    v_mfma_f32_32x32x16_bf16 v[64:79], v[24:27], v[12:15], v[64:79]
    ds_read_b128 v[20:23], v154 offset:31744
    ds_read_b64 v[28:29], v155 offset:30976
    v_exp_f32 v92, v92
    v_exp_f32 v93, v93
    v_exp_f32 v94, v94
    v_exp_f32 v95, v95
    s_nop 0
    v_cvt_pk_bf16_f32 v48, v80, v81
    v_cvt_pk_bf16_f32 v49, v82, v83
    v_cvt_pk_bf16_f32 v50, v84, v85
    v_cvt_pk_bf16_f32 v51, v86, v87
    v_cvt_pk_bf16_f32 v52, v88, v89
    v_cvt_pk_bf16_f32 v53, v90, v91
    v_cvt_pk_bf16_f32 v54, v92, v93
    v_cvt_pk_bf16_f32 v55, v94, v95
    s_waitcnt lgkmcnt(2)
    v_mfma_f32_32x32x16_bf16 v[96:111], v[40:43], v[48:51], v[96:111]
    v_exp_f32 v64, v64
    v_exp_f32 v65, v65
    v_exp_f32 v66, v66
    v_exp_f32 v67, v67
    v_mfma_f32_32x32x16_bf16 v[96:111], v[44:47], v[52:55], v[96:111]
    s_mov_b64 exec, s[16:17]
    ds_read_b128 v[32:35], v156 offset:30720
    ds_read_b128 v[36:39], v157 offset:30720
    s_mov_b64 exec, -1
    v_exp_f32 v68, v68
    v_exp_f32 v69, v69
    v_exp_f32 v70, v70
    v_exp_f32 v71, v71
    s_waitcnt lgkmcnt(2)
    v_mfma_f32_32x32x16_bf16 v[80:95], v[20:23], v[8:11], 0
    v_exp_f32 v72, v72
    v_exp_f32 v73, v73
    v_exp_f32 v74, v74
    v_exp_f32 v75, v75
    v_mfma_f32_32x32x16_bf16 v[80:95], v[28:31], v[12:15], v[80:95]
    ds_read_b128 v[16:19], v154 offset:32768
    ds_read_b64 v[24:25], v155 offset:31232
    v_exp_f32 v76, v76
    v_exp_f32 v77, v77
    v_exp_f32 v78, v78
    v_exp_f32 v79, v79
    s_nop 0
    v_cvt_pk_bf16_f32 v48, v64, v65
    v_cvt_pk_bf16_f32 v49, v66, v67
    v_cvt_pk_bf16_f32 v50, v68, v69
    v_cvt_pk_bf16_f32 v51, v70, v71
    v_cvt_pk_bf16_f32 v52, v72, v73
    v_cvt_pk_bf16_f32 v53, v74, v75
    v_cvt_pk_bf16_f32 v54, v76, v77
    v_cvt_pk_bf16_f32 v55, v78, v79
    s_setprio 0
    s_waitcnt lgkmcnt(2)
    v_mfma_f32_32x32x16_bf16 v[96:111], v[32:35], v[48:51], v[96:111]
    v_exp_f32 v80, v80
    v_exp_f32 v81, v81
    v_exp_f32 v82, v82
    v_exp_f32 v83, v83
    v_mfma_f32_32x32x16_bf16 v[96:111], v[36:39], v[52:55], v[96:111]
    s_mov_b64 exec, s[16:17]
    ds_read_b128 v[40:43], v158 offset:30720
    ds_read_b128 v[44:47], v159 offset:30720
    s_mov_b64 exec, -1
    v_exp_f32 v84, v84
    v_exp_f32 v85, v85
    v_exp_f32 v86, v86
    v_exp_f32 v87, v87
    s_waitcnt lgkmcnt(2)
    v_mfma_f32_32x32x16_bf16 v[64:79], v[16:19], v[8:11], 0
    v_exp_f32 v88, v88
    v_exp_f32 v89, v89
    v_exp_f32 v90, v90
    v_exp_f32 v91, v91
    v_mfma_f32_32x32x16_bf16 v[64:79], v[24:27], v[12:15], v[64:79]
    ds_read_b128 v[20:23], v154 offset:33792
    ds_read_b64 v[28:29], v155 offset:31488
    v_exp_f32 v92, v92
    v_exp_f32 v93, v93
    v_exp_f32 v94, v94
    v_exp_f32 v95, v95
    s_nop 0
    v_cvt_pk_bf16_f32 v48, v80, v81
    v_cvt_pk_bf16_f32 v49, v82, v83
    v_cvt_pk_bf16_f32 v50, v84, v85
    v_cvt_pk_bf16_f32 v51, v86, v87
    v_cvt_pk_bf16_f32 v52, v88, v89
    v_cvt_pk_bf16_f32 v53, v90, v91
    v_cvt_pk_bf16_f32 v54, v92, v93
    v_cvt_pk_bf16_f32 v55, v94, v95
    s_waitcnt lgkmcnt(2)
    v_mfma_f32_32x32x16_bf16 v[96:111], v[40:43], v[48:51], v[96:111]
    v_exp_f32 v64, v64
    v_exp_f32 v65, v65
    v_exp_f32 v66, v66
    v_exp_f32 v67, v67
    v_mfma_f32_32x32x16_bf16 v[96:111], v[44:47], v[52:55], v[96:111]
    s_mov_b64 exec, s[16:17]
    ds_read_b128 v[32:35], v160 offset:30720
    ds_read_b128 v[36:39], v161 offset:30720
    s_mov_b64 exec, -1
    v_exp_f32 v68, v68
    v_exp_f32 v69, v69
    v_exp_f32 v70, v70
    v_exp_f32 v71, v71
    s_waitcnt lgkmcnt(2)
    v_mfma_f32_32x32x16_bf16 v[80:95], v[20:23], v[8:11], 0
    v_exp_f32 v72, v72
    v_exp_f32 v73, v73
    v_exp_f32 v74, v74
    v_exp_f32 v75, v75
    v_mfma_f32_32x32x16_bf16 v[80:95], v[28:31], v[12:15], v[80:95]
    v_exp_f32 v76, v76
    v_exp_f32 v77, v77
    v_exp_f32 v78, v78
    v_exp_f32 v79, v79
    s_nop 0
    v_cvt_pk_bf16_f32 v48, v64, v65
    v_cvt_pk_bf16_f32 v49, v66, v67
    v_cvt_pk_bf16_f32 v50, v68, v69
    v_cvt_pk_bf16_f32 v51, v70, v71
    v_cvt_pk_bf16_f32 v52, v72, v73
    v_cvt_pk_bf16_f32 v53, v74, v75
    v_cvt_pk_bf16_f32 v54, v76, v77
    v_cvt_pk_bf16_f32 v55, v78, v79
    s_waitcnt lgkmcnt(0)
    v_mfma_f32_32x32x16_bf16 v[96:111], v[32:35], v[48:51], v[96:111]
    v_exp_f32 v80, v80
    v_exp_f32 v81, v81
    v_exp_f32 v82, v82
    v_exp_f32 v83, v83
    v_mfma_f32_32x32x16_bf16 v[96:111], v[36:39], v[52:55], v[96:111]
    s_mov_b64 exec, s[16:17]
    ds_read_b128 v[40:43], v162 offset:30720
    ds_read_b128 v[44:47], v163 offset:30720
    s_mov_b64 exec, -1
    v_exp_f32 v84, v84
    v_exp_f32 v85, v85
    v_exp_f32 v86, v86
    v_exp_f32 v87, v87
    v_exp_f32 v88, v88
    v_exp_f32 v89, v89
    v_exp_f32 v90, v90
    v_exp_f32 v91, v91
    v_exp_f32 v92, v92
    v_exp_f32 v93, v93
    v_exp_f32 v94, v94
    v_exp_f32 v95, v95
    s_nop 0
    v_cvt_pk_bf16_f32 v48, v80, v81
    v_cvt_pk_bf16_f32 v49, v82, v83
    v_cvt_pk_bf16_f32 v50, v84, v85
    v_cvt_pk_bf16_f32 v51, v86, v87
    v_cvt_pk_bf16_f32 v52, v88, v89
    v_cvt_pk_bf16_f32 v53, v90, v91
    v_cvt_pk_bf16_f32 v54, v92, v93
    v_cvt_pk_bf16_f32 v55, v94, v95
    s_waitcnt lgkmcnt(0)
    v_mfma_f32_32x32x16_bf16 v[96:111], v[40:43], v[48:51], v[96:111]
    v_mfma_f32_32x32x16_bf16 v[96:111], v[44:47], v[52:55], v[96:111]
attn_fin:
    s_nop 15
    s_nop 3
    v_mov_b32 v58, v104
    v_mov_b32 v59, v104
    s_nop 1
    v_permlane32_swap_b32 v58, v59
    v_mov_b32 v57, 562036736
    s_cmp_eq_u32 s11, 16
    v_cmp_nge_f32 vcc, v59, v57
    s_cbranch_scc0 attn_out
    s_cbranch_vccnz attn_fb
attn_out:
    v_rcp_f32 v59, v59
    s_nop 0
    v_mul_f32 v96, v96, v59
    v_mul_f32 v97, v97, v59
    v_mul_f32 v98, v98, v59
    v_mul_f32 v99, v99, v59
    v_mul_f32 v100, v100, v59
    v_mul_f32 v101, v101, v59
    v_mul_f32 v102, v102, v59
    v_mul_f32 v103, v103, v59
    v_mul_f32 v104, v104, v59
    v_mul_f32 v105, v105, v59
    v_mul_f32 v106, v106, v59
    v_mul_f32 v107, v107, v59
    v_cvt_pk_bf16_f32 v48, v96, v97
    v_cvt_pk_bf16_f32 v49, v98, v99
    v_cvt_pk_bf16_f32 v50, v100, v101
    v_cvt_pk_bf16_f32 v51, v102, v103
    v_cvt_pk_bf16_f32 v52, v104, v105
    v_cvt_pk_bf16_f32 v53, v106, v107
    v_lshrrev_b32 v56, 4, v6
    v_mul_u32_u24 v56, 20480, v56
    v_and_b32 v57, 15, v6
    v_lshl_add_u32 v56, v57, 4, v56
    s_mul_i32 s10, s5, 20
    v_lshl_add_u32 v57, v4, 2, s10
    v_lshrrev_b32 v60, 3, v57
    v_lshl_add_u32 v60, v60, 8, v56
    v_bfe_u32 v61, v57, 2, 1
    v_lshl_add_u32 v60, v61, 3, v60
    buffer_store_dwordx2 v[48:49], v60, s[52:55], 0 offen
    v_add_u32 v57, 8, v57
    v_lshrrev_b32 v60, 3, v57
    v_lshl_add_u32 v60, v60, 8, v56
    v_bfe_u32 v61, v57, 2, 1
    v_lshl_add_u32 v60, v61, 3, v60
    buffer_store_dwordx2 v[50:51], v60, s[52:55], 0 offen
    v_add_u32 v57, 8, v57
    v_lshrrev_b32 v60, 3, v57
    v_lshl_add_u32 v60, v60, 8, v56
    v_bfe_u32 v61, v57, 2, 1
    v_lshl_add_u32 v60, v61, 3, v60
    v_cmp_eq_u32 vcc, 0, v4
    s_and_saveexec_b64 s[14:15], vcc
    s_cbranch_execz attn_end
    buffer_store_dwordx2 v[52:53], v60, s[52:55], 0 offen
    s_endpgm
attn_fb:
    v_lshlrev_b32 v128, 5, v3
    v_lshl_add_u32 v128, v4, 4, v128
    v_lshlrev_b32 v129, 3, v3
    v_add_u32 v129, 4096, v129
    v_and_b32 v61, 15, v3
    v_add_u32 v130, 0, v4
    v_xor_b32 v130, v130, v61
    v_lshlrev_b32 v130, 4, v130
    v_lshl_add_u32 v130, v3, 8, v130
    v_add_u32 v130, 5120, v130
    v_add_u32 v131, 2, v4
    v_xor_b32 v131, v131, v61
    v_lshlrev_b32 v131, 4, v131
    v_lshl_add_u32 v131, v3, 8, v131
    v_add_u32 v131, 5120, v131
    v_add_u32 v132, 4, v4
    v_xor_b32 v132, v132, v61
    v_lshlrev_b32 v132, 4, v132
    v_lshl_add_u32 v132, v3, 8, v132
    v_add_u32 v132, 5120, v132
    v_add_u32 v133, 6, v4
    v_xor_b32 v133, v133, v61
    v_lshlrev_b32 v133, 4, v133
    v_lshl_add_u32 v133, v3, 8, v133
    v_add_u32 v133, 5120, v133
    v_add_u32 v134, 8, v4
    v_xor_b32 v134, v134, v61
    v_lshlrev_b32 v134, 4, v134
    v_lshl_add_u32 v134, v3, 8, v134
    v_add_u32 v134, 5120, v134
    v_add_u32 v135, 10, v4
    v_xor_b32 v135, v135, v61
    v_lshlrev_b32 v135, 4, v135
    v_lshl_add_u32 v135, v3, 8, v135
    v_add_u32 v135, 5120, v135
    v_add_u32 v136, 12, v4
    v_xor_b32 v136, v136, v61
    v_lshlrev_b32 v136, 4, v136
    v_lshl_add_u32 v136, v3, 8, v136
    v_add_u32 v136, 5120, v136
    v_add_u32 v137, 14, v4
    v_xor_b32 v137, v137, v61
    v_lshlrev_b32 v137, 4, v137
    v_lshl_add_u32 v137, v3, 8, v137
    v_add_u32 v137, 5120, v137
    v_mov_b32 v96, 0
    v_mov_b32 v97, 0
    v_mov_b32 v98, 0
    v_mov_b32 v99, 0
    v_mov_b32 v100, 0
    v_mov_b32 v101, 0
    v_mov_b32 v102, 0
    v_mov_b32 v103, 0
    v_mov_b32 v104, 0
    v_mov_b32 v105, 0
    v_mov_b32 v106, 0
    v_mov_b32 v107, 0
    v_mov_b32 v108, 0
    v_mov_b32 v109, 0
    v_mov_b32 v110, 0
    v_mov_b32 v111, 0
    v_mov_b32 v14, 0
    v_mov_b32 v56, 0xff800000
    s_mov_b32 s11, 32
attn_fb_loop:
    ds_read_b128 v[16:19], v128 offset:0
    ds_read_b64 v[24:25], v129 offset:0
    s_mov_b64 exec, s[16:17]
    ds_read_b128 v[32:35], v130
    ds_read_b128 v[36:39], v131
    s_mov_b64 exec, -1
    s_waitcnt lgkmcnt(0)
    v_mfma_f32_32x32x16_bf16 v[64:79], v[16:19], v[8:11], 0
    v_mfma_f32_32x32x16_bf16 v[64:79], v[24:27], v[12:15], v[64:79]
    s_nop 15
    s_nop 3
    v_max3_f32 v58, v64, v65, v66
    v_max3_f32 v59, v67, v68, v69
    v_max3_f32 v60, v70, v71, v72
    v_max3_f32 v61, v73, v74, v75
    v_max3_f32 v62, v76, v77, v78
    v_max3_f32 v58, v58, v59, v79
    v_max3_f32 v60, v60, v61, v62
    v_max3_f32 v58, v58, v60, v56
    v_mov_b32 v59, v58
    s_nop 1
    v_permlane32_swap_b32 v58, v59
    v_max_f32 v58, v58, v59
    v_sub_f32 v59, v56, v58
    v_exp_f32 v59, v59
    v_mov_b32 v56, v58
    v_mul_f32 v96, v96, v59
    v_mul_f32 v97, v97, v59
    v_mul_f32 v98, v98, v59
    v_mul_f32 v99, v99, v59
    v_mul_f32 v100, v100, v59
    v_mul_f32 v101, v101, v59
    v_mul_f32 v102, v102, v59
    v_mul_f32 v103, v103, v59
    v_mul_f32 v104, v104, v59
    v_mul_f32 v105, v105, v59
    v_mul_f32 v106, v106, v59
    v_mul_f32 v107, v107, v59
    v_sub_f32 v64, v64, v56
    v_sub_f32 v65, v65, v56
    v_sub_f32 v66, v66, v56
    v_sub_f32 v67, v67, v56
    v_sub_f32 v68, v68, v56
    v_sub_f32 v69, v69, v56
    v_sub_f32 v70, v70, v56
    v_sub_f32 v71, v71, v56
    v_sub_f32 v72, v72, v56
    v_sub_f32 v73, v73, v56
    v_sub_f32 v74, v74, v56
    v_sub_f32 v75, v75, v56
    v_sub_f32 v76, v76, v56
    v_sub_f32 v77, v77, v56
    v_sub_f32 v78, v78, v56
    v_sub_f32 v79, v79, v56
    v_exp_f32 v64, v64
    v_exp_f32 v65, v65
    v_exp_f32 v66, v66
    v_exp_f32 v67, v67
    v_exp_f32 v68, v68
    v_exp_f32 v69, v69
    v_exp_f32 v70, v70
    v_exp_f32 v71, v71
    v_exp_f32 v72, v72
    v_exp_f32 v73, v73
    v_exp_f32 v74, v74
    v_exp_f32 v75, v75
    v_exp_f32 v76, v76
    v_exp_f32 v77, v77
    v_exp_f32 v78, v78
    v_exp_f32 v79, v79
    s_nop 0
    v_cvt_pk_bf16_f32 v48, v64, v65
    v_cvt_pk_bf16_f32 v49, v66, v67
    v_cvt_pk_bf16_f32 v50, v68, v69
    v_cvt_pk_bf16_f32 v51, v70, v71
    v_cvt_pk_bf16_f32 v52, v72, v73
    v_cvt_pk_bf16_f32 v53, v74, v75
    v_cvt_pk_bf16_f32 v54, v76, v77
    v_cvt_pk_bf16_f32 v55, v78, v79
    s_nop 1
    v_mfma_f32_32x32x16_bf16 v[96:111], v[32:35], v[48:51], v[96:111]
    v_mfma_f32_32x32x16_bf16 v[96:111], v[36:39], v[52:55], v[96:111]
    ds_read_b128 v[16:19], v128 offset:1024
    ds_read_b64 v[24:25], v129 offset:256
    s_mov_b64 exec, s[16:17]
    ds_read_b128 v[32:35], v132
    ds_read_b128 v[36:39], v133
    s_mov_b64 exec, -1
    s_waitcnt lgkmcnt(0)
    v_mfma_f32_32x32x16_bf16 v[64:79], v[16:19], v[8:11], 0
    v_mfma_f32_32x32x16_bf16 v[64:79], v[24:27], v[12:15], v[64:79]
    s_nop 15
    s_nop 3
    v_max3_f32 v58, v64, v65, v66
    v_max3_f32 v59, v67, v68, v69
    v_max3_f32 v60, v70, v71, v72
    v_max3_f32 v61, v73, v74, v75
    v_max3_f32 v62, v76, v77, v78
    v_max3_f32 v58, v58, v59, v79
    v_max3_f32 v60, v60, v61, v62
    v_max3_f32 v58, v58, v60, v56
    v_mov_b32 v59, v58
    s_nop 1
    v_permlane32_swap_b32 v58, v59
    v_max_f32 v58, v58, v59
    v_sub_f32 v59, v56, v58
    v_exp_f32 v59, v59
    v_mov_b32 v56, v58
    v_mul_f32 v96, v96, v59
    v_mul_f32 v97, v97, v59
    v_mul_f32 v98, v98, v59
    v_mul_f32 v99, v99, v59
    v_mul_f32 v100, v100, v59
    v_mul_f32 v101, v101, v59
    v_mul_f32 v102, v102, v59
    v_mul_f32 v103, v103, v59
    v_mul_f32 v104, v104, v59
    v_mul_f32 v105, v105, v59
    v_mul_f32 v106, v106, v59
    v_mul_f32 v107, v107, v59
    v_sub_f32 v64, v64, v56
    v_sub_f32 v65, v65, v56
    v_sub_f32 v66, v66, v56
    v_sub_f32 v67, v67, v56
    v_sub_f32 v68, v68, v56
    v_sub_f32 v69, v69, v56
    v_sub_f32 v70, v70, v56
    v_sub_f32 v71, v71, v56
    v_sub_f32 v72, v72, v56
    v_sub_f32 v73, v73, v56
    v_sub_f32 v74, v74, v56
    v_sub_f32 v75, v75, v56
    v_sub_f32 v76, v76, v56
    v_sub_f32 v77, v77, v56
    v_sub_f32 v78, v78, v56
    v_sub_f32 v79, v79, v56
    v_exp_f32 v64, v64
    v_exp_f32 v65, v65
    v_exp_f32 v66, v66
    v_exp_f32 v67, v67
    v_exp_f32 v68, v68
    v_exp_f32 v69, v69
    v_exp_f32 v70, v70
    v_exp_f32 v71, v71
    v_exp_f32 v72, v72
    v_exp_f32 v73, v73
    v_exp_f32 v74, v74
    v_exp_f32 v75, v75
    v_exp_f32 v76, v76
    v_exp_f32 v77, v77
    v_exp_f32 v78, v78
    v_exp_f32 v79, v79
    s_nop 0
    v_cvt_pk_bf16_f32 v48, v64, v65
    v_cvt_pk_bf16_f32 v49, v66, v67
    v_cvt_pk_bf16_f32 v50, v68, v69
    v_cvt_pk_bf16_f32 v51, v70, v71
    v_cvt_pk_bf16_f32 v52, v72, v73
    v_cvt_pk_bf16_f32 v53, v74, v75
    v_cvt_pk_bf16_f32 v54, v76, v77
    v_cvt_pk_bf16_f32 v55, v78, v79
    s_nop 1
    v_mfma_f32_32x32x16_bf16 v[96:111], v[32:35], v[48:51], v[96:111]
    v_mfma_f32_32x32x16_bf16 v[96:111], v[36:39], v[52:55], v[96:111]
    ds_read_b128 v[16:19], v128 offset:2048
    ds_read_b64 v[24:25], v129 offset:512
    s_mov_b64 exec, s[16:17]
    ds_read_b128 v[32:35], v134
    ds_read_b128 v[36:39], v135
    s_mov_b64 exec, -1
    s_waitcnt lgkmcnt(0)
    v_mfma_f32_32x32x16_bf16 v[64:79], v[16:19], v[8:11], 0
    v_mfma_f32_32x32x16_bf16 v[64:79], v[24:27], v[12:15], v[64:79]
    s_nop 15
    s_nop 3
    v_max3_f32 v58, v64, v65, v66
    v_max3_f32 v59, v67, v68, v69
    v_max3_f32 v60, v70, v71, v72
    v_max3_f32 v61, v73, v74, v75
    v_max3_f32 v62, v76, v77, v78
    v_max3_f32 v58, v58, v59, v79
    v_max3_f32 v60, v60, v61, v62
    v_max3_f32 v58, v58, v60, v56
    v_mov_b32 v59, v58
    s_nop 1
    v_permlane32_swap_b32 v58, v59
    v_max_f32 v58, v58, v59
    v_sub_f32 v59, v56, v58
    v_exp_f32 v59, v59
    v_mov_b32 v56, v58
    v_mul_f32 v96, v96, v59
    v_mul_f32 v97, v97, v59
    v_mul_f32 v98, v98, v59
    v_mul_f32 v99, v99, v59
    v_mul_f32 v100, v100, v59
    v_mul_f32 v101, v101, v59
    v_mul_f32 v102, v102, v59
    v_mul_f32 v103, v103, v59
    v_mul_f32 v104, v104, v59
    v_mul_f32 v105, v105, v59
    v_mul_f32 v106, v106, v59
    v_mul_f32 v107, v107, v59
    v_sub_f32 v64, v64, v56
    v_sub_f32 v65, v65, v56
    v_sub_f32 v66, v66, v56
    v_sub_f32 v67, v67, v56
    v_sub_f32 v68, v68, v56
    v_sub_f32 v69, v69, v56
    v_sub_f32 v70, v70, v56
    v_sub_f32 v71, v71, v56
    v_sub_f32 v72, v72, v56
    v_sub_f32 v73, v73, v56
    v_sub_f32 v74, v74, v56
    v_sub_f32 v75, v75, v56
    v_sub_f32 v76, v76, v56
    v_sub_f32 v77, v77, v56
    v_sub_f32 v78, v78, v56
    v_sub_f32 v79, v79, v56
    v_exp_f32 v64, v64
    v_exp_f32 v65, v65
    v_exp_f32 v66, v66
    v_exp_f32 v67, v67
    v_exp_f32 v68, v68
    v_exp_f32 v69, v69
    v_exp_f32 v70, v70
    v_exp_f32 v71, v71
    v_exp_f32 v72, v72
    v_exp_f32 v73, v73
    v_exp_f32 v74, v74
    v_exp_f32 v75, v75
    v_exp_f32 v76, v76
    v_exp_f32 v77, v77
    v_exp_f32 v78, v78
    v_exp_f32 v79, v79
    s_nop 0
    v_cvt_pk_bf16_f32 v48, v64, v65
    v_cvt_pk_bf16_f32 v49, v66, v67
    v_cvt_pk_bf16_f32 v50, v68, v69
    v_cvt_pk_bf16_f32 v51, v70, v71
    v_cvt_pk_bf16_f32 v52, v72, v73
    v_cvt_pk_bf16_f32 v53, v74, v75
    v_cvt_pk_bf16_f32 v54, v76, v77
    v_cvt_pk_bf16_f32 v55, v78, v79
    s_nop 1
    v_mfma_f32_32x32x16_bf16 v[96:111], v[32:35], v[48:51], v[96:111]
    v_mfma_f32_32x32x16_bf16 v[96:111], v[36:39], v[52:55], v[96:111]
    ds_read_b128 v[16:19], v128 offset:3072
    ds_read_b64 v[24:25], v129 offset:768
    s_mov_b64 exec, s[16:17]
    ds_read_b128 v[32:35], v136
    ds_read_b128 v[36:39], v137
    s_mov_b64 exec, -1
    s_waitcnt lgkmcnt(0)
    v_mfma_f32_32x32x16_bf16 v[64:79], v[16:19], v[8:11], 0
    v_mfma_f32_32x32x16_bf16 v[64:79], v[24:27], v[12:15], v[64:79]
    s_nop 15
    s_nop 3
    v_max3_f32 v58, v64, v65, v66
    v_max3_f32 v59, v67, v68, v69
    v_max3_f32 v60, v70, v71, v72
    v_max3_f32 v61, v73, v74, v75
    v_max3_f32 v62, v76, v77, v78
    v_max3_f32 v58, v58, v59, v79
    v_max3_f32 v60, v60, v61, v62
    v_max3_f32 v58, v58, v60, v56
    v_mov_b32 v59, v58
    s_nop 1
    v_permlane32_swap_b32 v58, v59
    v_max_f32 v58, v58, v59
    v_sub_f32 v59, v56, v58
    v_exp_f32 v59, v59
    v_mov_b32 v56, v58
    v_mul_f32 v96, v96, v59
    v_mul_f32 v97, v97, v59
    v_mul_f32 v98, v98, v59
    v_mul_f32 v99, v99, v59
    v_mul_f32 v100, v100, v59
    v_mul_f32 v101, v101, v59
    v_mul_f32 v102, v102, v59
    v_mul_f32 v103, v103, v59
    v_mul_f32 v104, v104, v59
    v_mul_f32 v105, v105, v59
    v_mul_f32 v106, v106, v59
    v_mul_f32 v107, v107, v59
    v_sub_f32 v64, v64, v56
    v_sub_f32 v65, v65, v56
    v_sub_f32 v66, v66, v56
    v_sub_f32 v67, v67, v56
    v_sub_f32 v68, v68, v56
    v_sub_f32 v69, v69, v56
    v_sub_f32 v70, v70, v56
    v_sub_f32 v71, v71, v56
    v_sub_f32 v72, v72, v56
    v_sub_f32 v73, v73, v56
    v_sub_f32 v74, v74, v56
    v_sub_f32 v75, v75, v56
    v_sub_f32 v76, v76, v56
    v_sub_f32 v77, v77, v56
    v_sub_f32 v78, v78, v56
    v_sub_f32 v79, v79, v56
    v_exp_f32 v64, v64
    v_exp_f32 v65, v65
    v_exp_f32 v66, v66
    v_exp_f32 v67, v67
    v_exp_f32 v68, v68
    v_exp_f32 v69, v69
    v_exp_f32 v70, v70
    v_exp_f32 v71, v71
    v_exp_f32 v72, v72
    v_exp_f32 v73, v73
    v_exp_f32 v74, v74
    v_exp_f32 v75, v75
    v_exp_f32 v76, v76
    v_exp_f32 v77, v77
    v_exp_f32 v78, v78
    v_exp_f32 v79, v79
    s_nop 0
    v_cvt_pk_bf16_f32 v48, v64, v65
    v_cvt_pk_bf16_f32 v49, v66, v67
    v_cvt_pk_bf16_f32 v50, v68, v69
    v_cvt_pk_bf16_f32 v51, v70, v71
    v_cvt_pk_bf16_f32 v52, v72, v73
    v_cvt_pk_bf16_f32 v53, v74, v75
    v_cvt_pk_bf16_f32 v54, v76, v77
    v_cvt_pk_bf16_f32 v55, v78, v79
    s_nop 1
    v_mfma_f32_32x32x16_bf16 v[96:111], v[32:35], v[48:51], v[96:111]
    v_mfma_f32_32x32x16_bf16 v[96:111], v[36:39], v[52:55], v[96:111]
    v_add_u32 v128, 10240, v128
    v_add_u32 v129, 10240, v129
    v_add_u32 v130, 10240, v130
    v_add_u32 v131, 10240, v131
    v_add_u32 v132, 10240, v132
    v_add_u32 v133, 10240, v133
    v_add_u32 v134, 10240, v134
    v_add_u32 v135, 10240, v135
    v_add_u32 v136, 10240, v136
    v_add_u32 v137, 10240, v137
    s_add_u32 s11, s11, 1
    s_cmp_lt_u32 s11, 48
    s_cbranch_scc1 attn_fb_loop
    s_branch attn_fin
attn_end:
    s_endpgm
.section .rodata,"a"
.p2align 6
.amdhsa_kernel attn_kernel
  .amdhsa_next_free_vgpr 164
  .amdhsa_next_free_sgpr 102
  .amdhsa_accum_offset 164
  .amdhsa_group_segment_fixed_size 0
  .amdhsa_kernarg_size 120
  .amdhsa_user_sgpr_count 2
  .amdhsa_user_sgpr_kernarg_segment_ptr 1
  .amdhsa_system_sgpr_workgroup_id_x 1
.end_amdhsa_kernel
.text
.section .rodata,"a"
.p2align 6
.amdhsa_kernel attn2_kernel
  .amdhsa_next_free_vgpr 164
  .amdhsa_next_free_sgpr 102
  .amdhsa_accum_offset 164
  .amdhsa_group_segment_fixed_size 0
  .amdhsa_kernarg_size 120
  .amdhsa_user_sgpr_count 2
  .amdhsa_user_sgpr_kernarg_segment_ptr 1
  .amdhsa_system_sgpr_workgroup_id_x 1
.end_amdhsa_kernel
.text
.globl oprojt_kernel
.p2align 8
.type oprojt_kernel,@function
oprojt_kernel:
    s_cmp_ge_u32 s2, 256
    s_cbranch_scc1 opt_end
    s_load_dwordx16 s[16:31], s[0:1], 0
    s_load_dwordx8 s[32:39], s[0:1], 64
    s_load_dwordx2 s[40:41], s[0:1], 112
    s_load_dwordx2 s[42:43], s[0:1], 96
    v_lshrrev_b32 v2, 6, v0
    v_and_b32 v1, 63, v0
    v_and_b32 v5, 15, v0
    v_readfirstlane_b32 s3, v2
    v_bfe_u32 v6, v0, 4, 2
    v_lshlrev_b32 v7, 4, v1
    s_and_b32 s4, s2, 7
    s_lshl_b32 s4, s4, 2
    s_bfe_u32 s5, s2, 0x20003
    s_add_u32 s4, s4, s5
    s_lshr_b32 s5, s2, 5
    s_cmp_lt_u32 s3, 4
    s_cbranch_scc1 opt_ld
    s_sub_u32 s3, s3, 4
    s_setprio 2
    s_lshl_b32 s12, s4, 2
    s_add_u32 s12, s12, s3
    s_lshl_b32 s12, s12, 4
    s_and_b32 s6, s5, 1
    s_lshl_b32 s6, s6, 4
    s_cmp_eq_u32 s6, 0
    s_cselect_b32 s7, 64, 0
    s_lshl_b32 s11, s3, 5
    v_lshlrev_b32 v12, 7, v5
    v_lshl_add_u32 v12, v6, 3, v12
    s_add_u32 s11, s11, 143360
    s_lshl_b32 s8, s6, 7
    s_add_u32 s8, s8, s11
    s_lshl_b32 s9, s7, 7
    s_add_u32 s9, s9, s11
    v_add_u32 v11, s9, v12
    v_add_u32 v12, s8, v12
    v_mul_u32_u24 v13, 144, v5
    v_lshl_add_u32 v13, v6, 3, v13
    s_lshl_b32 s11, s3, 5
    s_add_u32 s11, s11, 40960
    v_add_u32 v13, s11, v13
    v_bfe_u32 v25, v0, 3, 5
    v_and_b32 v26, 7, v0
    v_mul_u32_u24 v27, 144, v25
    v_lshl_add_u32 v27, v26, 4, v27
    v_add_u32 v27, 40960, v27
    v_lshlrev_b32 v28, 12, v25
    v_lshl_add_u32 v28, v26, 4, v28
    v_lshlrev_b32 v15, 12, v5
    v_lshl_add_u32 v15, v6, 3, v15
    s_lshl_b32 s11, s3, 5
    v_add_u32 v15, s11, v15
    s_mul_i32 s10, s5, 327680
    s_lshl_b32 s11, s4, 7
    s_add_u32 s10, s10, s11
    v_and_b32 v24, 1, v5
    v_lshrrev_b32 v25, 1, v5
    v_cmp_eq_u32 s[64:65], 1, v24
    v_cmp_eq_u32 s[68:69], 1, v25
    v_cmp_eq_u32 s[70:71], 2, v25
    v_cmp_eq_u32 s[72:73], 3, v25
    v_cmp_gt_u32 s[66:67], 8, v5
    v_and_b32 v14, 1, v6
    v_lshrrev_b32 v24, 2, v5
    v_lshl_add_u32 v14, v14, 1, v24
    v_lshlrev_b32 v14, 12, v14
    v_lshrrev_b32 v24, 1, v6
    v_lshl_add_u32 v14, v24, 4, v14
    v_and_b32 v24, 1, v5
    v_lshl_add_u32 v14, v24, 3, v14
    v_and_b32 v24, 2, v5
    v_lshl_add_u32 v14, v24, 1, v14
    s_lshl_b32 s12, s12, 1
    s_lshl_b32 s6, s6, 12
    s_lshl_b32 s7, s7, 12
    s_add_u32 s74, s10, s6
    s_add_u32 s75, s74, 131072
    s_add_u32 s76, s10, s7
    s_lshl_b32 s9, s3, 10
    v_add_u32 v9, s9, v7
    v_add_u32 v10, 0x10000, v9
    v_add_u32 v8, 81920, v7
    s_waitcnt lgkmcnt(0)
    s_add_u32 s56, s40, 40894464
    s_addc_u32 s57, s41, 0
    s_mov_b32 s58, 2621440
    s_mov_b32 s59, 0x00020000
    s_add_u32 s60, s40, 11534336
    s_addc_u32 s61, s41, 0
    s_mov_b32 s62, 16384
    s_mov_b32 s63, 0x00020000
    s_barrier
    ds_read_b128 v[64:67], v9 offset:0
    ds_read_b128 v[144:147], v8 offset:0
    ds_read_b128 v[148:151], v8 offset:1024
    ds_read_b128 v[68:71], v9 offset:4096
    ds_read_b128 v[152:155], v8 offset:2048
    ds_read_b128 v[156:159], v8 offset:3072
    s_barrier
    ds_read_b128 v[72:75], v9 offset:8192
    ds_read_b128 v[160:163], v8 offset:4096
    ds_read_b128 v[164:167], v8 offset:5120
    ds_read_b128 v[76:79], v9 offset:12288
    s_waitcnt lgkmcnt(8)
    v_mfma_f32_16x16x32_bf16 v[192:195], v[64:67], v[144:147], 0
    ds_read_b128 v[168:171], v8 offset:6144
    s_waitcnt lgkmcnt(8)
    v_mfma_f32_16x16x32_bf16 v[196:199], v[64:67], v[148:151], 0
    ds_read_b128 v[172:175], v8 offset:7168
    s_barrier
    ds_read_b128 v[80:83], v9 offset:16384
    s_waitcnt lgkmcnt(8)
    v_mfma_f32_16x16x32_bf16 v[192:195], v[68:71], v[152:155], v[192:195]
    ds_read_b128 v[176:179], v8 offset:8192
    s_waitcnt lgkmcnt(8)
    v_mfma_f32_16x16x32_bf16 v[196:199], v[68:71], v[156:159], v[196:199]
    ds_read_b128 v[180:183], v8 offset:9216
    ds_read_b128 v[84:87], v9 offset:20480
    s_waitcnt lgkmcnt(8)
    v_mfma_f32_16x16x32_bf16 v[192:195], v[72:75], v[160:163], v[192:195]
    ds_read_b128 v[184:187], v8 offset:10240
    s_waitcnt lgkmcnt(8)
    v_mfma_f32_16x16x32_bf16 v[196:199], v[72:75], v[164:167], v[196:199]
    ds_read_b128 v[188:191], v8 offset:11264
    ds_read_b128 v[88:91], v9 offset:24576
    s_waitcnt lgkmcnt(8)
    v_mfma_f32_16x16x32_bf16 v[192:195], v[76:79], v[168:171], v[192:195]
    ds_read_b128 v[144:147], v8 offset:12288
    s_waitcnt lgkmcnt(8)
    v_mfma_f32_16x16x32_bf16 v[196:199], v[76:79], v[172:175], v[196:199]
    ds_read_b128 v[148:151], v8 offset:13312
    ds_read_b128 v[92:95], v9 offset:28672
    s_waitcnt lgkmcnt(8)
    v_mfma_f32_16x16x32_bf16 v[192:195], v[80:83], v[176:179], v[192:195]
    ds_read_b128 v[152:155], v8 offset:14336
    s_waitcnt lgkmcnt(8)
    v_mfma_f32_16x16x32_bf16 v[196:199], v[80:83], v[180:183], v[196:199]
    ds_read_b128 v[156:159], v8 offset:15360
    s_barrier
    ds_read_b128 v[96:99], v9 offset:32768
    s_waitcnt lgkmcnt(8)
    v_mfma_f32_16x16x32_bf16 v[192:195], v[84:87], v[184:187], v[192:195]
    ds_read_b128 v[160:163], v8 offset:16384
    s_waitcnt lgkmcnt(8)
    v_mfma_f32_16x16x32_bf16 v[196:199], v[84:87], v[188:191], v[196:199]
    ds_read_b128 v[164:167], v8 offset:17408
    ds_read_b128 v[100:103], v9 offset:36864
    s_waitcnt lgkmcnt(8)
    v_mfma_f32_16x16x32_bf16 v[192:195], v[88:91], v[144:147], v[192:195]
    ds_read_b128 v[168:171], v8 offset:18432
    s_waitcnt lgkmcnt(8)
    v_mfma_f32_16x16x32_bf16 v[196:199], v[88:91], v[148:151], v[196:199]
    ds_read_b128 v[172:175], v8 offset:19456
    s_barrier
    ds_read_b64 v[32:33], v12 offset:0
    ds_read_b64 v[34:35], v12 offset:2048
    ds_read_b64 v[36:37], v12 offset:4096
    ds_read_b64 v[38:39], v12 offset:6144
    ds_read_b64 v[40:41], v11 offset:0
    ds_read_b128 v[104:107], v9 offset:40960
    s_waitcnt lgkmcnt(13)
    v_mfma_f32_16x16x32_bf16 v[192:195], v[92:95], v[152:155], v[192:195]
    ds_read_b128 v[176:179], v8 offset:20480
    s_waitcnt lgkmcnt(13)
    v_mfma_f32_16x16x32_bf16 v[196:199], v[92:95], v[156:159], v[196:199]
    ds_read_b128 v[180:183], v8 offset:21504
    ds_read_b128 v[108:111], v9 offset:45056
    s_waitcnt lgkmcnt(13)
    v_mfma_f32_16x16x32_bf16 v[192:195], v[96:99], v[160:163], v[192:195]
    ds_read_b128 v[184:187], v8 offset:22528
    s_waitcnt lgkmcnt(13)
    v_mfma_f32_16x16x32_bf16 v[196:199], v[96:99], v[164:167], v[196:199]
    ds_read_b128 v[188:191], v8 offset:23552
    ds_read_b128 v[112:115], v9 offset:49152
    s_waitcnt lgkmcnt(13)
    v_mfma_f32_16x16x32_bf16 v[192:195], v[100:103], v[168:171], v[192:195]
    ds_read_b128 v[144:147], v8 offset:24576
    s_waitcnt lgkmcnt(13)
    v_mfma_f32_16x16x32_bf16 v[196:199], v[100:103], v[172:175], v[196:199]
    ds_read_b128 v[148:151], v8 offset:25600
    ds_read_b128 v[116:119], v9 offset:53248
    s_waitcnt lgkmcnt(8)
    v_mfma_f32_16x16x32_bf16 v[192:195], v[104:107], v[176:179], v[192:195]
    ds_read_b128 v[152:155], v8 offset:26624
    s_waitcnt lgkmcnt(8)
    v_mfma_f32_16x16x32_bf16 v[196:199], v[104:107], v[180:183], v[196:199]
    ds_read_b128 v[156:159], v8 offset:27648
    s_barrier
    ds_read_b128 v[120:123], v9 offset:57344
    s_waitcnt lgkmcnt(8)
    v_lshlrev_b32 v44, 16, v32
    v_and_b32 v45, 0xffff0000, v32
    v_lshlrev_b32 v46, 16, v33
    v_and_b32 v47, 0xffff0000, v33
    v_add_f32 v192, v192, v44
    v_add_f32 v193, v193, v45
    v_add_f32 v194, v194, v46
    v_add_f32 v195, v195, v47
    s_nop 1
    v_mfma_f32_16x16x32_bf16 v[192:195], v[108:111], v[184:187], v[192:195]
    ds_read_b128 v[160:163], v8 offset:28672
    s_waitcnt lgkmcnt(8)
    v_lshlrev_b32 v44, 16, v34
    v_and_b32 v45, 0xffff0000, v34
    v_lshlrev_b32 v46, 16, v35
    v_and_b32 v47, 0xffff0000, v35
    v_add_f32 v196, v196, v44
    v_add_f32 v197, v197, v45
    v_add_f32 v198, v198, v46
    v_add_f32 v199, v199, v47
    v_lshlrev_b32 v200, 16, v36
    v_and_b32 v201, 0xffff0000, v36
    v_lshlrev_b32 v202, 16, v37
    v_and_b32 v203, 0xffff0000, v37
    v_lshlrev_b32 v208, 16, v38
    v_and_b32 v209, 0xffff0000, v38
    v_lshlrev_b32 v210, 16, v39
    v_and_b32 v211, 0xffff0000, v39
    v_lshlrev_b32 v216, 16, v40
    v_and_b32 v217, 0xffff0000, v40
    v_lshlrev_b32 v218, 16, v41
    v_and_b32 v219, 0xffff0000, v41
    v_mfma_f32_16x16x32_bf16 v[196:199], v[108:111], v[188:191], v[196:199]
    ds_read_b128 v[164:167], v8 offset:29696
    ds_read_b128 v[124:127], v9 offset:61440
    s_waitcnt lgkmcnt(8)
    v_mfma_f32_16x16x32_bf16 v[192:195], v[112:115], v[144:147], v[192:195]
    ds_read_b128 v[168:171], v8 offset:30720
    s_waitcnt lgkmcnt(8)
    v_mfma_f32_16x16x32_bf16 v[196:199], v[112:115], v[148:151], v[196:199]
    ds_read_b128 v[172:175], v8 offset:31744
    ds_read_b128 v[128:131], v10 offset:0
    s_waitcnt lgkmcnt(8)
    v_mfma_f32_16x16x32_bf16 v[192:195], v[116:119], v[152:155], v[192:195]
    ds_read_b128 v[176:179], v8 offset:32768
    s_waitcnt lgkmcnt(8)
    v_mfma_f32_16x16x32_bf16 v[196:199], v[116:119], v[156:159], v[196:199]
    ds_read_b128 v[180:183], v8 offset:33792
    ds_read_b128 v[132:135], v10 offset:4096
    s_waitcnt lgkmcnt(8)
    v_mfma_f32_16x16x32_bf16 v[192:195], v[120:123], v[160:163], v[192:195]
    ds_read_b128 v[184:187], v8 offset:34816
    s_waitcnt lgkmcnt(8)
    v_mfma_f32_16x16x32_bf16 v[196:199], v[120:123], v[164:167], v[196:199]
    ds_read_b128 v[188:191], v8 offset:35840
    s_barrier
    ds_read_b128 v[136:139], v10 offset:8192
    s_waitcnt lgkmcnt(8)
    v_mfma_f32_16x16x32_bf16 v[192:195], v[124:127], v[168:171], v[192:195]
    ds_read_b128 v[144:147], v8 offset:36864
    s_waitcnt lgkmcnt(8)
    v_mfma_f32_16x16x32_bf16 v[196:199], v[124:127], v[172:175], v[196:199]
    ds_read_b128 v[148:151], v8 offset:37888
    ds_read_b128 v[140:143], v10 offset:12288
    s_waitcnt lgkmcnt(8)
    v_mfma_f32_16x16x32_bf16 v[192:195], v[128:131], v[176:179], v[192:195]
    ds_read_b128 v[152:155], v8 offset:38912
    s_waitcnt lgkmcnt(8)
    v_mfma_f32_16x16x32_bf16 v[196:199], v[128:131], v[180:183], v[196:199]
    ds_read_b128 v[156:159], v8 offset:39936
    s_barrier
    ds_read_b128 v[160:163], v8 offset:40960
    s_waitcnt lgkmcnt(8)
    v_mfma_f32_16x16x32_bf16 v[192:195], v[132:135], v[184:187], v[192:195]
    ds_read_b128 v[164:167], v8 offset:41984
    s_waitcnt lgkmcnt(8)
    v_mfma_f32_16x16x32_bf16 v[196:199], v[132:135], v[188:191], v[196:199]
    ds_read_b128 v[168:171], v8 offset:43008
    ds_read_b128 v[172:175], v8 offset:44032
    s_waitcnt lgkmcnt(8)
    v_mfma_f32_16x16x32_bf16 v[192:195], v[136:139], v[144:147], v[192:195]
    ds_read_b128 v[176:179], v8 offset:45056
    s_waitcnt lgkmcnt(8)
    v_mfma_f32_16x16x32_bf16 v[196:199], v[136:139], v[148:151], v[196:199]
    ds_read_b128 v[180:183], v8 offset:46080
    ds_read_b128 v[184:187], v8 offset:47104
    s_waitcnt lgkmcnt(8)
    v_mfma_f32_16x16x32_bf16 v[192:195], v[140:143], v[152:155], v[192:195]
    ds_read_b128 v[188:191], v8 offset:48128
    s_waitcnt lgkmcnt(8)
    v_mfma_f32_16x16x32_bf16 v[196:199], v[140:143], v[156:159], v[196:199]
    ds_read_b128 v[144:147], v8 offset:49152
    s_waitcnt lgkmcnt(8)
    v_mfma_f32_16x16x32_bf16 v[200:203], v[64:67], v[160:163], v[200:203]
    ds_read_b128 v[148:151], v8 offset:50176
    s_waitcnt lgkmcnt(8)
    v_mfma_f32_16x16x32_bf16 v[204:207], v[68:71], v[164:167], 0
    ds_read_b128 v[152:155], v8 offset:51200
    s_waitcnt lgkmcnt(8)
    v_mfma_f32_16x16x32_bf16 v[200:203], v[72:75], v[168:171], v[200:203]
    ds_read_b128 v[156:159], v8 offset:52224
    s_waitcnt lgkmcnt(8)
    v_mfma_f32_16x16x32_bf16 v[204:207], v[76:79], v[172:175], v[204:207]
    v_cvt_pk_bf16_f32 v32, v192, v193
    v_cvt_pk_bf16_f32 v33, v194, v195
    ds_write_b64 v13, v[32:33] offset:0
    v_lshlrev_b32 v16, 16, v32
    v_and_b32 v17, 0xffff0000, v32
    v_lshlrev_b32 v18, 16, v33
    v_and_b32 v19, 0xffff0000, v33
    v_mul_f32 v20, v16, v16
    v_mul_f32 v21, v17, v17
    v_mul_f32 v22, v18, v18
    v_mul_f32 v23, v19, v19
    v_cvt_pk_bf16_f32 v34, v196, v197
    v_cvt_pk_bf16_f32 v35, v198, v199
    ds_write_b64 v13, v[34:35] offset:2304
    v_lshlrev_b32 v44, 16, v34
    v_and_b32 v45, 0xffff0000, v34
    v_lshlrev_b32 v46, 16, v35
    v_and_b32 v47, 0xffff0000, v35
    v_add_f32 v16, v16, v44
    v_fma_f32 v20, v44, v44, v20
    v_add_f32 v17, v17, v45
    v_fma_f32 v21, v45, v45, v21
    v_add_f32 v18, v18, v46
    v_fma_f32 v22, v46, v46, v22
    v_add_f32 v19, v19, v47
    v_fma_f32 v23, v47, v47, v23
    ds_read_b128 v[160:163], v8 offset:53248
    s_waitcnt lgkmcnt(10)
    v_mfma_f32_16x16x32_bf16 v[200:203], v[80:83], v[176:179], v[200:203]
    ds_read_b128 v[164:167], v8 offset:54272
    s_waitcnt lgkmcnt(10)
    v_mfma_f32_16x16x32_bf16 v[204:207], v[84:87], v[180:183], v[204:207]
    ds_read_b128 v[168:171], v8 offset:55296
    s_waitcnt lgkmcnt(10)
    v_mfma_f32_16x16x32_bf16 v[200:203], v[88:91], v[184:187], v[200:203]
    ds_read_b128 v[172:175], v8 offset:56320
    s_waitcnt lgkmcnt(10)
    v_mfma_f32_16x16x32_bf16 v[204:207], v[92:95], v[188:191], v[204:207]
    ds_read_b128 v[176:179], v8 offset:57344
    s_waitcnt lgkmcnt(10)
    v_mfma_f32_16x16x32_bf16 v[200:203], v[96:99], v[144:147], v[200:203]
    ds_read_b128 v[180:183], v8 offset:58368
    s_waitcnt lgkmcnt(10)
    v_mfma_f32_16x16x32_bf16 v[204:207], v[100:103], v[148:151], v[204:207]
    ds_read_b128 v[184:187], v8 offset:59392
    s_waitcnt lgkmcnt(10)
    v_mfma_f32_16x16x32_bf16 v[200:203], v[104:107], v[152:155], v[200:203]
    ds_read_b128 v[188:191], v8 offset:60416
    s_waitcnt lgkmcnt(10)
    v_mfma_f32_16x16x32_bf16 v[204:207], v[108:111], v[156:159], v[204:207]
    s_waitcnt lgkmcnt(8)
    s_barrier
    ds_read_b128 v[48:51], v27 offset:0
    ds_read_b128 v[144:147], v7 offset:0
    s_waitcnt lgkmcnt(9)
    v_mfma_f32_16x16x32_bf16 v[200:203], v[112:115], v[160:163], v[200:203]
    ds_read_b128 v[148:151], v7 offset:1024
    s_waitcnt lgkmcnt(9)
    v_mfma_f32_16x16x32_bf16 v[204:207], v[116:119], v[164:167], v[204:207]
    ds_read_b128 v[152:155], v7 offset:2048
    s_waitcnt lgkmcnt(9)
    v_mfma_f32_16x16x32_bf16 v[200:203], v[120:123], v[168:171], v[200:203]
    ds_read_b128 v[156:159], v7 offset:3072
    s_waitcnt lgkmcnt(9)
    v_mfma_f32_16x16x32_bf16 v[204:207], v[124:127], v[172:175], v[204:207]
    ds_read_b128 v[160:163], v7 offset:4096
    s_waitcnt lgkmcnt(9)
    v_mfma_f32_16x16x32_bf16 v[200:203], v[128:131], v[176:179], v[200:203]
    s_waitcnt lgkmcnt(5)
    buffer_store_dwordx4 v[48:51], v28, s[56:59], s74 offen sc0 sc1
    ds_read_b128 v[164:167], v7 offset:5120
    v_mfma_f32_16x16x32_bf16 v[204:207], v[132:135], v[180:183], v[204:207]
    ds_read_b128 v[168:171], v7 offset:6144
    v_mfma_f32_16x16x32_bf16 v[200:203], v[136:139], v[184:187], v[200:203]
    ds_read_b128 v[172:175], v7 offset:7168
    v_mfma_f32_16x16x32_bf16 v[204:207], v[140:143], v[188:191], v[204:207]
    ds_read_b128 v[176:179], v7 offset:8192
    s_waitcnt lgkmcnt(8)
    v_mfma_f32_16x16x32_bf16 v[208:211], v[64:67], v[144:147], v[208:211]
    ds_read_b128 v[180:183], v7 offset:9216
    s_waitcnt lgkmcnt(8)
    v_mfma_f32_16x16x32_bf16 v[212:215], v[68:71], v[148:151], 0
    ds_read_b128 v[184:187], v7 offset:10240
    s_waitcnt lgkmcnt(8)
    v_mfma_f32_16x16x32_bf16 v[208:211], v[72:75], v[152:155], v[208:211]
    ds_read_b128 v[188:191], v7 offset:11264
    s_waitcnt lgkmcnt(8)
    v_mfma_f32_16x16x32_bf16 v[212:215], v[76:79], v[156:159], v[212:215]
    v_add_f32 v200, v200, v204
    v_add_f32 v201, v201, v205
    v_add_f32 v202, v202, v206
    v_add_f32 v203, v203, v207
    v_cvt_pk_bf16_f32 v36, v200, v201
    v_cvt_pk_bf16_f32 v37, v202, v203
    ds_write_b64 v13, v[36:37] offset:4608
    v_lshlrev_b32 v44, 16, v36
    v_and_b32 v45, 0xffff0000, v36
    v_lshlrev_b32 v46, 16, v37
    v_and_b32 v47, 0xffff0000, v37
    v_add_f32 v16, v16, v44
    v_fma_f32 v20, v44, v44, v20
    v_add_f32 v17, v17, v45
    v_fma_f32 v21, v45, v45, v21
    v_add_f32 v18, v18, v46
    v_fma_f32 v22, v46, v46, v22
    v_add_f32 v19, v19, v47
    v_fma_f32 v23, v47, v47, v23
    ds_read_b128 v[144:147], v7 offset:12288
    s_waitcnt lgkmcnt(9)
    v_mfma_f32_16x16x32_bf16 v[208:211], v[80:83], v[160:163], v[208:211]
    ds_read_b128 v[148:151], v7 offset:13312
    s_waitcnt lgkmcnt(9)
    v_mfma_f32_16x16x32_bf16 v[212:215], v[84:87], v[164:167], v[212:215]
    ds_read_b128 v[152:155], v7 offset:14336
    s_waitcnt lgkmcnt(9)
    v_mfma_f32_16x16x32_bf16 v[208:211], v[88:91], v[168:171], v[208:211]
    ds_read_b128 v[156:159], v7 offset:15360
    s_waitcnt lgkmcnt(9)
    v_mfma_f32_16x16x32_bf16 v[212:215], v[92:95], v[172:175], v[212:215]
    ds_read_b128 v[160:163], v7 offset:16384
    s_waitcnt lgkmcnt(9)
    v_mfma_f32_16x16x32_bf16 v[208:211], v[96:99], v[176:179], v[208:211]
    ds_read_b128 v[164:167], v7 offset:17408
    s_waitcnt lgkmcnt(9)
    v_mfma_f32_16x16x32_bf16 v[212:215], v[100:103], v[180:183], v[212:215]
    ds_read_b128 v[168:171], v7 offset:18432
    s_waitcnt lgkmcnt(9)
    v_mfma_f32_16x16x32_bf16 v[208:211], v[104:107], v[184:187], v[208:211]
    ds_read_b128 v[172:175], v7 offset:19456
    s_waitcnt lgkmcnt(9)
    v_mfma_f32_16x16x32_bf16 v[212:215], v[108:111], v[188:191], v[212:215]
    s_barrier
    ds_read_b128 v[176:179], v7 offset:20480
    s_waitcnt lgkmcnt(8)
    v_mfma_f32_16x16x32_bf16 v[208:211], v[112:115], v[144:147], v[208:211]
    ds_read_b128 v[180:183], v7 offset:21504
    s_waitcnt lgkmcnt(8)
    v_mfma_f32_16x16x32_bf16 v[212:215], v[116:119], v[148:151], v[212:215]
    ds_read_b128 v[184:187], v7 offset:22528
    s_waitcnt lgkmcnt(8)
    v_mfma_f32_16x16x32_bf16 v[208:211], v[120:123], v[152:155], v[208:211]
    ds_read_b128 v[188:191], v7 offset:23552
    s_waitcnt lgkmcnt(8)
    v_mfma_f32_16x16x32_bf16 v[212:215], v[124:127], v[156:159], v[212:215]
    ds_read_b128 v[144:147], v7 offset:24576
    s_waitcnt lgkmcnt(8)
    v_mfma_f32_16x16x32_bf16 v[208:211], v[128:131], v[160:163], v[208:211]
    ds_read_b128 v[148:151], v7 offset:25600
    s_waitcnt lgkmcnt(8)
    v_mfma_f32_16x16x32_bf16 v[212:215], v[132:135], v[164:167], v[212:215]
    ds_read_b128 v[152:155], v7 offset:26624
    s_waitcnt lgkmcnt(8)
    v_mfma_f32_16x16x32_bf16 v[208:211], v[136:139], v[168:171], v[208:211]
    ds_read_b128 v[156:159], v7 offset:27648
    s_waitcnt lgkmcnt(8)
    v_mfma_f32_16x16x32_bf16 v[212:215], v[140:143], v[172:175], v[212:215]
    ds_read_b128 v[160:163], v7 offset:28672
    s_waitcnt lgkmcnt(8)
    v_mfma_f32_16x16x32_bf16 v[216:219], v[64:67], v[176:179], v[216:219]
    ds_read_b128 v[164:167], v7 offset:29696
    s_waitcnt lgkmcnt(8)
    v_mfma_f32_16x16x32_bf16 v[220:223], v[68:71], v[180:183], 0
    ds_read_b128 v[168:171], v7 offset:30720
    s_waitcnt lgkmcnt(8)
    v_mfma_f32_16x16x32_bf16 v[216:219], v[72:75], v[184:187], v[216:219]
    ds_read_b128 v[172:175], v7 offset:31744
    s_waitcnt lgkmcnt(8)
    v_mfma_f32_16x16x32_bf16 v[220:223], v[76:79], v[188:191], v[220:223]
    v_add_f32 v208, v208, v212
    v_add_f32 v209, v209, v213
    v_add_f32 v210, v210, v214
    v_add_f32 v211, v211, v215
    v_cvt_pk_bf16_f32 v38, v208, v209
    v_cvt_pk_bf16_f32 v39, v210, v211
    ds_write_b64 v13, v[38:39] offset:6912
    v_lshlrev_b32 v44, 16, v38
    v_and_b32 v45, 0xffff0000, v38
    v_lshlrev_b32 v46, 16, v39
    v_and_b32 v47, 0xffff0000, v39
    v_add_f32 v16, v16, v44
    v_fma_f32 v20, v44, v44, v20
    v_add_f32 v17, v17, v45
    v_fma_f32 v21, v45, v45, v21
    v_add_f32 v18, v18, v46
    v_fma_f32 v22, v46, v46, v22
    v_add_f32 v19, v19, v47
    v_fma_f32 v23, v47, v47, v23
    s_waitcnt lgkmcnt(0)
    s_barrier
    ds_read_b128 v[48:51], v27 offset:4608
    ds_read_b128 v[176:179], v7 offset:32768
    v_mfma_f32_16x16x32_bf16 v[216:219], v[80:83], v[144:147], v[216:219]
    ds_read_b128 v[180:183], v7 offset:33792
    v_mfma_f32_16x16x32_bf16 v[220:223], v[84:87], v[148:151], v[220:223]
    ds_read_b128 v[184:187], v7 offset:34816
    v_mfma_f32_16x16x32_bf16 v[216:219], v[88:91], v[152:155], v[216:219]
    ds_read_b128 v[188:191], v7 offset:35840
    v_mfma_f32_16x16x32_bf16 v[220:223], v[92:95], v[156:159], v[220:223]
    ds_read_b128 v[144:147], v7 offset:36864
    v_mfma_f32_16x16x32_bf16 v[216:219], v[96:99], v[160:163], v[216:219]
    s_waitcnt lgkmcnt(5)
    buffer_store_dwordx4 v[48:51], v28, s[56:59], s75 offen sc0 sc1
    ds_read_b128 v[148:151], v7 offset:37888
    v_mfma_f32_16x16x32_bf16 v[220:223], v[100:103], v[164:167], v[220:223]
    ds_read_b128 v[152:155], v7 offset:38912
    v_mfma_f32_16x16x32_bf16 v[216:219], v[104:107], v[168:171], v[216:219]
    ds_read_b128 v[156:159], v7 offset:39936
    v_mfma_f32_16x16x32_bf16 v[220:223], v[108:111], v[172:175], v[220:223]
    s_waitcnt lgkmcnt(7)
    v_mfma_f32_16x16x32_bf16 v[216:219], v[112:115], v[176:179], v[216:219]
    s_waitcnt lgkmcnt(6)
    v_mfma_f32_16x16x32_bf16 v[220:223], v[116:119], v[180:183], v[220:223]
    s_waitcnt lgkmcnt(5)
    v_mfma_f32_16x16x32_bf16 v[216:219], v[120:123], v[184:187], v[216:219]
    s_waitcnt lgkmcnt(4)
    v_mfma_f32_16x16x32_bf16 v[220:223], v[124:127], v[188:191], v[220:223]
    s_waitcnt lgkmcnt(3)
    v_mfma_f32_16x16x32_bf16 v[216:219], v[128:131], v[144:147], v[216:219]
    s_waitcnt lgkmcnt(2)
    v_mfma_f32_16x16x32_bf16 v[220:223], v[132:135], v[148:151], v[220:223]
    s_waitcnt lgkmcnt(1)
    v_mfma_f32_16x16x32_bf16 v[216:219], v[136:139], v[152:155], v[216:219]
    s_waitcnt lgkmcnt(0)
    v_mfma_f32_16x16x32_bf16 v[220:223], v[140:143], v[156:159], v[220:223]
    s_nop 7
    v_add_f32 v216, v216, v220
    v_add_f32 v217, v217, v221
    v_add_f32 v218, v218, v222
    v_add_f32 v219, v219, v223
    v_cvt_pk_bf16_f32 v40, v216, v217
    v_cvt_pk_bf16_f32 v41, v218, v219
    buffer_store_dwordx2 v[40:41], v15, s[56:59], s76 offen
    v_lshlrev_b32 v44, 16, v40
    v_and_b32 v45, 0xffff0000, v40
    v_lshlrev_b32 v46, 16, v41
    v_and_b32 v47, 0xffff0000, v41
    v_add_f32 v16, v16, v44
    v_fma_f32 v20, v44, v44, v20
    v_add_f32 v17, v17, v45
    v_fma_f32 v21, v45, v45, v21
    v_add_f32 v18, v18, v46
    v_fma_f32 v22, v46, v46, v22
    v_add_f32 v19, v19, v47
    v_fma_f32 v23, v47, v47, v23
    v_add_f32_dpp v16, v16, v16 row_ror:1 row_mask:0xf bank_mask:0xf
    v_add_f32_dpp v17, v17, v17 row_ror:1 row_mask:0xf bank_mask:0xf
    v_add_f32_dpp v18, v18, v18 row_ror:1 row_mask:0xf bank_mask:0xf
    v_add_f32_dpp v19, v19, v19 row_ror:1 row_mask:0xf bank_mask:0xf
    v_add_f32_dpp v20, v20, v20 row_ror:1 row_mask:0xf bank_mask:0xf
    v_add_f32_dpp v21, v21, v21 row_ror:1 row_mask:0xf bank_mask:0xf
    v_add_f32_dpp v22, v22, v22 row_ror:1 row_mask:0xf bank_mask:0xf
    v_add_f32_dpp v23, v23, v23 row_ror:1 row_mask:0xf bank_mask:0xf
    v_add_f32_dpp v16, v16, v16 row_ror:2 row_mask:0xf bank_mask:0xf
    v_add_f32_dpp v17, v17, v17 row_ror:2 row_mask:0xf bank_mask:0xf
    v_add_f32_dpp v18, v18, v18 row_ror:2 row_mask:0xf bank_mask:0xf
    v_add_f32_dpp v19, v19, v19 row_ror:2 row_mask:0xf bank_mask:0xf
    v_add_f32_dpp v20, v20, v20 row_ror:2 row_mask:0xf bank_mask:0xf
    v_add_f32_dpp v21, v21, v21 row_ror:2 row_mask:0xf bank_mask:0xf
    v_add_f32_dpp v22, v22, v22 row_ror:2 row_mask:0xf bank_mask:0xf
    v_add_f32_dpp v23, v23, v23 row_ror:2 row_mask:0xf bank_mask:0xf
    v_add_f32_dpp v16, v16, v16 row_ror:4 row_mask:0xf bank_mask:0xf
    v_add_f32_dpp v17, v17, v17 row_ror:4 row_mask:0xf bank_mask:0xf
    v_add_f32_dpp v18, v18, v18 row_ror:4 row_mask:0xf bank_mask:0xf
    v_add_f32_dpp v19, v19, v19 row_ror:4 row_mask:0xf bank_mask:0xf
    v_add_f32_dpp v20, v20, v20 row_ror:4 row_mask:0xf bank_mask:0xf
    v_add_f32_dpp v21, v21, v21 row_ror:4 row_mask:0xf bank_mask:0xf
    v_add_f32_dpp v22, v22, v22 row_ror:4 row_mask:0xf bank_mask:0xf
    v_add_f32_dpp v23, v23, v23 row_ror:4 row_mask:0xf bank_mask:0xf
    v_add_f32_dpp v16, v16, v16 row_ror:8 row_mask:0xf bank_mask:0xf
    v_add_f32_dpp v17, v17, v17 row_ror:8 row_mask:0xf bank_mask:0xf
    v_add_f32_dpp v18, v18, v18 row_ror:8 row_mask:0xf bank_mask:0xf
    v_add_f32_dpp v19, v19, v19 row_ror:8 row_mask:0xf bank_mask:0xf
    v_add_f32_dpp v20, v20, v20 row_ror:8 row_mask:0xf bank_mask:0xf
    v_add_f32_dpp v21, v21, v21 row_ror:8 row_mask:0xf bank_mask:0xf
    v_add_f32_dpp v22, v22, v22 row_ror:8 row_mask:0xf bank_mask:0xf
    v_add_f32_dpp v23, v23, v23 row_ror:8 row_mask:0xf bank_mask:0xf
    v_cndmask_b32 v16, v16, v20, s[64:65]
    v_cndmask_b32 v17, v17, v21, s[64:65]
    v_cndmask_b32 v18, v18, v22, s[64:65]
    v_cndmask_b32 v19, v19, v23, s[64:65]
    v_cndmask_b32 v16, v16, v17, s[68:69]
    v_cndmask_b32 v16, v16, v18, s[70:71]
    v_cndmask_b32 v16, v16, v19, s[72:73]
    s_mov_b64 exec, s[66:67]
    buffer_atomic_add_f32 v16, v14, s[60:63], s12 offen
    s_endpgm
opt_ld:
    s_lshl_b32 s9, s3, 10
    s_mul_i32 s8, s5, 102400
    s_add_u32 s8, s8, s9
    s_lshl_b32 s12, s4, 2
    s_add_u32 s12, s12, s3
    s_mul_i32 s13, s12, 20480
    s_mul_i32 s10, s4, 81920
    s_mul_i32 s11, s5, 10240
    s_add_u32 s10, s10, s11
    v_add_u32 v8, s10, v7
    v_add_u32 v8, s9, v8
    s_waitcnt lgkmcnt(0)
    s_add_u32 s44, s40, 16777216
    s_addc_u32 s45, s41, 0
    s_mov_b32 s46, 2621440
    s_mov_b32 s47, 0x00020000
    s_add_u32 s48, s40, 1048576
    s_addc_u32 s49, s41, 0
    s_mov_b32 s50, 819200
    s_mov_b32 s51, 0x00020000
    s_add_u32 s26, s9, 0
    s_add_u32 s27, s13, 0
    s_mov_b32 m0, s26
    s_nop 0
    buffer_load_dwordx4 v7, s[44:47], s27 offen lds
    s_add_u32 s26, s9, 4096
    s_add_u32 s27, s13, 1024
    s_mov_b32 m0, s26
    s_nop 0
    buffer_load_dwordx4 v7, s[44:47], s27 offen lds
    s_add_u32 s26, s9, 81920
    s_add_u32 s27, s8, 0
    s_mov_b32 m0, s26
    s_nop 0
    buffer_load_dwordx4 v7, s[48:51], s27 offen lds
    s_add_u32 s26, s9, 8192
    s_add_u32 s27, s13, 2048
    s_mov_b32 m0, s26
    s_nop 0
    buffer_load_dwordx4 v7, s[44:47], s27 offen lds
    s_add_u32 s26, s9, 12288
    s_add_u32 s27, s13, 3072
    s_mov_b32 m0, s26
    s_nop 0
    buffer_load_dwordx4 v7, s[44:47], s27 offen lds
    s_add_u32 s26, s9, 86016
    s_add_u32 s27, s8, 4096
    s_mov_b32 m0, s26
    s_nop 0
    buffer_load_dwordx4 v7, s[48:51], s27 offen lds
    s_add_u32 s26, s9, 16384
    s_add_u32 s27, s13, 4096
    s_mov_b32 m0, s26
    s_nop 0
    buffer_load_dwordx4 v7, s[44:47], s27 offen lds
    s_add_u32 s26, s9, 20480
    s_add_u32 s27, s13, 5120
    s_mov_b32 m0, s26
    s_nop 0
    buffer_load_dwordx4 v7, s[44:47], s27 offen lds
    s_add_u32 s26, s9, 90112
    s_add_u32 s27, s8, 8192
    s_mov_b32 m0, s26
    s_nop 0
    buffer_load_dwordx4 v7, s[48:51], s27 offen lds
    s_add_u32 s26, s9, 24576
    s_add_u32 s27, s13, 6144
    s_mov_b32 m0, s26
    s_nop 0
    buffer_load_dwordx4 v7, s[44:47], s27 offen lds
    s_add_u32 s26, s9, 28672
    s_add_u32 s27, s13, 7168
    s_mov_b32 m0, s26
    s_nop 0
    buffer_load_dwordx4 v7, s[44:47], s27 offen lds
    s_waitcnt vmcnt(8)
    s_barrier
    s_add_u32 s26, s9, 94208
    s_add_u32 s27, s8, 12288
    s_mov_b32 m0, s26
    s_nop 0
    buffer_load_dwordx4 v7, s[48:51], s27 offen lds
    s_add_u32 s52, s40, 8388608
    s_addc_u32 s53, s41, 0
    s_mov_b32 s54, 2621440
    s_mov_b32 s55, 0x00020000
    s_add_u32 s26, s9, 143360
    s_mov_b32 m0, s26
    s_nop 0
    buffer_load_dwordx4 v8, s[52:55], 0 offen lds
    v_add_u32 v8, 4096, v8
    s_add_u32 s26, s9, 147456
    s_mov_b32 m0, s26
    s_nop 0
    buffer_load_dwordx4 v8, s[52:55], 0 offen lds
    v_add_u32 v8, 4096, v8
    s_add_u32 s26, s9, 151552
    s_mov_b32 m0, s26
    s_nop 0
    buffer_load_dwordx4 v8, s[52:55], 0 offen lds
    s_add_u32 s26, s9, 32768
    s_add_u32 s27, s13, 8192
    s_mov_b32 m0, s26
    s_nop 0
    buffer_load_dwordx4 v7, s[44:47], s27 offen lds
    s_add_u32 s26, s9, 36864
    s_add_u32 s27, s13, 9216
    s_mov_b32 m0, s26
    s_nop 0
    buffer_load_dwordx4 v7, s[44:47], s27 offen lds
    s_add_u32 s26, s9, 98304
    s_add_u32 s27, s8, 16384
    s_mov_b32 m0, s26
    s_nop 0
    buffer_load_dwordx4 v7, s[48:51], s27 offen lds
    s_add_u32 s26, s9, 40960
    s_add_u32 s27, s13, 10240
    s_mov_b32 m0, s26
    s_nop 0
    buffer_load_dwordx4 v7, s[44:47], s27 offen lds
    s_add_u32 s26, s9, 45056
    s_add_u32 s27, s13, 11264
    s_mov_b32 m0, s26
    s_nop 0
    buffer_load_dwordx4 v7, s[44:47], s27 offen lds
    s_add_u32 s26, s9, 102400
    s_add_u32 s27, s8, 20480
    s_mov_b32 m0, s26
    s_nop 0
    buffer_load_dwordx4 v7, s[48:51], s27 offen lds
    s_add_u32 s26, s9, 49152
    s_add_u32 s27, s13, 12288
    s_mov_b32 m0, s26
    s_nop 0
    buffer_load_dwordx4 v7, s[44:47], s27 offen lds
    s_waitcnt vmcnt(16)
    s_barrier
    s_add_u32 s26, s9, 53248
    s_add_u32 s27, s13, 13312
    s_mov_b32 m0, s26
    s_nop 0
    buffer_load_dwordx4 v7, s[44:47], s27 offen lds
    s_add_u32 s26, s9, 106496
    s_add_u32 s27, s8, 24576
    s_mov_b32 m0, s26
    s_nop 0
    buffer_load_dwordx4 v7, s[48:51], s27 offen lds
    s_add_u32 s26, s9, 57344
    s_add_u32 s27, s13, 14336
    s_mov_b32 m0, s26
    s_nop 0
    buffer_load_dwordx4 v7, s[44:47], s27 offen lds
    s_add_u32 s26, s9, 61440
    s_add_u32 s27, s13, 15360
    s_mov_b32 m0, s26
    s_nop 0
    buffer_load_dwordx4 v7, s[44:47], s27 offen lds
    s_add_u32 s26, s9, 110592
    s_add_u32 s27, s8, 28672
    s_mov_b32 m0, s26
    s_nop 0
    buffer_load_dwordx4 v7, s[48:51], s27 offen lds
    s_add_u32 s26, s9, 65536
    s_add_u32 s27, s13, 16384
    s_mov_b32 m0, s26
    s_nop 0
    buffer_load_dwordx4 v7, s[44:47], s27 offen lds
    s_waitcnt vmcnt(16)
    s_barrier
    s_add_u32 s26, s9, 69632
    s_add_u32 s27, s13, 17408
    s_mov_b32 m0, s26
    s_nop 0
    buffer_load_dwordx4 v7, s[44:47], s27 offen lds
    s_add_u32 s26, s9, 114688
    s_add_u32 s27, s8, 32768
    s_mov_b32 m0, s26
    s_nop 0
    buffer_load_dwordx4 v7, s[48:51], s27 offen lds
    s_add_u32 s26, s9, 73728
    s_add_u32 s27, s13, 18432
    s_mov_b32 m0, s26
    s_nop 0
    buffer_load_dwordx4 v7, s[44:47], s27 offen lds
    s_add_u32 s26, s9, 77824
    s_add_u32 s27, s13, 19456
    s_mov_b32 m0, s26
    s_nop 0
    buffer_load_dwordx4 v7, s[44:47], s27 offen lds
    s_add_u32 s26, s9, 118784
    s_add_u32 s27, s8, 36864
    s_mov_b32 m0, s26
    s_nop 0
    buffer_load_dwordx4 v7, s[48:51], s27 offen lds
    s_add_u32 s26, s9, 122880
    s_add_u32 s27, s8, 40960
    s_mov_b32 m0, s26
    s_nop 0
    buffer_load_dwordx4 v7, s[48:51], s27 offen lds
    s_waitcnt vmcnt(16)
    s_barrier
    s_add_u32 s26, s9, 126976
    s_add_u32 s27, s8, 45056
    s_mov_b32 m0, s26
    s_nop 0
    buffer_load_dwordx4 v7, s[48:51], s27 offen lds
    s_add_u32 s26, s9, 131072
    s_add_u32 s27, s8, 49152
    s_mov_b32 m0, s26
    s_nop 0
    buffer_load_dwordx4 v7, s[48:51], s27 offen lds
    s_add_u32 s26, s9, 135168
    s_add_u32 s27, s8, 53248
    s_mov_b32 m0, s26
    s_nop 0
    buffer_load_dwordx4 v7, s[48:51], s27 offen lds
    s_add_u32 s26, s9, 139264
    s_add_u32 s27, s8, 57344
    s_mov_b32 m0, s26
    s_nop 0
    buffer_load_dwordx4 v7, s[48:51], s27 offen lds
    s_add_u32 s26, s9, 0
    s_add_u32 s27, s8, 61440
    s_mov_b32 m0, s26
    s_nop 0
    buffer_load_dwordx4 v7, s[48:51], s27 offen lds
    s_add_u32 s26, s9, 4096
    s_add_u32 s27, s8, 65536
    s_mov_b32 m0, s26
    s_nop 0
    buffer_load_dwordx4 v7, s[48:51], s27 offen lds
    s_waitcnt vmcnt(16)
    s_barrier
    s_add_u32 s26, s9, 8192
    s_add_u32 s27, s8, 69632
    s_mov_b32 m0, s26
    s_nop 0
    buffer_load_dwordx4 v7, s[48:51], s27 offen lds
    s_add_u32 s26, s9, 12288
    s_add_u32 s27, s8, 73728
    s_mov_b32 m0, s26
    s_nop 0
    buffer_load_dwordx4 v7, s[48:51], s27 offen lds
    s_add_u32 s26, s9, 16384
    s_add_u32 s27, s8, 77824
    s_mov_b32 m0, s26
    s_nop 0
    buffer_load_dwordx4 v7, s[48:51], s27 offen lds
    s_add_u32 s26, s9, 20480
    s_add_u32 s27, s8, 81920
    s_mov_b32 m0, s26
    s_nop 0
    buffer_load_dwordx4 v7, s[48:51], s27 offen lds
    s_add_u32 s26, s9, 24576
    s_add_u32 s27, s8, 86016
    s_mov_b32 m0, s26
    s_nop 0
    buffer_load_dwordx4 v7, s[48:51], s27 offen lds
    s_waitcnt vmcnt(15)
    s_barrier
    s_add_u32 s26, s9, 28672
    s_add_u32 s27, s8, 90112
    s_mov_b32 m0, s26
    s_nop 0
    buffer_load_dwordx4 v7, s[48:51], s27 offen lds
    s_add_u32 s26, s9, 32768
    s_add_u32 s27, s8, 94208
    s_mov_b32 m0, s26
    s_nop 0
    buffer_load_dwordx4 v7, s[48:51], s27 offen lds
    s_add_u32 s26, s9, 36864
    s_add_u32 s27, s8, 98304
    s_mov_b32 m0, s26
    s_nop 0
    buffer_load_dwordx4 v7, s[48:51], s27 offen lds
    s_waitcnt vmcnt(15)
    s_barrier
    s_waitcnt vmcnt(10)
    s_barrier
    s_waitcnt vmcnt(5)
    s_barrier
    s_waitcnt vmcnt(2)
    s_barrier
    s_waitcnt vmcnt(0)
    s_barrier
opt_end:
    s_endpgm
.section .rodata,"a"
.p2align 6
.amdhsa_kernel oprojt_kernel
  .amdhsa_next_free_vgpr 224
  .amdhsa_next_free_sgpr 102
  .amdhsa_accum_offset 224
  .amdhsa_group_segment_fixed_size 0
  .amdhsa_kernarg_size 120
  .amdhsa_user_sgpr_count 2
  .amdhsa_user_sgpr_kernarg_segment_ptr 1
  .amdhsa_system_sgpr_workgroup_id_x 1
.end_amdhsa_kernel
.text
.globl oprojf_kernel
.p2align 8
.type oprojf_kernel,@function
oprojf_kernel:
    s_cmp_ge_u32 s2, 256
    s_cbranch_scc1 opf_end
    s_load_dwordx16 s[16:31], s[0:1], 0
    s_load_dwordx8 s[32:39], s[0:1], 64
    s_load_dwordx2 s[40:41], s[0:1], 112
    s_load_dwordx2 s[42:43], s[0:1], 96
    v_lshrrev_b32 v2, 6, v0
    v_and_b32 v1, 63, v0
    v_and_b32 v5, 15, v0
    v_readfirstlane_b32 s3, v2
    v_bfe_u32 v6, v0, 4, 2
    v_lshlrev_b32 v7, 4, v1
    s_and_b32 s4, s2, 7
    s_lshl_b32 s4, s4, 2
    s_bfe_u32 s5, s2, 0x20003
    s_add_u32 s4, s4, s5
    s_lshr_b32 s5, s2, 5
    s_cmp_lt_u32 s3, 4
    s_cbranch_scc1 opf_ld
    s_sub_u32 s3, s3, 4
    s_setprio 2
    s_lshl_b32 s12, s4, 2
    s_add_u32 s12, s12, s3
    s_lshl_b32 s12, s12, 4
    s_and_b32 s6, s5, 1
    s_lshl_b32 s6, s6, 4
    s_cmp_eq_u32 s6, 0
    s_cselect_b32 s7, 64, 0
    s_lshl_b32 s11, s3, 5
    v_lshrrev_b32 v12, 2, v1
    v_lshlrev_b32 v12, 7, v12
    v_and_b32 v8, 3, v1
    v_lshl_add_u32 v12, v8, 3, v12
    s_add_u32 s11, s11, 143360
    s_lshl_b32 s8, s6, 7
    s_add_u32 s8, s8, s11
    s_lshl_b32 s9, s7, 7
    s_add_u32 s9, s9, s11
    v_add_u32 v11, s9, v12
    v_add_u32 v12, s8, v12
    s_mul_i32 s11, s3, 2560
    s_add_u32 s11, s11, 40960
    v_mul_u32_u24 v13, 80, v5
    v_lshl_add_u32 v13, v6, 3, v13
    v_add_u32 v13, s11, v13
    v_lshrrev_b32 v9, 2, v1
    v_mul_u32_u24 v27, 80, v9
    v_lshl_add_u32 v27, v8, 4, v27
    v_add_u32 v27, s11, v27
    v_mul_u32_u24 v28, 1280, v9
    v_lshl_add_u32 v28, v8, 4, v28
    v_mul_u32_u24 v15, 1280, v5
    v_lshl_add_u32 v15, v6, 3, v15
    s_mul_i32 s10, s12, 1280
    s_mul_i32 s14, s5, 160
    s_add_u32 s10, s10, s14
    s_lshl_b32 s6, s6, 1
    s_lshl_b32 s7, s7, 1
    s_add_u32 s74, s10, s6
    s_add_u32 s75, s74, 64
    s_add_u32 s76, s10, s7
    s_lshl_b32 s9, s3, 10
    v_add_u32 v9, s9, v7
    v_add_u32 v10, 0x10000, v9
    v_add_u32 v8, 81920, v7
    s_waitcnt lgkmcnt(0)
    s_add_u32 s56, s42, 0
    s_addc_u32 s57, s43, 0
    s_mov_b32 s58, 2621440
    s_mov_b32 s59, 0x00020000
    s_barrier
    ds_read_b128 v[64:67], v9 offset:0
    ds_read_b128 v[144:147], v8 offset:0
    ds_read_b128 v[148:151], v8 offset:1024
    ds_read_b128 v[68:71], v9 offset:4096
    ds_read_b128 v[152:155], v8 offset:2048
    ds_read_b128 v[156:159], v8 offset:3072
    s_barrier
    ds_read_b128 v[72:75], v9 offset:8192
    ds_read_b128 v[160:163], v8 offset:4096
    ds_read_b128 v[164:167], v8 offset:5120
    ds_read_b128 v[76:79], v9 offset:12288
    s_waitcnt lgkmcnt(8)
    v_mfma_f32_16x16x32_bf16 v[192:195], v[144:147], v[64:67], 0
    ds_read_b128 v[168:171], v8 offset:6144
    s_waitcnt lgkmcnt(8)
    v_mfma_f32_16x16x32_bf16 v[196:199], v[148:151], v[64:67], 0
    ds_read_b128 v[172:175], v8 offset:7168
    s_barrier
    ds_read_b128 v[80:83], v9 offset:16384
    s_waitcnt lgkmcnt(8)
    v_mfma_f32_16x16x32_bf16 v[192:195], v[152:155], v[68:71], v[192:195]
    ds_read_b128 v[176:179], v8 offset:8192
    s_waitcnt lgkmcnt(8)
    v_mfma_f32_16x16x32_bf16 v[196:199], v[156:159], v[68:71], v[196:199]
    ds_read_b128 v[180:183], v8 offset:9216
    ds_read_b128 v[84:87], v9 offset:20480
    s_waitcnt lgkmcnt(8)
    v_mfma_f32_16x16x32_bf16 v[192:195], v[160:163], v[72:75], v[192:195]
    ds_read_b128 v[184:187], v8 offset:10240
    s_waitcnt lgkmcnt(8)
    v_mfma_f32_16x16x32_bf16 v[196:199], v[164:167], v[72:75], v[196:199]
    ds_read_b128 v[188:191], v8 offset:11264
    ds_read_b128 v[88:91], v9 offset:24576
    s_waitcnt lgkmcnt(8)
    v_mfma_f32_16x16x32_bf16 v[192:195], v[168:171], v[76:79], v[192:195]
    ds_read_b128 v[144:147], v8 offset:12288
    s_waitcnt lgkmcnt(8)
    v_mfma_f32_16x16x32_bf16 v[196:199], v[172:175], v[76:79], v[196:199]
    ds_read_b128 v[148:151], v8 offset:13312
    ds_read_b128 v[92:95], v9 offset:28672
    s_waitcnt lgkmcnt(8)
    v_mfma_f32_16x16x32_bf16 v[192:195], v[176:179], v[80:83], v[192:195]
    ds_read_b128 v[152:155], v8 offset:14336
    s_waitcnt lgkmcnt(8)
    v_mfma_f32_16x16x32_bf16 v[196:199], v[180:183], v[80:83], v[196:199]
    ds_read_b128 v[156:159], v8 offset:15360
    s_barrier
    ds_read_b128 v[96:99], v9 offset:32768
    s_waitcnt lgkmcnt(8)
    v_mfma_f32_16x16x32_bf16 v[192:195], v[184:187], v[84:87], v[192:195]
    ds_read_b128 v[160:163], v8 offset:16384
    s_waitcnt lgkmcnt(8)
    v_mfma_f32_16x16x32_bf16 v[196:199], v[188:191], v[84:87], v[196:199]
    ds_read_b128 v[164:167], v8 offset:17408
    ds_read_b128 v[100:103], v9 offset:36864
    s_waitcnt lgkmcnt(8)
    v_mfma_f32_16x16x32_bf16 v[192:195], v[144:147], v[88:91], v[192:195]
    ds_read_b128 v[168:171], v8 offset:18432
    s_waitcnt lgkmcnt(8)
    v_mfma_f32_16x16x32_bf16 v[196:199], v[148:151], v[88:91], v[196:199]
    ds_read_b128 v[172:175], v8 offset:19456
    s_barrier
    ds_read_b64_tr_b16 v[32:33], v12 offset:0
    ds_read_b64_tr_b16 v[34:35], v12 offset:2048
    ds_read_b64_tr_b16 v[36:37], v12 offset:4096
    ds_read_b64_tr_b16 v[38:39], v12 offset:6144
    ds_read_b64_tr_b16 v[40:41], v11 offset:0
    ds_read_b128 v[104:107], v9 offset:40960
    s_waitcnt lgkmcnt(13)
    v_mfma_f32_16x16x32_bf16 v[192:195], v[152:155], v[92:95], v[192:195]
    ds_read_b128 v[176:179], v8 offset:20480
    s_waitcnt lgkmcnt(13)
    v_mfma_f32_16x16x32_bf16 v[196:199], v[156:159], v[92:95], v[196:199]
    ds_read_b128 v[180:183], v8 offset:21504
    ds_read_b128 v[108:111], v9 offset:45056
    s_waitcnt lgkmcnt(13)
    v_mfma_f32_16x16x32_bf16 v[192:195], v[160:163], v[96:99], v[192:195]
    ds_read_b128 v[184:187], v8 offset:22528
    s_waitcnt lgkmcnt(13)
    v_mfma_f32_16x16x32_bf16 v[196:199], v[164:167], v[96:99], v[196:199]
    ds_read_b128 v[188:191], v8 offset:23552
    ds_read_b128 v[112:115], v9 offset:49152
    s_waitcnt lgkmcnt(13)
    v_mfma_f32_16x16x32_bf16 v[192:195], v[168:171], v[100:103], v[192:195]
    ds_read_b128 v[144:147], v8 offset:24576
    s_waitcnt lgkmcnt(13)
    v_mfma_f32_16x16x32_bf16 v[196:199], v[172:175], v[100:103], v[196:199]
    ds_read_b128 v[148:151], v8 offset:25600
    ds_read_b128 v[116:119], v9 offset:53248
    s_waitcnt lgkmcnt(8)
    v_mfma_f32_16x16x32_bf16 v[192:195], v[176:179], v[104:107], v[192:195]
    ds_read_b128 v[152:155], v8 offset:26624
    s_waitcnt lgkmcnt(8)
    v_mfma_f32_16x16x32_bf16 v[196:199], v[180:183], v[104:107], v[196:199]
    ds_read_b128 v[156:159], v8 offset:27648
    s_barrier
    ds_read_b128 v[120:123], v9 offset:57344
    s_waitcnt lgkmcnt(8)
    v_lshlrev_b32 v44, 16, v32
    v_and_b32 v45, 0xffff0000, v32
    v_lshlrev_b32 v46, 16, v33
    v_and_b32 v47, 0xffff0000, v33
    v_add_f32 v192, v192, v44
    v_add_f32 v193, v193, v45
    v_add_f32 v194, v194, v46
    v_add_f32 v195, v195, v47
    s_nop 1
    v_mfma_f32_16x16x32_bf16 v[192:195], v[184:187], v[108:111], v[192:195]
    ds_read_b128 v[160:163], v8 offset:28672
    s_waitcnt lgkmcnt(8)
    v_lshlrev_b32 v44, 16, v34
    v_and_b32 v45, 0xffff0000, v34
    v_lshlrev_b32 v46, 16, v35
    v_and_b32 v47, 0xffff0000, v35
    v_add_f32 v196, v196, v44
    v_add_f32 v197, v197, v45
    v_add_f32 v198, v198, v46
    v_add_f32 v199, v199, v47
    v_lshlrev_b32 v200, 16, v36
    v_and_b32 v201, 0xffff0000, v36
    v_lshlrev_b32 v202, 16, v37
    v_and_b32 v203, 0xffff0000, v37
    v_lshlrev_b32 v208, 16, v38
    v_and_b32 v209, 0xffff0000, v38
    v_lshlrev_b32 v210, 16, v39
    v_and_b32 v211, 0xffff0000, v39
    v_lshlrev_b32 v216, 16, v40
    v_and_b32 v217, 0xffff0000, v40
    v_lshlrev_b32 v218, 16, v41
    v_and_b32 v219, 0xffff0000, v41
    v_mfma_f32_16x16x32_bf16 v[196:199], v[188:191], v[108:111], v[196:199]
    ds_read_b128 v[164:167], v8 offset:29696
    ds_read_b128 v[124:127], v9 offset:61440
    s_waitcnt lgkmcnt(8)
    v_mfma_f32_16x16x32_bf16 v[192:195], v[144:147], v[112:115], v[192:195]
    ds_read_b128 v[168:171], v8 offset:30720
    s_waitcnt lgkmcnt(8)
    v_mfma_f32_16x16x32_bf16 v[196:199], v[148:151], v[112:115], v[196:199]
    ds_read_b128 v[172:175], v8 offset:31744
    ds_read_b128 v[128:131], v10 offset:0
    s_waitcnt lgkmcnt(8)
    v_mfma_f32_16x16x32_bf16 v[192:195], v[152:155], v[116:119], v[192:195]
    ds_read_b128 v[176:179], v8 offset:32768
    s_waitcnt lgkmcnt(8)
    v_mfma_f32_16x16x32_bf16 v[196:199], v[156:159], v[116:119], v[196:199]
    ds_read_b128 v[180:183], v8 offset:33792
    ds_read_b128 v[132:135], v10 offset:4096
    s_waitcnt lgkmcnt(8)
    v_mfma_f32_16x16x32_bf16 v[192:195], v[160:163], v[120:123], v[192:195]
    ds_read_b128 v[184:187], v8 offset:34816
    s_waitcnt lgkmcnt(8)
    v_mfma_f32_16x16x32_bf16 v[196:199], v[164:167], v[120:123], v[196:199]
    ds_read_b128 v[188:191], v8 offset:35840
    s_barrier
    ds_read_b128 v[136:139], v10 offset:8192
    s_waitcnt lgkmcnt(8)
    v_mfma_f32_16x16x32_bf16 v[192:195], v[168:171], v[124:127], v[192:195]
    ds_read_b128 v[144:147], v8 offset:36864
    s_waitcnt lgkmcnt(8)
    v_mfma_f32_16x16x32_bf16 v[196:199], v[172:175], v[124:127], v[196:199]
    ds_read_b128 v[148:151], v8 offset:37888
    ds_read_b128 v[140:143], v10 offset:12288
    s_waitcnt lgkmcnt(8)
    v_mfma_f32_16x16x32_bf16 v[192:195], v[176:179], v[128:131], v[192:195]
    ds_read_b128 v[152:155], v8 offset:38912
    s_waitcnt lgkmcnt(8)
    v_mfma_f32_16x16x32_bf16 v[196:199], v[180:183], v[128:131], v[196:199]
    ds_read_b128 v[156:159], v8 offset:39936
    s_barrier
    ds_read_b128 v[160:163], v8 offset:40960
    s_waitcnt lgkmcnt(8)
    v_mfma_f32_16x16x32_bf16 v[192:195], v[184:187], v[132:135], v[192:195]
    ds_read_b128 v[164:167], v8 offset:41984
    s_waitcnt lgkmcnt(8)
    v_mfma_f32_16x16x32_bf16 v[196:199], v[188:191], v[132:135], v[196:199]
    ds_read_b128 v[168:171], v8 offset:43008
    ds_read_b128 v[172:175], v8 offset:44032
    s_waitcnt lgkmcnt(8)
    v_mfma_f32_16x16x32_bf16 v[192:195], v[144:147], v[136:139], v[192:195]
    ds_read_b128 v[176:179], v8 offset:45056
    s_waitcnt lgkmcnt(8)
    v_mfma_f32_16x16x32_bf16 v[196:199], v[148:151], v[136:139], v[196:199]
    ds_read_b128 v[180:183], v8 offset:46080
    ds_read_b128 v[184:187], v8 offset:47104
    s_waitcnt lgkmcnt(8)
    v_mfma_f32_16x16x32_bf16 v[192:195], v[152:155], v[140:143], v[192:195]
    ds_read_b128 v[188:191], v8 offset:48128
    s_waitcnt lgkmcnt(8)
    v_mfma_f32_16x16x32_bf16 v[196:199], v[156:159], v[140:143], v[196:199]
    ds_read_b128 v[144:147], v8 offset:49152
    s_waitcnt lgkmcnt(8)
    v_mfma_f32_16x16x32_bf16 v[200:203], v[160:163], v[64:67], v[200:203]
    ds_read_b128 v[148:151], v8 offset:50176
    s_waitcnt lgkmcnt(8)
    v_mfma_f32_16x16x32_bf16 v[204:207], v[164:167], v[68:71], 0
    ds_read_b128 v[152:155], v8 offset:51200
    s_waitcnt lgkmcnt(8)
    v_mfma_f32_16x16x32_bf16 v[200:203], v[168:171], v[72:75], v[200:203]
    ds_read_b128 v[156:159], v8 offset:52224
    s_waitcnt lgkmcnt(8)
    v_mfma_f32_16x16x32_bf16 v[204:207], v[172:175], v[76:79], v[204:207]
    v_cvt_pk_bf16_f32 v32, v192, v193
    v_cvt_pk_bf16_f32 v33, v194, v195
    ds_write_b64 v13, v[32:33] offset:0
    v_cvt_pk_bf16_f32 v34, v196, v197
    v_cvt_pk_bf16_f32 v35, v198, v199
    ds_write_b64 v13, v[34:35] offset:32
    ds_read_b128 v[160:163], v8 offset:53248
    s_waitcnt lgkmcnt(10)
    v_mfma_f32_16x16x32_bf16 v[200:203], v[176:179], v[80:83], v[200:203]
    ds_read_b128 v[164:167], v8 offset:54272
    s_waitcnt lgkmcnt(10)
    v_mfma_f32_16x16x32_bf16 v[204:207], v[180:183], v[84:87], v[204:207]
    ds_read_b128 v[168:171], v8 offset:55296
    s_waitcnt lgkmcnt(10)
    v_mfma_f32_16x16x32_bf16 v[200:203], v[184:187], v[88:91], v[200:203]
    s_waitcnt lgkmcnt(3)
    ds_read_b128 v[48:51], v27 offset:0
    ds_read_b128 v[172:175], v8 offset:56320
    v_mfma_f32_16x16x32_bf16 v[204:207], v[188:191], v[92:95], v[204:207]
    ds_read_b128 v[176:179], v8 offset:57344
    v_mfma_f32_16x16x32_bf16 v[200:203], v[144:147], v[96:99], v[200:203]
    ds_read_b128 v[180:183], v8 offset:58368
    v_mfma_f32_16x16x32_bf16 v[204:207], v[148:151], v[100:103], v[204:207]
    ds_read_b128 v[184:187], v8 offset:59392
    v_mfma_f32_16x16x32_bf16 v[200:203], v[152:155], v[104:107], v[200:203]
    s_waitcnt lgkmcnt(4)
    buffer_store_dwordx4 v[48:51], v28, s[56:59], s74 offen sc0 sc1
    ds_read_b128 v[188:191], v8 offset:60416
    v_mfma_f32_16x16x32_bf16 v[204:207], v[156:159], v[108:111], v[204:207]
    s_barrier
    ds_read_b128 v[144:147], v7 offset:0
    v_mfma_f32_16x16x32_bf16 v[200:203], v[160:163], v[112:115], v[200:203]
    ds_read_b128 v[148:151], v7 offset:1024
    v_mfma_f32_16x16x32_bf16 v[204:207], v[164:167], v[116:119], v[204:207]
    ds_read_b128 v[152:155], v7 offset:2048
    v_mfma_f32_16x16x32_bf16 v[200:203], v[168:171], v[120:123], v[200:203]
    ds_read_b128 v[156:159], v7 offset:3072
    s_waitcnt lgkmcnt(8)
    v_mfma_f32_16x16x32_bf16 v[204:207], v[172:175], v[124:127], v[204:207]
    ds_read_b128 v[160:163], v7 offset:4096
    s_waitcnt lgkmcnt(8)
    v_mfma_f32_16x16x32_bf16 v[200:203], v[176:179], v[128:131], v[200:203]
    ds_read_b128 v[164:167], v7 offset:5120
    s_waitcnt lgkmcnt(8)
    v_mfma_f32_16x16x32_bf16 v[204:207], v[180:183], v[132:135], v[204:207]
    ds_read_b128 v[168:171], v7 offset:6144
    s_waitcnt lgkmcnt(8)
    v_mfma_f32_16x16x32_bf16 v[200:203], v[184:187], v[136:139], v[200:203]
    ds_read_b128 v[172:175], v7 offset:7168
    s_waitcnt lgkmcnt(8)
    v_mfma_f32_16x16x32_bf16 v[204:207], v[188:191], v[140:143], v[204:207]
    ds_read_b128 v[176:179], v7 offset:8192
    s_waitcnt lgkmcnt(8)
    v_mfma_f32_16x16x32_bf16 v[208:211], v[144:147], v[64:67], v[208:211]
    ds_read_b128 v[180:183], v7 offset:9216
    s_waitcnt lgkmcnt(8)
    v_mfma_f32_16x16x32_bf16 v[212:215], v[148:151], v[68:71], 0
    ds_read_b128 v[184:187], v7 offset:10240
    s_waitcnt lgkmcnt(8)
    v_mfma_f32_16x16x32_bf16 v[208:211], v[152:155], v[72:75], v[208:211]
    ds_read_b128 v[188:191], v7 offset:11264
    s_waitcnt lgkmcnt(8)
    v_mfma_f32_16x16x32_bf16 v[212:215], v[156:159], v[76:79], v[212:215]
    v_add_f32 v200, v200, v204
    v_add_f32 v201, v201, v205
    v_add_f32 v202, v202, v206
    v_add_f32 v203, v203, v207
    v_cvt_pk_bf16_f32 v36, v200, v201
    v_cvt_pk_bf16_f32 v37, v202, v203
    ds_write_b64 v13, v[36:37] offset:1280
    ds_read_b128 v[144:147], v7 offset:12288
    s_waitcnt lgkmcnt(9)
    v_mfma_f32_16x16x32_bf16 v[208:211], v[160:163], v[80:83], v[208:211]
    ds_read_b128 v[148:151], v7 offset:13312
    s_waitcnt lgkmcnt(9)
    v_mfma_f32_16x16x32_bf16 v[212:215], v[164:167], v[84:87], v[212:215]
    ds_read_b128 v[152:155], v7 offset:14336
    s_waitcnt lgkmcnt(9)
    v_mfma_f32_16x16x32_bf16 v[208:211], v[168:171], v[88:91], v[208:211]
    ds_read_b128 v[156:159], v7 offset:15360
    s_waitcnt lgkmcnt(9)
    v_mfma_f32_16x16x32_bf16 v[212:215], v[172:175], v[92:95], v[212:215]
    ds_read_b128 v[160:163], v7 offset:16384
    s_waitcnt lgkmcnt(9)
    v_mfma_f32_16x16x32_bf16 v[208:211], v[176:179], v[96:99], v[208:211]
    ds_read_b128 v[164:167], v7 offset:17408
    s_waitcnt lgkmcnt(9)
    v_mfma_f32_16x16x32_bf16 v[212:215], v[180:183], v[100:103], v[212:215]
    ds_read_b128 v[168:171], v7 offset:18432
    s_waitcnt lgkmcnt(9)
    v_mfma_f32_16x16x32_bf16 v[208:211], v[184:187], v[104:107], v[208:211]
    ds_read_b128 v[172:175], v7 offset:19456
    s_waitcnt lgkmcnt(9)
    v_mfma_f32_16x16x32_bf16 v[212:215], v[188:191], v[108:111], v[212:215]
    s_barrier
    ds_read_b128 v[176:179], v7 offset:20480
    s_waitcnt lgkmcnt(8)
    v_mfma_f32_16x16x32_bf16 v[208:211], v[144:147], v[112:115], v[208:211]
    ds_read_b128 v[180:183], v7 offset:21504
    s_waitcnt lgkmcnt(8)
    v_mfma_f32_16x16x32_bf16 v[212:215], v[148:151], v[116:119], v[212:215]
    ds_read_b128 v[184:187], v7 offset:22528
    s_waitcnt lgkmcnt(8)
    v_mfma_f32_16x16x32_bf16 v[208:211], v[152:155], v[120:123], v[208:211]
    ds_read_b128 v[188:191], v7 offset:23552
    s_waitcnt lgkmcnt(8)
    v_mfma_f32_16x16x32_bf16 v[212:215], v[156:159], v[124:127], v[212:215]
    ds_read_b128 v[144:147], v7 offset:24576
    s_waitcnt lgkmcnt(8)
    v_mfma_f32_16x16x32_bf16 v[208:211], v[160:163], v[128:131], v[208:211]
    ds_read_b128 v[148:151], v7 offset:25600
    s_waitcnt lgkmcnt(8)
    v_mfma_f32_16x16x32_bf16 v[212:215], v[164:167], v[132:135], v[212:215]
    ds_read_b128 v[152:155], v7 offset:26624
    s_waitcnt lgkmcnt(8)
    v_mfma_f32_16x16x32_bf16 v[208:211], v[168:171], v[136:139], v[208:211]
    ds_read_b128 v[156:159], v7 offset:27648
    s_waitcnt lgkmcnt(8)
    v_mfma_f32_16x16x32_bf16 v[212:215], v[172:175], v[140:143], v[212:215]
    ds_read_b128 v[160:163], v7 offset:28672
    s_waitcnt lgkmcnt(8)
    v_mfma_f32_16x16x32_bf16 v[216:219], v[176:179], v[64:67], v[216:219]
    ds_read_b128 v[164:167], v7 offset:29696
    s_waitcnt lgkmcnt(8)
    v_mfma_f32_16x16x32_bf16 v[220:223], v[180:183], v[68:71], 0
    ds_read_b128 v[168:171], v7 offset:30720
    s_waitcnt lgkmcnt(8)
    v_mfma_f32_16x16x32_bf16 v[216:219], v[184:187], v[72:75], v[216:219]
    ds_read_b128 v[172:175], v7 offset:31744
    s_waitcnt lgkmcnt(8)
    v_mfma_f32_16x16x32_bf16 v[220:223], v[188:191], v[76:79], v[220:223]
    v_add_f32 v208, v208, v212
    v_add_f32 v209, v209, v213
    v_add_f32 v210, v210, v214
    v_add_f32 v211, v211, v215
    v_cvt_pk_bf16_f32 v38, v208, v209
    v_cvt_pk_bf16_f32 v39, v210, v211
    ds_write_b64 v13, v[38:39] offset:1312
    s_barrier
    ds_read_b128 v[176:179], v7 offset:32768
    s_waitcnt lgkmcnt(9)
    v_mfma_f32_16x16x32_bf16 v[216:219], v[144:147], v[80:83], v[216:219]
    ds_read_b128 v[180:183], v7 offset:33792
    s_waitcnt lgkmcnt(9)
    v_mfma_f32_16x16x32_bf16 v[220:223], v[148:151], v[84:87], v[220:223]
    ds_read_b128 v[184:187], v7 offset:34816
    s_waitcnt lgkmcnt(9)
    v_mfma_f32_16x16x32_bf16 v[216:219], v[152:155], v[88:91], v[216:219]
    s_waitcnt lgkmcnt(3)
    ds_read_b128 v[48:51], v27 offset:1280
    ds_read_b128 v[188:191], v7 offset:35840
    v_mfma_f32_16x16x32_bf16 v[220:223], v[156:159], v[92:95], v[220:223]
    ds_read_b128 v[144:147], v7 offset:36864
    v_mfma_f32_16x16x32_bf16 v[216:219], v[160:163], v[96:99], v[216:219]
    ds_read_b128 v[148:151], v7 offset:37888
    v_mfma_f32_16x16x32_bf16 v[220:223], v[164:167], v[100:103], v[220:223]
    ds_read_b128 v[152:155], v7 offset:38912
    v_mfma_f32_16x16x32_bf16 v[216:219], v[168:171], v[104:107], v[216:219]
    s_waitcnt lgkmcnt(4)
    buffer_store_dwordx4 v[48:51], v28, s[56:59], s75 offen sc0 sc1
    ds_read_b128 v[156:159], v7 offset:39936
    v_mfma_f32_16x16x32_bf16 v[220:223], v[172:175], v[108:111], v[220:223]
    v_mfma_f32_16x16x32_bf16 v[216:219], v[176:179], v[112:115], v[216:219]
    v_mfma_f32_16x16x32_bf16 v[220:223], v[180:183], v[116:119], v[220:223]
    v_mfma_f32_16x16x32_bf16 v[216:219], v[184:187], v[120:123], v[216:219]
    s_waitcnt lgkmcnt(4)
    v_mfma_f32_16x16x32_bf16 v[220:223], v[188:191], v[124:127], v[220:223]
    s_waitcnt lgkmcnt(3)
    v_mfma_f32_16x16x32_bf16 v[216:219], v[144:147], v[128:131], v[216:219]
    s_waitcnt lgkmcnt(2)
    v_mfma_f32_16x16x32_bf16 v[220:223], v[148:151], v[132:135], v[220:223]
    s_waitcnt lgkmcnt(1)
    v_mfma_f32_16x16x32_bf16 v[216:219], v[152:155], v[136:139], v[216:219]
    s_waitcnt lgkmcnt(0)
    v_mfma_f32_16x16x32_bf16 v[220:223], v[156:159], v[140:143], v[220:223]
    s_nop 7
    v_add_f32 v216, v216, v220
    v_add_f32 v217, v217, v221
    v_add_f32 v218, v218, v222
    v_add_f32 v219, v219, v223
    v_cvt_pk_bf16_f32 v40, v216, v217
    v_cvt_pk_bf16_f32 v41, v218, v219
    buffer_store_dwordx2 v[40:41], v15, s[56:59], s76 offen
    s_endpgm
opf_ld:
    s_lshl_b32 s9, s3, 10
    s_mul_i32 s8, s5, 102400
    s_add_u32 s8, s8, s9
    s_lshl_b32 s12, s4, 2
    s_add_u32 s12, s12, s3
    s_mul_i32 s13, s12, 20480
    s_mul_i32 s10, s4, 81920
    s_mul_i32 s11, s5, 10240
    s_add_u32 s10, s10, s11
    v_add_u32 v8, s10, v7
    v_add_u32 v8, s9, v8
    s_waitcnt lgkmcnt(0)
    s_add_u32 s44, s40, 34603008
    s_addc_u32 s45, s41, 0
    s_mov_b32 s46, 2621440
    s_mov_b32 s47, 0x00020000
    s_add_u32 s48, s40, 1048576
    s_addc_u32 s49, s41, 0
    s_mov_b32 s50, 819200
    s_mov_b32 s51, 0x00020000
    s_add_u32 s26, s9, 0
    s_add_u32 s27, s13, 0
    s_mov_b32 m0, s26
    s_nop 0
    buffer_load_dwordx4 v7, s[44:47], s27 offen lds
    s_add_u32 s26, s9, 4096
    s_add_u32 s27, s13, 1024
    s_mov_b32 m0, s26
    s_nop 0
    buffer_load_dwordx4 v7, s[44:47], s27 offen lds
    s_add_u32 s26, s9, 81920
    s_add_u32 s27, s8, 0
    s_mov_b32 m0, s26
    s_nop 0
    buffer_load_dwordx4 v7, s[48:51], s27 offen lds
    s_add_u32 s26, s9, 8192
    s_add_u32 s27, s13, 2048
    s_mov_b32 m0, s26
    s_nop 0
    buffer_load_dwordx4 v7, s[44:47], s27 offen lds
    s_add_u32 s26, s9, 12288
    s_add_u32 s27, s13, 3072
    s_mov_b32 m0, s26
    s_nop 0
    buffer_load_dwordx4 v7, s[44:47], s27 offen lds
    s_add_u32 s26, s9, 86016
    s_add_u32 s27, s8, 4096
    s_mov_b32 m0, s26
    s_nop 0
    buffer_load_dwordx4 v7, s[48:51], s27 offen lds
    s_add_u32 s26, s9, 16384
    s_add_u32 s27, s13, 4096
    s_mov_b32 m0, s26
    s_nop 0
    buffer_load_dwordx4 v7, s[44:47], s27 offen lds
    s_add_u32 s26, s9, 20480
    s_add_u32 s27, s13, 5120
    s_mov_b32 m0, s26
    s_nop 0
    buffer_load_dwordx4 v7, s[44:47], s27 offen lds
    s_add_u32 s26, s9, 90112
    s_add_u32 s27, s8, 8192
    s_mov_b32 m0, s26
    s_nop 0
    buffer_load_dwordx4 v7, s[48:51], s27 offen lds
    s_add_u32 s26, s9, 24576
    s_add_u32 s27, s13, 6144
    s_mov_b32 m0, s26
    s_nop 0
    buffer_load_dwordx4 v7, s[44:47], s27 offen lds
    s_add_u32 s26, s9, 28672
    s_add_u32 s27, s13, 7168
    s_mov_b32 m0, s26
    s_nop 0
    buffer_load_dwordx4 v7, s[44:47], s27 offen lds
    s_waitcnt vmcnt(8)
    s_barrier
    s_add_u32 s26, s9, 94208
    s_add_u32 s27, s8, 12288
    s_mov_b32 m0, s26
    s_nop 0
    buffer_load_dwordx4 v7, s[48:51], s27 offen lds
    s_add_u32 s52, s40, 26214400
    s_addc_u32 s53, s41, 0
    s_mov_b32 s54, 2621440
    s_mov_b32 s55, 0x00020000
    s_add_u32 s26, s9, 143360
    s_mov_b32 m0, s26
    s_nop 0
    buffer_load_dwordx4 v8, s[52:55], 0 offen lds
    v_add_u32 v8, 4096, v8
    s_add_u32 s26, s9, 147456
    s_mov_b32 m0, s26
    s_nop 0
    buffer_load_dwordx4 v8, s[52:55], 0 offen lds
    v_add_u32 v8, 4096, v8
    s_add_u32 s26, s9, 151552
    s_mov_b32 m0, s26
    s_nop 0
    buffer_load_dwordx4 v8, s[52:55], 0 offen lds
    s_add_u32 s26, s9, 32768
    s_add_u32 s27, s13, 8192
    s_mov_b32 m0, s26
    s_nop 0
    buffer_load_dwordx4 v7, s[44:47], s27 offen lds
    s_add_u32 s26, s9, 36864
    s_add_u32 s27, s13, 9216
    s_mov_b32 m0, s26
    s_nop 0
    buffer_load_dwordx4 v7, s[44:47], s27 offen lds
    s_add_u32 s26, s9, 98304
    s_add_u32 s27, s8, 16384
    s_mov_b32 m0, s26
    s_nop 0
    buffer_load_dwordx4 v7, s[48:51], s27 offen lds
    s_add_u32 s26, s9, 40960
    s_add_u32 s27, s13, 10240
    s_mov_b32 m0, s26
    s_nop 0
    buffer_load_dwordx4 v7, s[44:47], s27 offen lds
    s_add_u32 s26, s9, 45056
    s_add_u32 s27, s13, 11264
    s_mov_b32 m0, s26
    s_nop 0
    buffer_load_dwordx4 v7, s[44:47], s27 offen lds
    s_add_u32 s26, s9, 102400
    s_add_u32 s27, s8, 20480
    s_mov_b32 m0, s26
    s_nop 0
    buffer_load_dwordx4 v7, s[48:51], s27 offen lds
    s_add_u32 s26, s9, 49152
    s_add_u32 s27, s13, 12288
    s_mov_b32 m0, s26
    s_nop 0
    buffer_load_dwordx4 v7, s[44:47], s27 offen lds
    s_waitcnt vmcnt(16)
    s_barrier
    s_add_u32 s26, s9, 53248
    s_add_u32 s27, s13, 13312
    s_mov_b32 m0, s26
    s_nop 0
    buffer_load_dwordx4 v7, s[44:47], s27 offen lds
    s_add_u32 s26, s9, 106496
    s_add_u32 s27, s8, 24576
    s_mov_b32 m0, s26
    s_nop 0
    buffer_load_dwordx4 v7, s[48:51], s27 offen lds
    s_add_u32 s26, s9, 57344
    s_add_u32 s27, s13, 14336
    s_mov_b32 m0, s26
    s_nop 0
    buffer_load_dwordx4 v7, s[44:47], s27 offen lds
    s_add_u32 s26, s9, 61440
    s_add_u32 s27, s13, 15360
    s_mov_b32 m0, s26
    s_nop 0
    buffer_load_dwordx4 v7, s[44:47], s27 offen lds
    s_add_u32 s26, s9, 110592
    s_add_u32 s27, s8, 28672
    s_mov_b32 m0, s26
    s_nop 0
    buffer_load_dwordx4 v7, s[48:51], s27 offen lds
    s_add_u32 s26, s9, 65536
    s_add_u32 s27, s13, 16384
    s_mov_b32 m0, s26
    s_nop 0
    buffer_load_dwordx4 v7, s[44:47], s27 offen lds
    s_waitcnt vmcnt(16)
    s_barrier
    s_add_u32 s26, s9, 69632
    s_add_u32 s27, s13, 17408
    s_mov_b32 m0, s26
    s_nop 0
    buffer_load_dwordx4 v7, s[44:47], s27 offen lds
    s_add_u32 s26, s9, 114688
    s_add_u32 s27, s8, 32768
    s_mov_b32 m0, s26
    s_nop 0
    buffer_load_dwordx4 v7, s[48:51], s27 offen lds
    s_add_u32 s26, s9, 73728
    s_add_u32 s27, s13, 18432
    s_mov_b32 m0, s26
    s_nop 0
    buffer_load_dwordx4 v7, s[44:47], s27 offen lds
    s_add_u32 s26, s9, 77824
    s_add_u32 s27, s13, 19456
    s_mov_b32 m0, s26
    s_nop 0
    buffer_load_dwordx4 v7, s[44:47], s27 offen lds
    s_add_u32 s26, s9, 118784
    s_add_u32 s27, s8, 36864
    s_mov_b32 m0, s26
    s_nop 0
    buffer_load_dwordx4 v7, s[48:51], s27 offen lds
    s_add_u32 s26, s9, 122880
    s_add_u32 s27, s8, 40960
    s_mov_b32 m0, s26
    s_nop 0
    buffer_load_dwordx4 v7, s[48:51], s27 offen lds
    s_waitcnt vmcnt(16)
    s_barrier
    s_add_u32 s26, s9, 126976
    s_add_u32 s27, s8, 45056
    s_mov_b32 m0, s26
    s_nop 0
    buffer_load_dwordx4 v7, s[48:51], s27 offen lds
    s_add_u32 s26, s9, 131072
    s_add_u32 s27, s8, 49152
    s_mov_b32 m0, s26
    s_nop 0
    buffer_load_dwordx4 v7, s[48:51], s27 offen lds
    s_add_u32 s26, s9, 135168
    s_add_u32 s27, s8, 53248
    s_mov_b32 m0, s26
    s_nop 0
    buffer_load_dwordx4 v7, s[48:51], s27 offen lds
    s_add_u32 s26, s9, 139264
    s_add_u32 s27, s8, 57344
    s_mov_b32 m0, s26
    s_nop 0
    buffer_load_dwordx4 v7, s[48:51], s27 offen lds
    s_add_u32 s26, s9, 0
    s_add_u32 s27, s8, 61440
    s_mov_b32 m0, s26
    s_nop 0
    buffer_load_dwordx4 v7, s[48:51], s27 offen lds
    s_add_u32 s26, s9, 4096
    s_add_u32 s27, s8, 65536
    s_mov_b32 m0, s26
    s_nop 0
    buffer_load_dwordx4 v7, s[48:51], s27 offen lds
    s_waitcnt vmcnt(16)
    s_barrier
    s_add_u32 s26, s9, 8192
    s_add_u32 s27, s8, 69632
    s_mov_b32 m0, s26
    s_nop 0
    buffer_load_dwordx4 v7, s[48:51], s27 offen lds
    s_add_u32 s26, s9, 12288
    s_add_u32 s27, s8, 73728
    s_mov_b32 m0, s26
    s_nop 0
    buffer_load_dwordx4 v7, s[48:51], s27 offen lds
    s_add_u32 s26, s9, 16384
    s_add_u32 s27, s8, 77824
    s_mov_b32 m0, s26
    s_nop 0
    buffer_load_dwordx4 v7, s[48:51], s27 offen lds
    s_add_u32 s26, s9, 20480
    s_add_u32 s27, s8, 81920
    s_mov_b32 m0, s26
    s_nop 0
    buffer_load_dwordx4 v7, s[48:51], s27 offen lds
    s_add_u32 s26, s9, 24576
    s_add_u32 s27, s8, 86016
    s_mov_b32 m0, s26
    s_nop 0
    buffer_load_dwordx4 v7, s[48:51], s27 offen lds
    s_waitcnt vmcnt(15)
    s_barrier
    s_add_u32 s26, s9, 28672
    s_add_u32 s27, s8, 90112
    s_mov_b32 m0, s26
    s_nop 0
    buffer_load_dwordx4 v7, s[48:51], s27 offen lds
    s_add_u32 s26, s9, 32768
    s_add_u32 s27, s8, 94208
    s_mov_b32 m0, s26
    s_nop 0
    buffer_load_dwordx4 v7, s[48:51], s27 offen lds
    s_add_u32 s26, s9, 36864
    s_add_u32 s27, s8, 98304
    s_mov_b32 m0, s26
    s_nop 0
    buffer_load_dwordx4 v7, s[48:51], s27 offen lds
    s_waitcnt vmcnt(15)
    s_barrier
    s_waitcnt vmcnt(10)
    s_barrier
    s_waitcnt vmcnt(5)
    s_barrier
    s_waitcnt vmcnt(2)
    s_barrier
    s_waitcnt vmcnt(0)
    s_barrier
opf_end:
    s_endpgm
.section .rodata,"a"
.p2align 6
.amdhsa_kernel oprojf_kernel
  .amdhsa_next_free_vgpr 224
  .amdhsa_next_free_sgpr 102
  .amdhsa_accum_offset 224
  .amdhsa_group_segment_fixed_size 0
  .amdhsa_kernarg_size 120
  .amdhsa_user_sgpr_count 2
  .amdhsa_user_sgpr_kernarg_segment_ptr 1
  .amdhsa_system_sgpr_workgroup_id_x 1
.end_amdhsa_kernel
.text
code_end:
```
